```python
import torch

def _softmax(x, axis=-1):
    return torch.softmax(x, dim=axis)
def _gelu(x):
    return torch.nn.functional.gelu(x, approximate="tanh")
def _silu(x):
    return torch.nn.functional.silu(x)
def _sigmoid(x):
    return torch.sigmoid(x)
def _layernorm(x, axis=-1, eps=1e-5):
    m = x.mean(dim=axis, keepdim=True)
    v = x.var(dim=axis, keepdim=True, unbiased=False)
    return (x - m) / torch.sqrt(v + eps)
def _scatter_add(tgt, idx, src, axis=0):
    return tgt.clone().index_add_(axis, idx, src)
def _segment_sum(src, seg, n):
    out = torch.zeros((n,) + src.shape[1:], dtype=src.dtype)
    return out.index_add_(0, seg, src)
def _pad(x, pw):
    flat = tuple(v for pair in reversed(pw) for v in pair)
    return torch.nn.functional.pad(x, flat)

kernel_name = 'sequential_preLN__softmax_full_mha__glu_gated_swiglu__prompt'

def setup_inputs():

    _w = (lambda a: (lambda t: t.to(torch.bfloat16) if t.is_floating_point() else t)(torch.as_tensor(a)))
    def _A_setup():
        B, S, D = 1, 2048, 512
        return {
            "x": _w((lambda *s: torch.randn(*s, dtype=torch.bfloat16) * 0.05)(B, S, D)),
            "wqkv": _w((lambda *s: torch.randn(*s, dtype=torch.bfloat16) * 0.05)(D, 3 * D)),
            "wo": _w((lambda *s: torch.randn(*s, dtype=torch.bfloat16) * 0.05)(D, D)),
        }
    _A_in = _A_setup()

    def _B_setup():
        B, S, D, F = 1, 2048, 512, 1792
        return {
            "x": _w((lambda *s: torch.randn(*s, dtype=torch.bfloat16) * 0.05)(B, S, D)),
            "w1": _w((lambda *s: torch.randn(*s, dtype=torch.bfloat16) * 0.4)(D, F) * (2.0 / D) ** 0.5),
            "w3": _w((lambda *s: torch.randn(*s, dtype=torch.bfloat16) * 0.4)(D, F) * (2.0 / D) ** 0.5),
            "w2": _w((lambda *s: torch.randn(*s, dtype=torch.bfloat16) * 0.4)(F, D) * (2.0 / F) ** 0.5),
        }
    _B_in = _B_setup()

    return {
        "A_x": _A_in["x"],
        "A_wqkv": _A_in["wqkv"],
        "A_wo": _A_in["wo"],
        "B_x": _B_in["x"],
        "B_w1": _B_in["w1"],
        "B_w3": _B_in["w3"],
        "B_w2": _B_in["w2"],
    }

def reference(A_x, A_wqkv, A_wo, B_x, B_w1, B_w3, B_w2):
    def _A_ref(x, wqkv, wo):
        B, S, D = x.shape
        H = 32; Dh = D // H
        qkv = (lambda x, *d: x.permute(*d))((x @ wqkv).reshape(B, S, 3, H, Dh), 2, 0, 3, 1, 4)
        q, k, v = qkv[0], qkv[1], qkv[2]
        scale = Dh ** -0.5
        scores = torch.einsum("bhqd,bhkd->bhqk", q, k) * scale
        p = _softmax(scores, axis=-1)
        o = torch.einsum("bhqk,bhkd->bhqd", p, v)
        return (lambda x, *d: x.permute(*d))(o, 0, 2, 1, 3).reshape(B, S, D) @ wo

    def _B_ref(x, w1, w3, w2):
        gate = torch.einsum("bsd,df->bsf", x, w1)
        up = torch.einsum("bsd,df->bsf", x, w3)
        h = _silu(gate) * up
        out = torch.einsum("bsf,fd->bsd", h, w2)
        return out

    x = A_x
    h = x + _A_ref(_layernorm(x, axis=-1), A_wqkv, A_wo)
    h2 = h + _B_ref(_layernorm(h, axis=-1), B_w1, B_w3, B_w2)
    return h2
```

```asm
; @launch grid=(256,1,1) block=(256,1,1) lds=163840
.amdgcn_target "amdgcn-amd-amdhsa--gfx950"
.text
.globl sequential_preLN__softmax_full_mha__glu_gated_swiglu__prompt_kernel
.p2align 8
.type sequential_preLN__softmax_full_mha__glu_gated_swiglu__prompt_kernel,@function
sequential_preLN__softmax_full_mha__glu_gated_swiglu__prompt_kernel:
    s_load_dwordx16 s[32:47], s[0:1], 0
    s_load_dwordx4 s[48:51], s[0:1], 64
    s_cmp_ge_u32 s2, 256
    s_cbranch_scc1 F_exit
    v_lshrrev_b32 v3, 6, v0
    v_and_b32 v2, 63, v0
    v_readfirstlane_b32 s3, v3
    s_and_b32 s52, s2, 7
    s_lshr_b32 s53, s2, 3
    s_getpc_b64 s[94:95]
F_ct0:
    s_lshl2_add_u32 s98, s53, s3
    s_and_b32 s98, s98, 127
    s_lshl_b32 s98, s98, 9
    v_lshlrev_b32 v254, 7, v2
    v_add_u32 v254, s98, v254
    s_mov_b32 s98, F_fallback-F_ct0
    v_min_u32 v254, s98, v254
    s_mov_b64 exec, 0xf
    global_load_dword v255, v254, s[94:95]
    s_mov_b64 exec, -1
    s_and_b32 s54, s53, 15
    s_lshr_b32 s31, s53, 4
    s_xor_b32 s72, s52, 0
    s_lshl3_add_u32 s55, s31, s72
    s_mov_b32 s72, s54
    s_mul_i32 s31, s52, 1
    s_add_u32 s72, s72, s31
    s_and_b32 s72, s72, 7
    v_lshrrev_b32 v3, 3, v2
    v_lshrrev_b32 v4, 4, v2
    v_and_b32 v5, 7, v2
    v_xor_b32 v6, v4, v5
    v_lshlrev_b32 v6, 4, v6
    v_lshl_add_u32 v16, v3, 10, v6
    v_xor_b32 v6, 64, v16
    v_add_u32 v17, 7168, v6
    v_add_u32 v18, 14336, v16
    v_add_u32 v19, 21504, v6
    s_lshl2_add_u32 s56, s54, s3
    s_lshl_b32 s57, s56, 15
    s_lshl_b32 s31, s72, 7
    s_add_u32 s57, s57, s31
    s_mul_i32 s59, s3, 20480
    s_mov_b32 s10, 2097152
    s_mov_b32 s11, 0x20000
    s_mul_i32 s58, s3, 49152
    s_lshl_b32 s31, s55, 6
    s_add_u32 s58, s58, s31
    s_mul_i32 s31, s72, 196608
    s_add_u32 s58, s58, s31
    s_mul_i32 s60, s3, 3072
    s_add_u32 s60, s60, 81920
    s_mov_b32 s18, 1572864
    s_mov_b32 s19, 0x20000
    v_add_u32 v6, 0, v2
    v_mul_u32_u24 v7, 171, v6
    v_lshrrev_b32 v7, 11, v7
    v_mul_u32_u24 v23, 12, v7
    v_sub_u32 v6, v6, v23
    v_mul_u32_u24 v7, 3072, v7
    v_lshrrev_b32 v23, 2, v6
    v_lshl_add_u32 v7, v23, 10, v7
    v_and_b32 v6, 3, v6
    v_lshl_add_u32 v7, v6, 4, v7
    v_subrev_u32 v20, 0, v7
    v_add_u32 v6, 64, v2
    v_mul_u32_u24 v7, 171, v6
    v_lshrrev_b32 v7, 11, v7
    v_mul_u32_u24 v23, 12, v7
    v_sub_u32 v6, v6, v23
    v_mul_u32_u24 v7, 3072, v7
    v_lshrrev_b32 v23, 2, v6
    v_lshl_add_u32 v7, v23, 10, v7
    v_and_b32 v6, 3, v6
    v_lshl_add_u32 v7, v6, 4, v7
    v_subrev_u32 v21, 1024, v7
    v_add_u32 v6, 128, v2
    v_mul_u32_u24 v7, 171, v6
    v_lshrrev_b32 v7, 11, v7
    v_mul_u32_u24 v23, 12, v7
    v_sub_u32 v6, v6, v23
    v_mul_u32_u24 v7, 3072, v7
    v_lshrrev_b32 v23, 2, v6
    v_lshl_add_u32 v7, v23, 10, v7
    v_and_b32 v6, 3, v6
    v_lshl_add_u32 v7, v6, 4, v7
    v_subrev_u32 v22, 2048, v7
    s_waitcnt lgkmcnt(0)
    s_mov_b32 s8, s32
    s_mov_b32 s9, s33
    s_mov_b32 s16, s34
    s_mov_b32 s17, s35
    s_add_u32 m0, s59, 0
    s_nop 0
    buffer_load_dwordx4 v16, s[8:11], s57 offen offset:0 lds
    buffer_load_dwordx4 v17, s[8:11], s57 offen offset:1024 lds
    buffer_load_dwordx4 v18, s[8:11], s57 offen offset:2048 lds
    buffer_load_dwordx4 v19, s[8:11], s57 offen offset:3072 lds
    s_add_u32 s57, s57, 128
    s_bitset0_b32 s57, 10
    s_add_u32 m0, s60, 0
    s_nop 0
    buffer_load_dwordx4 v20, s[16:19], s58 offen offset:0 lds
    buffer_load_dwordx4 v21, s[16:19], s58 offen offset:1024 lds
    buffer_load_dwordx4 v22, s[16:19], s58 offen offset:2048 lds
    s_add_u32 s58, s58, 196608
    s_sub_u32 s31, s58, 1572864
    s_min_u32 s58, s58, s31
    v_lshlrev_b32 v1, 4, v2
    s_mov_b32 s28, 1065369472
    s_mov_b32 s29, 117834498
    s_mov_b32 s30, 60000
    s_getreg_b32 s70, hwreg(HW_REG_XCC_ID, 0, 4)
    s_and_b32 s70, s70, 7
    s_add_u32 s70, s70, 1
    v_and_b32 v3, 31, v2
    v_lshrrev_b32 v4, 5, v2
    v_bfe_u32 v5, v3, 1, 3
    v_lshlrev_b32 v6, 7, v3
    v_add_u32 v6, s59, v6
    v_bfe_u32 v7, v2, 2, 2
    v_lshl_add_u32 v7, v4, 3, v7
    v_mul_u32_u24 v7, 192, v7
    v_bfe_u32 v23, v2, 4, 1
    v_lshl_add_u32 v7, v23, 5, v7
    v_and_b32 v23, 3, v2
    v_lshl_add_u32 v7, v23, 3, v7
    v_add_u32 v7, 81920, v7
    s_add_u32 s73, s3, 0
    s_and_b32 s73, s73, 3
    s_lshl_b32 s74, s73, 1
    v_add_u32 v23, s74, v4
    v_xor_b32 v23, v23, v5
    v_lshl_add_u32 v8, v23, 4, v6
    s_mul_i32 s74, s73, 3072
    v_add_u32 v12, s74, v7
    s_add_u32 s73, s3, 1
    s_and_b32 s73, s73, 3
    s_lshl_b32 s74, s73, 1
    v_add_u32 v23, s74, v4
    v_xor_b32 v23, v23, v5
    v_lshl_add_u32 v9, v23, 4, v6
    s_mul_i32 s74, s73, 3072
    v_add_u32 v13, s74, v7
    s_add_u32 s73, s3, 2
    s_and_b32 s73, s73, 3
    s_lshl_b32 s74, s73, 1
    v_add_u32 v23, s74, v4
    v_xor_b32 v23, v23, v5
    v_lshl_add_u32 v10, v23, 4, v6
    s_mul_i32 s74, s73, 3072
    v_add_u32 v14, s74, v7
    s_add_u32 s73, s3, 3
    s_and_b32 s73, s73, 3
    s_lshl_b32 s74, s73, 1
    v_add_u32 v23, s74, v4
    v_xor_b32 v23, v23, v5
    v_lshl_add_u32 v11, v23, 4, v6
    s_mul_i32 s74, s73, 3072
    v_add_u32 v15, s74, v7
    v_lshrrev_b32 v23, 2, v2
    v_xor_b32 v23, v23, v2
    v_and_b32 v24, 3, v2
    v_bfe_u32 v23, v23, 2, 1
    v_or_b32 v23, v23, v24
    v_mov_b32 v24, s28
    v_cmp_eq_u32 vcc, 0, v23
    s_mov_b32 s75, 0xffff0000
    s_nop 0
    v_cndmask_b32 v200, 0, v24, vcc
    v_cndmask_b32 v201, 0, v24, vcc
    v_cndmask_b32 v202, 0, v24, vcc
    v_cndmask_b32 v203, 0, v24, vcc
    s_mov_b32 s4, s50
    s_mov_b32 s5, s51
    s_mov_b32 s6, 33554432
    s_mov_b32 s7, 0x20000
    s_mov_b32 s12, s46
    s_mov_b32 s13, s47
    s_mov_b32 s14, 2097152
    s_mov_b32 s15, 0x20000
    s_mov_b32 s24, s48
    s_mov_b32 s25, s49
    s_mov_b32 s26, 256
    s_mov_b32 s27, 0x20000
    v_min_u32 v228, 12, v2
    v_lshlrev_b32 v228, 21, v228
    v_lshrrev_b32 v239, 3, v2
    v_and_b32 v23, 7, v2
    v_bfe_u32 v26, v2, 2, 2
    v_lshl_add_u32 v26, v4, 2, v26
    v_lshlrev_b32 v241, 7, v26
    v_and_b32 v26, 3, v2
    v_lshl_add_u32 v241, v26, 3, v241
    s_mul_i32 s31, s3, 8320
    s_add_u32 s31, s31, 99840
    v_add_u32 v241, s31, v241
    v_bfe_u32 v26, v2, 4, 1
    s_cmp_ge_u32 s2, 112
    s_cbranch_scc1 F_prB
    s_mov_b32 s20, s40
    s_mov_b32 s21, s41
    s_mov_b32 s22, 1835008
    s_mov_b32 s23, 0x20000
    s_mov_b32 s64, s42
    s_mov_b32 s65, s43
    s_mov_b32 s66, 1835008
    s_mov_b32 s67, 0x20000
    v_mul_u32_u24 v239, 3584, v239
    v_lshl_add_u32 v239, v23, 4, v239
    v_mov_b32 v240, v239
    v_mul_u32_u24 v244, 3584, v3
    v_lshl_add_u32 v241, v26, 10, v241
    v_add_u32 v243, 32, v241
    s_lshr_b32 s32, s2, 2
    s_and_b32 s33, s2, 3
    s_lshl_b32 s34, s33, 2
    s_add_u32 s34, s34, s3
    s_mul_i32 s96, s34, 114688
    s_lshl_b32 s35, s32, 7
    s_add_u32 s96, s96, s35
    s_mov_b32 s97, 28672
    s_lshl_b32 s98, s32, 17
    s_lshl_b32 s35, s34, 11
    s_add_u32 s98, s98, s35
    s_add_u32 s98, s98, 18874368
    s_mov_b32 s99, 1835008
    s_mov_b32 s100, 65536
    s_mov_b32 s101, 32768
    s_and_b32 s34, s3, 1
    s_lshl_b32 s34, s34, 1
    s_lshr_b32 s35, s3, 1
    s_add_u32 s34, s34, s35
    s_lshl_b32 s35, s32, 2
    s_add_u32 s34, s34, s35
    s_lshl_b32 s45, s34, 10
    s_lshr_b32 s35, s33, 1
    s_lshl_b32 s35, s35, 9
    s_add_u32 s45, s45, s35
    s_and_b32 s35, s33, 1
    s_lshl_b32 s35, s35, 3
    s_add_u32 s45, s45, s35
    s_add_u32 s45, s45, 22544384
    s_lshl_b32 s34, s32, 2
    s_add_u32 s35, s34, 3
    s_mul_i32 s34, s34, 147
    s_lshr_b32 s34, s34, 10
    s_mul_i32 s35, s35, 147
    s_lshr_b32 s35, s35, 10
    s_mul_i32 s68, s34, 7
    s_lshr_b32 s68, s68, 2
    s_sub_u32 s68, s32, s68
    s_lshl_b32 s68, s68, 2
    s_add_u32 s68, s68, s33
    s_lshl_b32 s68, s68, 4
    s_mul_i32 s34, s34, 256
    s_add_u32 s68, s68, s34
    s_add_u32 s68, s68, 25710592
    s_mul_i32 s69, s35, 7
    s_lshr_b32 s69, s69, 2
    s_sub_u32 s69, s32, s69
    s_lshl_b32 s69, s69, 2
    s_add_u32 s69, s69, s33
    s_lshl_b32 s69, s69, 4
    s_mul_i32 s35, s35, 256
    s_add_u32 s69, s69, s35
    s_add_u32 s69, s69, 25710592
    s_branch F_prE
F_prB:
    s_cmp_ge_u32 s2, 224
    s_cselect_b32 s20, s36, s44
    s_cselect_b32 s21, s37, s45
    s_cselect_b32 s64, s36, s44
    s_cselect_b32 s65, s37, s45
    s_mov_b32 s22, 1835008
    s_mov_b32 s32, 112
    s_mov_b32 s100, 114688
    s_mov_b32 s34, 23068672
    s_cmov_b32 s22, 524288
    s_cmov_b32 s32, 224
    s_cmov_b32 s100, 32768
    s_cmov_b32 s34, 17825792
    s_cselect_b32 s68, 14, 0
    s_mov_b32 s23, 0x20000
    s_mov_b32 s66, s22
    s_mov_b32 s67, 0x20000
    s_sub_u32 s32, s2, s32
    s_and_b32 s35, s32, 7
    s_lshr_b32 s32, s32, 3
    s_add_u32 s68, s68, s32
    s_lshl_b32 s68, s68, 4
    s_mul_i32 s69, s35, 512
    s_add_u32 s68, s68, s69
    s_add_u32 s68, s68, 25706496
    s_mov_b32 s69, s68
    s_lshl_b32 s32, s32, 2
    s_add_u32 s32, s32, s3
    s_lshl_b32 s96, s32, 15
    s_lshl_b32 s33, s35, 7
    s_add_u32 s96, s96, s33
    s_mov_b32 s97, 8192
    s_mul_i32 s98, s35, s100
    s_lshl_b32 s98, s98, 1
    s_lshl_b32 s33, s32, 11
    s_add_u32 s98, s98, s33
    s_add_u32 s98, s98, s34
    s_mov_b32 s99, 0
    s_mov_b32 s101, 1024
    s_mov_b32 s45, 0
    v_lshlrev_b32 v239, 10, v239
    v_lshl_add_u32 v239, v23, 4, v239
    v_add_u32 v240, 16384, v239
    v_lshlrev_b32 v244, 10, v3
    v_lshl_add_u32 v241, v26, 5, v241
    v_add_u32 v243, 1024, v241
F_prE:
    s_mov_b32 s44, s31
    v_lshlrev_b32 v245, 4, v3
    v_add_u32 v242, 133120, v245
    v_mov_b32 v134, 0
    v_mov_b32 v135, 0
    v_lshlrev_b32 v27, 4, v3
    v_add_u32 v27, 143360, v27
    s_lshl_b32 s35, s3, 2
    v_add_u32 v28, s35, v27
    v_lshlrev_b32 v29, 2, v3
    v_add_u32 v29, s59, v29
    v_lshlrev_b32 v30, 4, v4
    v_add_u32 v30, s59, v30
    v_cmp_eq_u32 s[76:77], 0, v4
    s_add_u32 s35, s3, 144896
    v_mov_b32 v224, s35
    v_mov_b32 v225, 144896
    v_mov_b32 v227, 1
    v_lshl_add_u32 v226, v2, 2, v225
    s_mov_b32 s74, 0x01010101
    ds_write_b32 v226, v134
    v_and_b32 v31, 15, v2
    v_lshl_add_u32 v31, v4, 4, v31
    v_lshlrev_b32 v31, 5, v31
    v_bfe_u32 v23, v2, 4, 1
    v_lshl_add_u32 v31, v23, 17, v31
    s_lshl_b32 s46, s55, 7
    s_add_u32 s46, s46, s56
    s_lshl_b32 s47, s46, 10
    s_add_u32 s48, s47, 65536
    s_lshl_b32 s49, s46, 11
    s_add_u32 s49, s49, 2097152
    s_add_u32 s50, s49, 131072
    s_mul_i32 s83, s55, 256
    s_lshl_b32 s31, s54, 4
    s_add_u32 s83, s83, s31
    s_add_u32 s83, s83, 25714688
    v_mov_b32 v26, 0
    v_and_b32 v229, 15, v2
    v_lshlrev_b32 v229, 7, v229
    v_bfe_u32 v23, v2, 4, 1
    v_lshl_add_u32 v229, v23, 17, v229
    v_add_u32 v229, s49, v229
    v_and_b32 v230, 7, v2
    v_lshlrev_b32 v230, 7, v230
    v_bfe_u32 v23, v2, 3, 1
    v_lshl_add_u32 v230, v23, 16, v230
    v_add_u32 v230, s47, v230
    s_cmp_lt_u32 s56, 24
    s_cselect_b64 s[78:79], s[76:77], 0
    v_mov_b32 v23, 0x7fffff00
    v_cmp_lt_u32 vcc, 47, v2
    s_nop 1
    v_cndmask_b32 v230, v23, v230, vcc
    v_cndmask_b32 v229, v230, v229, s[78:79]
    s_add_u32 m0, s60, 12288
    s_nop 0
    buffer_load_dwordx4 v20, s[16:19], s58 offen offset:0 lds
    buffer_load_dwordx4 v21, s[16:19], s58 offen offset:1024 lds
    buffer_load_dwordx4 v22, s[16:19], s58 offen offset:2048 lds
    s_add_u32 s58, s58, 196608
    s_sub_u32 s31, s58, 1572864
    s_min_u32 s58, s58, s31
    s_add_u32 m0, s59, 4096
    s_nop 0
    buffer_load_dwordx4 v16, s[8:11], s57 offen offset:0 lds
    buffer_load_dwordx4 v17, s[8:11], s57 offen offset:1024 lds
    buffer_load_dwordx4 v18, s[8:11], s57 offen offset:2048 lds
    buffer_load_dwordx4 v19, s[8:11], s57 offen offset:3072 lds
    s_add_u32 s57, s57, 128
    s_bitset0_b32 s57, 10
    s_cmp_lg_u32 s2, 0
    s_cbranch_scc1 F_noz
    v_mov_b32 v232, 0
    v_mov_b32 v233, 0
    v_mov_b32 v234, 0
    v_mov_b32 v235, 0
    s_mul_i32 s31, s3, 8192
    s_add_u32 s31, s31, 25690112
    buffer_store_dwordx4 v[232:235], v1, s[4:7], s31 offen sc1
    s_add_u32 s31, s31, 1024
    buffer_store_dwordx4 v[232:235], v1, s[4:7], s31 offen sc1
    s_add_u32 s31, s31, 1024
    buffer_store_dwordx4 v[232:235], v1, s[4:7], s31 offen sc1
    s_add_u32 s31, s31, 1024
    buffer_store_dwordx4 v[232:235], v1, s[4:7], s31 offen sc1
    s_add_u32 s31, s31, 1024
    buffer_store_dwordx4 v[232:235], v1, s[4:7], s31 offen sc1
    s_add_u32 s31, s31, 1024
    buffer_store_dwordx4 v[232:235], v1, s[4:7], s31 offen sc1
    s_add_u32 s31, s31, 1024
    buffer_store_dwordx4 v[232:235], v1, s[4:7], s31 offen sc1
    s_add_u32 s31, s31, 1024
    buffer_store_dwordx4 v[232:235], v1, s[4:7], s31 offen sc1
    s_add_u32 s31, s31, 1024
    s_nop 1
F_noz:
    s_waitcnt vmcnt(7) lgkmcnt(0)
    s_barrier
    ds_read_b128 v[80:83], v8 offset:0
    ds_read_b64_tr_b16 v[96:97], v12 offset:0
    ds_read_b64_tr_b16 v[98:99], v12 offset:768
    ds_read_b64_tr_b16 v[100:101], v12 offset:64
    ds_read_b64_tr_b16 v[102:103], v12 offset:832
    ds_read_b64_tr_b16 v[104:105], v12 offset:128
    ds_read_b64_tr_b16 v[106:107], v12 offset:896
    ds_read_b128 v[84:87], v9 offset:0
    ds_read_b64_tr_b16 v[108:109], v13 offset:0
    ds_read_b64_tr_b16 v[110:111], v13 offset:768
    ds_read_b64_tr_b16 v[112:113], v13 offset:64
    ds_read_b64_tr_b16 v[114:115], v13 offset:832
    ds_read_b64_tr_b16 v[116:117], v13 offset:128
    ds_read_b64_tr_b16 v[118:119], v13 offset:896
    s_waitcnt lgkmcnt(7)
    v_mfma_f32_32x32x16_bf16 v[48:63], v[100:103], v[80:83], 0
    ds_read_b128 v[88:91], v10 offset:0
    ds_read_b64_tr_b16 v[120:121], v14 offset:0
    ds_read_b64_tr_b16 v[122:123], v14 offset:768
    ds_read_b64_tr_b16 v[124:125], v14 offset:64
    ds_read_b64_tr_b16 v[126:127], v14 offset:832
    ds_read_b64_tr_b16 v[128:129], v14 offset:128
    ds_read_b64_tr_b16 v[130:131], v14 offset:896
    s_waitcnt vmcnt(4)
    ds_write_b8 v224, v227 offset:4
    v_mfma_f32_16x16x32_bf16 v[204:207], v[200:203], v[80:83], 0
    v_lshlrev_b32 v220, 16, v80
    v_and_b32 v221, s75, v80
    v_mfma_f32_16x16x32_bf16 v[208:211], v[200:203], v[96:99], 0
    v_fmac_f32 v134, v220, v220
    v_fmac_f32 v135, v221, v221
    v_mfma_f32_16x16x32_bf16 v[212:215], v[200:203], v[100:103], 0
    v_lshlrev_b32 v222, 16, v81
    v_and_b32 v223, s75, v81
    v_mfma_f32_16x16x32_bf16 v[216:219], v[200:203], v[104:107], 0
    v_fmac_f32 v134, v222, v222
    v_fmac_f32 v135, v223, v223
    v_mfma_f32_32x32x16_bf16 v[64:79], v[80:83], v[104:107], 0
    s_add_u32 m0, s60, 24576
    s_nop 0
    buffer_load_dwordx4 v20, s[16:19], s58 offen offset:0 lds
    buffer_load_dwordx4 v21, s[16:19], s58 offen offset:1024 lds
    buffer_load_dwordx4 v22, s[16:19], s58 offen offset:2048 lds
    s_add_u32 s58, s58, 196608
    s_sub_u32 s31, s58, 1572864
    s_min_u32 s58, s58, s31
    v_lshlrev_b32 v220, 16, v82
    v_and_b32 v221, s75, v82
    v_fmac_f32 v134, v220, v220
    v_fmac_f32 v135, v221, v221
    v_mfma_f32_32x32x16_bf16 v[32:47], v[96:99], v[80:83], 0
    v_lshlrev_b32 v222, 16, v83
    v_and_b32 v223, s75, v83
    v_fmac_f32 v134, v222, v222
    v_fmac_f32 v135, v223, v223
    s_waitcnt lgkmcnt(8)
    v_mfma_f32_32x32x16_bf16 v[48:63], v[112:115], v[84:87], v[48:63]
    ds_read_b32 v226, v225 offset:4
    ds_read_b128 v[92:95], v11 offset:0
    ds_read_b64_tr_b16 v[96:97], v15 offset:0
    ds_read_b64_tr_b16 v[98:99], v15 offset:768
    ds_read_b64_tr_b16 v[100:101], v15 offset:64
    ds_read_b64_tr_b16 v[102:103], v15 offset:832
    ds_read_b64_tr_b16 v[104:105], v15 offset:128
    ds_read_b64_tr_b16 v[106:107], v15 offset:896
    v_mfma_f32_16x16x32_bf16 v[204:207], v[200:203], v[84:87], v[204:207]
    v_lshlrev_b32 v220, 16, v84
    v_and_b32 v221, s75, v84
    v_fmac_f32 v134, v220, v220
    v_fmac_f32 v135, v221, v221
    v_mfma_f32_32x32x16_bf16 v[64:79], v[84:87], v[116:119], v[64:79]
    s_add_u32 m0, s59, 8192
    s_nop 0
    buffer_load_dwordx4 v16, s[8:11], s57 offen offset:0 lds
    buffer_load_dwordx4 v17, s[8:11], s57 offen offset:1024 lds
    buffer_load_dwordx4 v18, s[8:11], s57 offen offset:2048 lds
    buffer_load_dwordx4 v19, s[8:11], s57 offen offset:3072 lds
    s_add_u32 s57, s57, 128
    s_bitset0_b32 s57, 10
    v_lshlrev_b32 v222, 16, v85
    v_and_b32 v223, s75, v85
    v_fmac_f32 v134, v222, v222
    v_fmac_f32 v135, v223, v223
    v_lshlrev_b32 v220, 16, v86
    v_and_b32 v221, s75, v86
    v_mfma_f32_32x32x16_bf16 v[32:47], v[108:111], v[84:87], v[32:47]
    v_fmac_f32 v134, v220, v220
    v_fmac_f32 v135, v221, v221
    v_lshlrev_b32 v222, 16, v87
    v_and_b32 v223, s75, v87
    v_fmac_f32 v134, v222, v222
    v_fmac_f32 v135, v223, v223
    s_waitcnt lgkmcnt(7)
    v_mfma_f32_32x32x16_bf16 v[48:63], v[124:127], v[88:91], v[48:63]
    v_cmp_ne_u32 vcc, s74, v226
    s_cbranch_vccnz F_ls1
F_lb1:
    s_waitcnt vmcnt(7)
    ds_read_b128 v[80:83], v8 offset:4096
    ds_read_b64_tr_b16 v[108:109], v12 offset:12288
    ds_read_b64_tr_b16 v[110:111], v12 offset:13056
    ds_read_b64_tr_b16 v[112:113], v12 offset:12352
    ds_read_b64_tr_b16 v[114:115], v12 offset:13120
    ds_read_b64_tr_b16 v[116:117], v12 offset:12416
    ds_read_b64_tr_b16 v[118:119], v12 offset:13184
    v_mfma_f32_16x16x32_bf16 v[204:207], v[200:203], v[88:91], v[204:207]
    v_lshlrev_b32 v220, 16, v88
    v_and_b32 v221, s75, v88
    v_fmac_f32 v134, v220, v220
    v_fmac_f32 v135, v221, v221
    v_mfma_f32_32x32x16_bf16 v[64:79], v[88:91], v[128:131], v[64:79]
    v_lshlrev_b32 v222, 16, v89
    v_and_b32 v223, s75, v89
    v_fmac_f32 v134, v222, v222
    v_fmac_f32 v135, v223, v223
    v_lshlrev_b32 v220, 16, v90
    v_and_b32 v221, s75, v90
    v_mfma_f32_32x32x16_bf16 v[32:47], v[120:123], v[88:91], v[32:47]
    v_fmac_f32 v134, v220, v220
    v_fmac_f32 v135, v221, v221
    v_lshlrev_b32 v222, 16, v91
    v_and_b32 v223, s75, v91
    v_fmac_f32 v134, v222, v222
    v_fmac_f32 v135, v223, v223
    s_waitcnt lgkmcnt(7)
    v_mfma_f32_32x32x16_bf16 v[48:63], v[100:103], v[92:95], v[48:63]
    ds_read_b128 v[84:87], v9 offset:4096
    ds_read_b64_tr_b16 v[120:121], v13 offset:12288
    ds_read_b64_tr_b16 v[122:123], v13 offset:13056
    ds_read_b64_tr_b16 v[124:125], v13 offset:12352
    ds_read_b64_tr_b16 v[126:127], v13 offset:13120
    ds_read_b64_tr_b16 v[128:129], v13 offset:12416
    ds_read_b64_tr_b16 v[130:131], v13 offset:13184
    v_mfma_f32_16x16x32_bf16 v[204:207], v[200:203], v[92:95], v[204:207]
    v_lshlrev_b32 v220, 16, v92
    v_and_b32 v221, s75, v92
    v_fmac_f32 v134, v220, v220
    v_fmac_f32 v135, v221, v221
    v_mfma_f32_32x32x16_bf16 v[64:79], v[92:95], v[104:107], v[64:79]
    s_add_u32 m0, s60, 36864
    s_nop 0
    buffer_load_dwordx4 v20, s[16:19], s58 offen offset:0 lds
    buffer_load_dwordx4 v21, s[16:19], s58 offen offset:1024 lds
    buffer_load_dwordx4 v22, s[16:19], s58 offen offset:2048 lds
    s_add_u32 s58, s58, 196608
    s_sub_u32 s31, s58, 1572864
    s_min_u32 s58, s58, s31
    v_lshlrev_b32 v222, 16, v93
    v_and_b32 v223, s75, v93
    v_fmac_f32 v134, v222, v222
    v_fmac_f32 v135, v223, v223
    v_lshlrev_b32 v220, 16, v94
    v_and_b32 v221, s75, v94
    v_mfma_f32_32x32x16_bf16 v[32:47], v[96:99], v[92:95], v[32:47]
    v_fmac_f32 v134, v220, v220
    v_fmac_f32 v135, v221, v221
    v_lshlrev_b32 v222, 16, v95
    v_and_b32 v223, s75, v95
    v_fmac_f32 v134, v222, v222
    v_fmac_f32 v135, v223, v223
    s_waitcnt lgkmcnt(7)
    v_mfma_f32_32x32x16_bf16 v[48:63], v[112:115], v[80:83], v[48:63]
    ds_read_b128 v[88:91], v10 offset:4096
    ds_read_b64_tr_b16 v[96:97], v14 offset:12288
    ds_read_b64_tr_b16 v[98:99], v14 offset:13056
    ds_read_b64_tr_b16 v[100:101], v14 offset:12352
    ds_read_b64_tr_b16 v[102:103], v14 offset:13120
    ds_read_b64_tr_b16 v[104:105], v14 offset:12416
    ds_read_b64_tr_b16 v[106:107], v14 offset:13184
    s_waitcnt vmcnt(7)
    ds_write_b8 v224, v227 offset:8
    v_mfma_f32_16x16x32_bf16 v[204:207], v[200:203], v[80:83], v[204:207]
    v_lshlrev_b32 v220, 16, v80
    v_and_b32 v221, s75, v80
    v_mfma_f32_16x16x32_bf16 v[208:211], v[200:203], v[108:111], v[208:211]
    v_fmac_f32 v134, v220, v220
    v_fmac_f32 v135, v221, v221
    v_mfma_f32_16x16x32_bf16 v[212:215], v[200:203], v[112:115], v[212:215]
    v_lshlrev_b32 v222, 16, v81
    v_and_b32 v223, s75, v81
    v_mfma_f32_16x16x32_bf16 v[216:219], v[200:203], v[116:119], v[216:219]
    v_fmac_f32 v134, v222, v222
    v_fmac_f32 v135, v223, v223
    v_mfma_f32_32x32x16_bf16 v[64:79], v[80:83], v[116:119], v[64:79]
    s_add_u32 m0, s59, 12288
    s_nop 0
    buffer_load_dwordx4 v16, s[8:11], s57 offen offset:0 lds
    buffer_load_dwordx4 v17, s[8:11], s57 offen offset:1024 lds
    buffer_load_dwordx4 v18, s[8:11], s57 offen offset:2048 lds
    buffer_load_dwordx4 v19, s[8:11], s57 offen offset:3072 lds
    s_add_u32 s57, s57, 128
    s_bitset0_b32 s57, 10
    v_lshlrev_b32 v220, 16, v82
    v_and_b32 v221, s75, v82
    v_fmac_f32 v134, v220, v220
    v_fmac_f32 v135, v221, v221
    v_mfma_f32_32x32x16_bf16 v[32:47], v[108:111], v[80:83], v[32:47]
    v_lshlrev_b32 v222, 16, v83
    v_and_b32 v223, s75, v83
    v_fmac_f32 v134, v222, v222
    v_fmac_f32 v135, v223, v223
    s_waitcnt lgkmcnt(8)
    v_mfma_f32_32x32x16_bf16 v[48:63], v[124:127], v[84:87], v[48:63]
    ds_read_b32 v226, v225 offset:8
    ds_read_b128 v[92:95], v11 offset:4096
    ds_read_b64_tr_b16 v[108:109], v15 offset:12288
    ds_read_b64_tr_b16 v[110:111], v15 offset:13056
    ds_read_b64_tr_b16 v[112:113], v15 offset:12352
    ds_read_b64_tr_b16 v[114:115], v15 offset:13120
    ds_read_b64_tr_b16 v[116:117], v15 offset:12416
    ds_read_b64_tr_b16 v[118:119], v15 offset:13184
    v_mfma_f32_16x16x32_bf16 v[204:207], v[200:203], v[84:87], v[204:207]
    v_lshlrev_b32 v220, 16, v84
    v_and_b32 v221, s75, v84
    v_fmac_f32 v134, v220, v220
    v_fmac_f32 v135, v221, v221
    v_mfma_f32_32x32x16_bf16 v[64:79], v[84:87], v[128:131], v[64:79]
    v_lshlrev_b32 v222, 16, v85
    v_and_b32 v223, s75, v85
    v_fmac_f32 v134, v222, v222
    v_fmac_f32 v135, v223, v223
    v_lshlrev_b32 v220, 16, v86
    v_and_b32 v221, s75, v86
    v_mfma_f32_32x32x16_bf16 v[32:47], v[120:123], v[84:87], v[32:47]
    v_fmac_f32 v134, v220, v220
    v_fmac_f32 v135, v221, v221
    v_lshlrev_b32 v222, 16, v87
    v_and_b32 v223, s75, v87
    v_fmac_f32 v134, v222, v222
    v_fmac_f32 v135, v223, v223
    s_waitcnt lgkmcnt(7)
    v_mfma_f32_32x32x16_bf16 v[48:63], v[100:103], v[88:91], v[48:63]
    v_cmp_ne_u32 vcc, s74, v226
    s_cbranch_vccnz F_ls2
F_lb2:
    s_waitcnt vmcnt(7)
    s_cmp_lg_u32 s2, 0
    s_cbranch_scc1 F_nopub
    s_cmp_lg_u32 s3, 0
    s_cbranch_scc1 F_nopub2
    v_mov_b32 v23, 0
    v_mov_b32 v24, 1
    s_mov_b64 exec, 1
    buffer_store_dword v24, v23, s[24:27], 0 offen sc1
    s_mov_b64 exec, -1
F_nopub2:
F_nopub:
    ds_read_b128 v[80:83], v8 offset:8192
    ds_read_b64_tr_b16 v[120:121], v12 offset:24576
    ds_read_b64_tr_b16 v[122:123], v12 offset:25344
    ds_read_b64_tr_b16 v[124:125], v12 offset:24640
    ds_read_b64_tr_b16 v[126:127], v12 offset:25408
    ds_read_b64_tr_b16 v[128:129], v12 offset:24704
    ds_read_b64_tr_b16 v[130:131], v12 offset:25472
    v_mfma_f32_16x16x32_bf16 v[204:207], v[200:203], v[88:91], v[204:207]
    v_lshlrev_b32 v220, 16, v88
    v_and_b32 v221, s75, v88
    v_fmac_f32 v134, v220, v220
    v_fmac_f32 v135, v221, v221
    v_mfma_f32_32x32x16_bf16 v[64:79], v[88:91], v[104:107], v[64:79]
    s_add_u32 m0, s60, 49152
    s_nop 0
    buffer_load_dwordx4 v20, s[16:19], s58 offen offset:0 lds
    buffer_load_dwordx4 v21, s[16:19], s58 offen offset:1024 lds
    buffer_load_dwordx4 v22, s[16:19], s58 offen offset:2048 lds
    s_add_u32 s58, s58, 196608
    s_sub_u32 s31, s58, 1572864
    s_min_u32 s58, s58, s31
    v_lshlrev_b32 v222, 16, v89
    v_and_b32 v223, s75, v89
    v_fmac_f32 v134, v222, v222
    v_fmac_f32 v135, v223, v223
    v_lshlrev_b32 v220, 16, v90
    v_and_b32 v221, s75, v90
    v_mfma_f32_32x32x16_bf16 v[32:47], v[96:99], v[88:91], v[32:47]
    v_fmac_f32 v134, v220, v220
    v_fmac_f32 v135, v221, v221
    v_lshlrev_b32 v222, 16, v91
    v_and_b32 v223, s75, v91
    v_fmac_f32 v134, v222, v222
    v_fmac_f32 v135, v223, v223
    s_waitcnt lgkmcnt(7)
    v_mfma_f32_32x32x16_bf16 v[48:63], v[112:115], v[92:95], v[48:63]
    ds_read_b128 v[84:87], v9 offset:8192
    ds_read_b64_tr_b16 v[96:97], v13 offset:24576
    ds_read_b64_tr_b16 v[98:99], v13 offset:25344
    ds_read_b64_tr_b16 v[100:101], v13 offset:24640
    ds_read_b64_tr_b16 v[102:103], v13 offset:25408
    ds_read_b64_tr_b16 v[104:105], v13 offset:24704
    ds_read_b64_tr_b16 v[106:107], v13 offset:25472
    v_mfma_f32_16x16x32_bf16 v[204:207], v[200:203], v[92:95], v[204:207]
    v_lshlrev_b32 v220, 16, v92
    v_and_b32 v221, s75, v92
    v_fmac_f32 v134, v220, v220
    v_fmac_f32 v135, v221, v221
    v_mfma_f32_32x32x16_bf16 v[64:79], v[92:95], v[116:119], v[64:79]
    s_add_u32 m0, s59, 16384
    s_nop 0
    buffer_load_dwordx4 v16, s[8:11], s57 offen offset:0 lds
    buffer_load_dwordx4 v17, s[8:11], s57 offen offset:1024 lds
    buffer_load_dwordx4 v18, s[8:11], s57 offen offset:2048 lds
    buffer_load_dwordx4 v19, s[8:11], s57 offen offset:3072 lds
    s_add_u32 s57, s57, 128
    s_bitset0_b32 s57, 10
    v_lshlrev_b32 v222, 16, v93
    v_and_b32 v223, s75, v93
    v_fmac_f32 v134, v222, v222
    v_fmac_f32 v135, v223, v223
    v_lshlrev_b32 v220, 16, v94
    v_and_b32 v221, s75, v94
    v_mfma_f32_32x32x16_bf16 v[32:47], v[108:111], v[92:95], v[32:47]
    v_fmac_f32 v134, v220, v220
    v_fmac_f32 v135, v221, v221
    v_lshlrev_b32 v222, 16, v95
    v_and_b32 v223, s75, v95
    v_fmac_f32 v134, v222, v222
    v_fmac_f32 v135, v223, v223
    s_waitcnt lgkmcnt(7)
    v_mfma_f32_32x32x16_bf16 v[48:63], v[124:127], v[80:83], v[48:63]
    ds_read_b128 v[88:91], v10 offset:8192
    ds_read_b64_tr_b16 v[108:109], v14 offset:24576
    ds_read_b64_tr_b16 v[110:111], v14 offset:25344
    ds_read_b64_tr_b16 v[112:113], v14 offset:24640
    ds_read_b64_tr_b16 v[114:115], v14 offset:25408
    ds_read_b64_tr_b16 v[116:117], v14 offset:24704
    ds_read_b64_tr_b16 v[118:119], v14 offset:25472
    s_waitcnt vmcnt(11)
    ds_write_b8 v224, v227 offset:12
    v_mfma_f32_16x16x32_bf16 v[204:207], v[200:203], v[80:83], v[204:207]
    v_lshlrev_b32 v220, 16, v80
    v_and_b32 v221, s75, v80
    v_mfma_f32_16x16x32_bf16 v[208:211], v[200:203], v[120:123], v[208:211]
    v_fmac_f32 v134, v220, v220
    v_fmac_f32 v135, v221, v221
    v_mfma_f32_16x16x32_bf16 v[212:215], v[200:203], v[124:127], v[212:215]
    v_lshlrev_b32 v222, 16, v81
    v_and_b32 v223, s75, v81
    v_mfma_f32_16x16x32_bf16 v[216:219], v[200:203], v[128:131], v[216:219]
    v_fmac_f32 v134, v222, v222
    v_fmac_f32 v135, v223, v223
    v_mfma_f32_32x32x16_bf16 v[64:79], v[80:83], v[128:131], v[64:79]
    v_lshlrev_b32 v220, 16, v82
    v_and_b32 v221, s75, v82
    v_fmac_f32 v134, v220, v220
    v_fmac_f32 v135, v221, v221
    v_mfma_f32_32x32x16_bf16 v[32:47], v[120:123], v[80:83], v[32:47]
    v_lshlrev_b32 v222, 16, v83
    v_and_b32 v223, s75, v83
    v_fmac_f32 v134, v222, v222
    v_fmac_f32 v135, v223, v223
    s_waitcnt lgkmcnt(8)
    v_mfma_f32_32x32x16_bf16 v[48:63], v[100:103], v[84:87], v[48:63]
    ds_read_b32 v226, v225 offset:12
    ds_read_b128 v[92:95], v11 offset:8192
    ds_read_b64_tr_b16 v[120:121], v15 offset:24576
    ds_read_b64_tr_b16 v[122:123], v15 offset:25344
    ds_read_b64_tr_b16 v[124:125], v15 offset:24640
    ds_read_b64_tr_b16 v[126:127], v15 offset:25408
    ds_read_b64_tr_b16 v[128:129], v15 offset:24704
    ds_read_b64_tr_b16 v[130:131], v15 offset:25472
    v_mfma_f32_16x16x32_bf16 v[204:207], v[200:203], v[84:87], v[204:207]
    v_lshlrev_b32 v220, 16, v84
    v_and_b32 v221, s75, v84
    v_fmac_f32 v134, v220, v220
    v_fmac_f32 v135, v221, v221
    v_mfma_f32_32x32x16_bf16 v[64:79], v[84:87], v[104:107], v[64:79]
    s_add_u32 m0, s60, 0
    s_nop 0
    buffer_load_dwordx4 v20, s[16:19], s58 offen offset:0 lds
    buffer_load_dwordx4 v21, s[16:19], s58 offen offset:1024 lds
    buffer_load_dwordx4 v22, s[16:19], s58 offen offset:2048 lds
    s_add_u32 s58, s58, 196608
    s_sub_u32 s31, s58, 1572864
    s_min_u32 s58, s58, s31
    v_lshlrev_b32 v222, 16, v85
    v_and_b32 v223, s75, v85
    v_fmac_f32 v134, v222, v222
    v_fmac_f32 v135, v223, v223
    v_lshlrev_b32 v220, 16, v86
    v_and_b32 v221, s75, v86
    v_mfma_f32_32x32x16_bf16 v[32:47], v[96:99], v[84:87], v[32:47]
    v_fmac_f32 v134, v220, v220
    v_fmac_f32 v135, v221, v221
    v_lshlrev_b32 v222, 16, v87
    v_and_b32 v223, s75, v87
    v_fmac_f32 v134, v222, v222
    v_fmac_f32 v135, v223, v223
    s_waitcnt lgkmcnt(7)
    v_mfma_f32_32x32x16_bf16 v[48:63], v[112:115], v[88:91], v[48:63]
    v_cmp_ne_u32 vcc, s74, v226
    s_cbranch_vccnz F_ls3
F_lb3:
    s_waitcnt vmcnt(10)
    ds_read_b128 v[80:83], v8 offset:12288
    ds_read_b64_tr_b16 v[96:97], v12 offset:36864
    ds_read_b64_tr_b16 v[98:99], v12 offset:37632
    ds_read_b64_tr_b16 v[100:101], v12 offset:36928
    ds_read_b64_tr_b16 v[102:103], v12 offset:37696
    ds_read_b64_tr_b16 v[104:105], v12 offset:36992
    ds_read_b64_tr_b16 v[106:107], v12 offset:37760
    v_mfma_f32_16x16x32_bf16 v[204:207], v[200:203], v[88:91], v[204:207]
    v_lshlrev_b32 v220, 16, v88
    v_and_b32 v221, s75, v88
    v_fmac_f32 v134, v220, v220
    v_fmac_f32 v135, v221, v221
    v_mfma_f32_32x32x16_bf16 v[64:79], v[88:91], v[116:119], v[64:79]
    s_add_u32 m0, s59, 0
    s_nop 0
    buffer_load_dwordx4 v16, s[8:11], s57 offen offset:0 lds
    buffer_load_dwordx4 v17, s[8:11], s57 offen offset:1024 lds
    buffer_load_dwordx4 v18, s[8:11], s57 offen offset:2048 lds
    buffer_load_dwordx4 v19, s[8:11], s57 offen offset:3072 lds
    s_add_u32 s57, s57, 128
    s_bitset0_b32 s57, 10
    v_lshlrev_b32 v222, 16, v89
    v_and_b32 v223, s75, v89
    v_fmac_f32 v134, v222, v222
    v_fmac_f32 v135, v223, v223
    v_lshlrev_b32 v220, 16, v90
    v_and_b32 v221, s75, v90
    v_mfma_f32_32x32x16_bf16 v[32:47], v[108:111], v[88:91], v[32:47]
    v_fmac_f32 v134, v220, v220
    v_fmac_f32 v135, v221, v221
    v_lshlrev_b32 v222, 16, v91
    v_and_b32 v223, s75, v91
    v_fmac_f32 v134, v222, v222
    v_fmac_f32 v135, v223, v223
    s_waitcnt lgkmcnt(7)
    v_mfma_f32_32x32x16_bf16 v[48:63], v[124:127], v[92:95], v[48:63]
    ds_read_b128 v[84:87], v9 offset:12288
    ds_read_b64_tr_b16 v[108:109], v13 offset:36864
    ds_read_b64_tr_b16 v[110:111], v13 offset:37632
    ds_read_b64_tr_b16 v[112:113], v13 offset:36928
    ds_read_b64_tr_b16 v[114:115], v13 offset:37696
    ds_read_b64_tr_b16 v[116:117], v13 offset:36992
    ds_read_b64_tr_b16 v[118:119], v13 offset:37760
    v_mfma_f32_16x16x32_bf16 v[204:207], v[200:203], v[92:95], v[204:207]
    v_lshlrev_b32 v220, 16, v92
    v_and_b32 v221, s75, v92
    v_fmac_f32 v134, v220, v220
    v_fmac_f32 v135, v221, v221
    v_mfma_f32_32x32x16_bf16 v[64:79], v[92:95], v[128:131], v[64:79]
    v_lshlrev_b32 v222, 16, v93
    v_and_b32 v223, s75, v93
    v_fmac_f32 v134, v222, v222
    v_fmac_f32 v135, v223, v223
    v_lshlrev_b32 v220, 16, v94
    v_and_b32 v221, s75, v94
    v_mfma_f32_32x32x16_bf16 v[32:47], v[120:123], v[92:95], v[32:47]
    v_fmac_f32 v134, v220, v220
    v_fmac_f32 v135, v221, v221
    v_lshlrev_b32 v222, 16, v95
    v_and_b32 v223, s75, v95
    v_fmac_f32 v134, v222, v222
    v_fmac_f32 v135, v223, v223
    s_waitcnt lgkmcnt(7)
    v_mfma_f32_32x32x16_bf16 v[48:63], v[100:103], v[80:83], v[48:63]
    ds_read_b128 v[88:91], v10 offset:12288
    ds_read_b64_tr_b16 v[120:121], v14 offset:36864
    ds_read_b64_tr_b16 v[122:123], v14 offset:37632
    ds_read_b64_tr_b16 v[124:125], v14 offset:36928
    ds_read_b64_tr_b16 v[126:127], v14 offset:37696
    ds_read_b64_tr_b16 v[128:129], v14 offset:36992
    ds_read_b64_tr_b16 v[130:131], v14 offset:37760
    s_waitcnt vmcnt(11)
    ds_write_b8 v224, v227 offset:16
    v_mfma_f32_16x16x32_bf16 v[204:207], v[200:203], v[80:83], v[204:207]
    v_lshlrev_b32 v220, 16, v80
    v_and_b32 v221, s75, v80
    v_mfma_f32_16x16x32_bf16 v[208:211], v[200:203], v[96:99], v[208:211]
    v_fmac_f32 v134, v220, v220
    v_fmac_f32 v135, v221, v221
    v_mfma_f32_16x16x32_bf16 v[212:215], v[200:203], v[100:103], v[212:215]
    v_lshlrev_b32 v222, 16, v81
    v_and_b32 v223, s75, v81
    v_mfma_f32_16x16x32_bf16 v[216:219], v[200:203], v[104:107], v[216:219]
    v_fmac_f32 v134, v222, v222
    v_fmac_f32 v135, v223, v223
    v_mfma_f32_32x32x16_bf16 v[64:79], v[80:83], v[104:107], v[64:79]
    s_add_u32 m0, s60, 12288
    s_nop 0
    buffer_load_dwordx4 v20, s[16:19], s58 offen offset:0 lds
    buffer_load_dwordx4 v21, s[16:19], s58 offen offset:1024 lds
    buffer_load_dwordx4 v22, s[16:19], s58 offen offset:2048 lds
    s_add_u32 s58, s58, 196608
    s_sub_u32 s31, s58, 1572864
    s_min_u32 s58, s58, s31
    v_lshlrev_b32 v220, 16, v82
    v_and_b32 v221, s75, v82
    v_fmac_f32 v134, v220, v220
    v_fmac_f32 v135, v221, v221
    v_mfma_f32_32x32x16_bf16 v[32:47], v[96:99], v[80:83], v[32:47]
    v_lshlrev_b32 v222, 16, v83
    v_and_b32 v223, s75, v83
    v_fmac_f32 v134, v222, v222
    v_fmac_f32 v135, v223, v223
    s_waitcnt lgkmcnt(8)
    v_mfma_f32_32x32x16_bf16 v[48:63], v[112:115], v[84:87], v[48:63]
    ds_read_b32 v226, v225 offset:16
    ds_read_b128 v[92:95], v11 offset:12288
    ds_read_b64_tr_b16 v[96:97], v15 offset:36864
    ds_read_b64_tr_b16 v[98:99], v15 offset:37632
    ds_read_b64_tr_b16 v[100:101], v15 offset:36928
    ds_read_b64_tr_b16 v[102:103], v15 offset:37696
    ds_read_b64_tr_b16 v[104:105], v15 offset:36992
    ds_read_b64_tr_b16 v[106:107], v15 offset:37760
    v_mfma_f32_16x16x32_bf16 v[204:207], v[200:203], v[84:87], v[204:207]
    v_lshlrev_b32 v220, 16, v84
    v_and_b32 v221, s75, v84
    v_fmac_f32 v134, v220, v220
    v_fmac_f32 v135, v221, v221
    v_mfma_f32_32x32x16_bf16 v[64:79], v[84:87], v[116:119], v[64:79]
    s_add_u32 m0, s59, 4096
    s_nop 0
    buffer_load_dwordx4 v16, s[8:11], s57 offen offset:0 lds
    buffer_load_dwordx4 v17, s[8:11], s57 offen offset:1024 lds
    buffer_load_dwordx4 v18, s[8:11], s57 offen offset:2048 lds
    buffer_load_dwordx4 v19, s[8:11], s57 offen offset:3072 lds
    s_add_u32 s57, s57, 128
    s_bitset0_b32 s57, 10
    v_lshlrev_b32 v222, 16, v85
    v_and_b32 v223, s75, v85
    v_fmac_f32 v134, v222, v222
    v_fmac_f32 v135, v223, v223
    v_lshlrev_b32 v220, 16, v86
    v_and_b32 v221, s75, v86
    v_mfma_f32_32x32x16_bf16 v[32:47], v[108:111], v[84:87], v[32:47]
    v_fmac_f32 v134, v220, v220
    v_fmac_f32 v135, v221, v221
    v_lshlrev_b32 v222, 16, v87
    v_and_b32 v223, s75, v87
    v_fmac_f32 v134, v222, v222
    v_fmac_f32 v135, v223, v223
    s_waitcnt lgkmcnt(7)
    v_mfma_f32_32x32x16_bf16 v[48:63], v[124:127], v[88:91], v[48:63]
    v_cmp_ne_u32 vcc, s74, v226
    s_cbranch_vccnz F_ls4
F_lb4:
    s_waitcnt vmcnt(14)
    ds_read_b128 v[80:83], v8 offset:16384
    ds_read_b64_tr_b16 v[108:109], v12 offset:49152
    ds_read_b64_tr_b16 v[110:111], v12 offset:49920
    ds_read_b64_tr_b16 v[112:113], v12 offset:49216
    ds_read_b64_tr_b16 v[114:115], v12 offset:49984
    ds_read_b64_tr_b16 v[116:117], v12 offset:49280
    ds_read_b64_tr_b16 v[118:119], v12 offset:50048
    v_mfma_f32_16x16x32_bf16 v[204:207], v[200:203], v[88:91], v[204:207]
    v_lshlrev_b32 v220, 16, v88
    v_and_b32 v221, s75, v88
    v_fmac_f32 v134, v220, v220
    v_fmac_f32 v135, v221, v221
    v_mfma_f32_32x32x16_bf16 v[64:79], v[88:91], v[128:131], v[64:79]
    v_lshlrev_b32 v222, 16, v89
    v_and_b32 v223, s75, v89
    v_fmac_f32 v134, v222, v222
    v_fmac_f32 v135, v223, v223
    v_lshlrev_b32 v220, 16, v90
    v_and_b32 v221, s75, v90
    v_mfma_f32_32x32x16_bf16 v[32:47], v[120:123], v[88:91], v[32:47]
    v_fmac_f32 v134, v220, v220
    v_fmac_f32 v135, v221, v221
    v_lshlrev_b32 v222, 16, v91
    v_and_b32 v223, s75, v91
    v_fmac_f32 v134, v222, v222
    v_fmac_f32 v135, v223, v223
    s_waitcnt lgkmcnt(7)
    v_mfma_f32_32x32x16_bf16 v[48:63], v[100:103], v[92:95], v[48:63]
    ds_read_b128 v[84:87], v9 offset:16384
    ds_read_b64_tr_b16 v[120:121], v13 offset:49152
    ds_read_b64_tr_b16 v[122:123], v13 offset:49920
    ds_read_b64_tr_b16 v[124:125], v13 offset:49216
    ds_read_b64_tr_b16 v[126:127], v13 offset:49984
    ds_read_b64_tr_b16 v[128:129], v13 offset:49280
    ds_read_b64_tr_b16 v[130:131], v13 offset:50048
    v_mfma_f32_16x16x32_bf16 v[204:207], v[200:203], v[92:95], v[204:207]
    v_lshlrev_b32 v220, 16, v92
    v_and_b32 v221, s75, v92
    v_fmac_f32 v134, v220, v220
    v_fmac_f32 v135, v221, v221
    v_mfma_f32_32x32x16_bf16 v[64:79], v[92:95], v[104:107], v[64:79]
    s_add_u32 m0, s60, 24576
    s_nop 0
    buffer_load_dwordx4 v20, s[16:19], s58 offen offset:0 lds
    buffer_load_dwordx4 v21, s[16:19], s58 offen offset:1024 lds
    buffer_load_dwordx4 v22, s[16:19], s58 offen offset:2048 lds
    v_lshlrev_b32 v222, 16, v93
    v_and_b32 v223, s75, v93
    v_fmac_f32 v134, v222, v222
    v_fmac_f32 v135, v223, v223
    v_lshlrev_b32 v220, 16, v94
    v_and_b32 v221, s75, v94
    v_mfma_f32_32x32x16_bf16 v[32:47], v[96:99], v[92:95], v[32:47]
    v_fmac_f32 v134, v220, v220
    v_fmac_f32 v135, v221, v221
    v_lshlrev_b32 v222, 16, v95
    v_and_b32 v223, s75, v95
    v_fmac_f32 v134, v222, v222
    v_fmac_f32 v135, v223, v223
    s_waitcnt lgkmcnt(7)
    v_mfma_f32_32x32x16_bf16 v[48:63], v[112:115], v[80:83], v[48:63]
    ds_read_b128 v[88:91], v10 offset:16384
    ds_read_b64_tr_b16 v[96:97], v14 offset:49152
    ds_read_b64_tr_b16 v[98:99], v14 offset:49920
    ds_read_b64_tr_b16 v[100:101], v14 offset:49216
    ds_read_b64_tr_b16 v[102:103], v14 offset:49984
    ds_read_b64_tr_b16 v[104:105], v14 offset:49280
    ds_read_b64_tr_b16 v[106:107], v14 offset:50048
    s_waitcnt vmcnt(14)
    ds_write_b8 v224, v227 offset:20
    v_mfma_f32_16x16x32_bf16 v[204:207], v[200:203], v[80:83], v[204:207]
    v_lshlrev_b32 v220, 16, v80
    v_and_b32 v221, s75, v80
    v_mfma_f32_16x16x32_bf16 v[208:211], v[200:203], v[108:111], v[208:211]
    v_fmac_f32 v134, v220, v220
    v_fmac_f32 v135, v221, v221
    v_mfma_f32_16x16x32_bf16 v[212:215], v[200:203], v[112:115], v[212:215]
    v_lshlrev_b32 v222, 16, v81
    v_and_b32 v223, s75, v81
    v_mfma_f32_16x16x32_bf16 v[216:219], v[200:203], v[116:119], v[216:219]
    v_fmac_f32 v134, v222, v222
    v_fmac_f32 v135, v223, v223
    v_mfma_f32_32x32x16_bf16 v[64:79], v[80:83], v[116:119], v[64:79]
    s_add_u32 m0, s59, 8192
    s_nop 0
    buffer_load_dwordx4 v16, s[8:11], s57 offen offset:0 lds
    buffer_load_dwordx4 v17, s[8:11], s57 offen offset:1024 lds
    buffer_load_dwordx4 v18, s[8:11], s57 offen offset:2048 lds
    buffer_load_dwordx4 v19, s[8:11], s57 offen offset:3072 lds
    v_lshlrev_b32 v220, 16, v82
    v_and_b32 v221, s75, v82
    v_fmac_f32 v134, v220, v220
    v_fmac_f32 v135, v221, v221
    v_mfma_f32_32x32x16_bf16 v[32:47], v[108:111], v[80:83], v[32:47]
    v_lshlrev_b32 v222, 16, v83
    v_and_b32 v223, s75, v83
    v_fmac_f32 v134, v222, v222
    v_fmac_f32 v135, v223, v223
    s_waitcnt lgkmcnt(8)
    v_mfma_f32_32x32x16_bf16 v[48:63], v[124:127], v[84:87], v[48:63]
    ds_read_b32 v226, v225 offset:20
    ds_read_b128 v[92:95], v11 offset:16384
    ds_read_b64_tr_b16 v[108:109], v15 offset:49152
    ds_read_b64_tr_b16 v[110:111], v15 offset:49920
    ds_read_b64_tr_b16 v[112:113], v15 offset:49216
    ds_read_b64_tr_b16 v[114:115], v15 offset:49984
    ds_read_b64_tr_b16 v[116:117], v15 offset:49280
    ds_read_b64_tr_b16 v[118:119], v15 offset:50048
    v_mfma_f32_16x16x32_bf16 v[204:207], v[200:203], v[84:87], v[204:207]
    v_lshlrev_b32 v220, 16, v84
    v_and_b32 v221, s75, v84
    v_fmac_f32 v134, v220, v220
    v_fmac_f32 v135, v221, v221
    v_mfma_f32_32x32x16_bf16 v[64:79], v[84:87], v[128:131], v[64:79]
    buffer_load_dword v24, v229, s[4:7], 0 offen
    v_lshlrev_b32 v222, 16, v85
    v_and_b32 v223, s75, v85
    v_fmac_f32 v134, v222, v222
    v_fmac_f32 v135, v223, v223
    v_lshlrev_b32 v220, 16, v86
    v_and_b32 v221, s75, v86
    v_mfma_f32_32x32x16_bf16 v[32:47], v[120:123], v[84:87], v[32:47]
    v_fmac_f32 v134, v220, v220
    v_fmac_f32 v135, v221, v221
    v_lshlrev_b32 v222, 16, v87
    v_and_b32 v223, s75, v87
    v_fmac_f32 v134, v222, v222
    v_fmac_f32 v135, v223, v223
    s_waitcnt lgkmcnt(7)
    v_mfma_f32_32x32x16_bf16 v[48:63], v[100:103], v[88:91], v[48:63]
    v_cmp_ne_u32 vcc, s74, v226
    s_cbranch_vccnz F_ls5
F_lb5:
    s_waitcnt vmcnt(15)
    ds_read_b128 v[80:83], v8 offset:0
    ds_read_b64_tr_b16 v[120:121], v12 offset:0
    ds_read_b64_tr_b16 v[122:123], v12 offset:768
    ds_read_b64_tr_b16 v[124:125], v12 offset:64
    ds_read_b64_tr_b16 v[126:127], v12 offset:832
    ds_read_b64_tr_b16 v[128:129], v12 offset:128
    ds_read_b64_tr_b16 v[130:131], v12 offset:896
    v_mfma_f32_16x16x32_bf16 v[204:207], v[200:203], v[88:91], v[204:207]
    v_lshlrev_b32 v220, 16, v88
    v_and_b32 v221, s75, v88
    v_fmac_f32 v134, v220, v220
    v_fmac_f32 v135, v221, v221
    v_mfma_f32_32x32x16_bf16 v[64:79], v[88:91], v[104:107], v[64:79]
    v_lshlrev_b32 v222, 16, v89
    v_and_b32 v223, s75, v89
    v_fmac_f32 v134, v222, v222
    v_fmac_f32 v135, v223, v223
    v_lshlrev_b32 v220, 16, v90
    v_and_b32 v221, s75, v90
    v_mfma_f32_32x32x16_bf16 v[32:47], v[96:99], v[88:91], v[32:47]
    v_fmac_f32 v134, v220, v220
    v_fmac_f32 v135, v221, v221
    v_lshlrev_b32 v222, 16, v91
    v_and_b32 v223, s75, v91
    v_fmac_f32 v134, v222, v222
    v_fmac_f32 v135, v223, v223
    s_waitcnt lgkmcnt(7)
    v_mfma_f32_32x32x16_bf16 v[48:63], v[112:115], v[92:95], v[48:63]
    ds_read_b128 v[84:87], v9 offset:0
    ds_read_b64_tr_b16 v[96:97], v13 offset:0
    ds_read_b64_tr_b16 v[98:99], v13 offset:768
    ds_read_b64_tr_b16 v[100:101], v13 offset:64
    ds_read_b64_tr_b16 v[102:103], v13 offset:832
    ds_read_b64_tr_b16 v[104:105], v13 offset:128
    ds_read_b64_tr_b16 v[106:107], v13 offset:896
    v_mfma_f32_16x16x32_bf16 v[204:207], v[200:203], v[92:95], v[204:207]
    v_lshlrev_b32 v220, 16, v92
    v_and_b32 v221, s75, v92
    v_fmac_f32 v134, v220, v220
    v_fmac_f32 v135, v221, v221
    v_mfma_f32_32x32x16_bf16 v[64:79], v[92:95], v[116:119], v[64:79]
    v_lshlrev_b32 v222, 16, v93
    v_and_b32 v223, s75, v93
    v_fmac_f32 v134, v222, v222
    v_fmac_f32 v135, v223, v223
    v_lshlrev_b32 v220, 16, v94
    v_and_b32 v221, s75, v94
    v_mfma_f32_32x32x16_bf16 v[32:47], v[108:111], v[92:95], v[32:47]
    v_fmac_f32 v134, v220, v220
    v_fmac_f32 v135, v221, v221
    v_lshlrev_b32 v222, 16, v95
    v_and_b32 v223, s75, v95
    v_fmac_f32 v134, v222, v222
    v_fmac_f32 v135, v223, v223
    s_waitcnt lgkmcnt(7)
    v_mfma_f32_32x32x16_bf16 v[48:63], v[124:127], v[80:83], v[48:63]
    ds_read_b128 v[88:91], v10 offset:0
    ds_read_b64_tr_b16 v[108:109], v14 offset:0
    ds_read_b64_tr_b16 v[110:111], v14 offset:768
    ds_read_b64_tr_b16 v[112:113], v14 offset:64
    ds_read_b64_tr_b16 v[114:115], v14 offset:832
    ds_read_b64_tr_b16 v[116:117], v14 offset:128
    ds_read_b64_tr_b16 v[118:119], v14 offset:896
    s_waitcnt vmcnt(12)
    ds_write_b8 v224, v227 offset:24
    v_mfma_f32_16x16x32_bf16 v[204:207], v[200:203], v[80:83], v[204:207]
    v_lshlrev_b32 v220, 16, v80
    v_and_b32 v221, s75, v80
    v_mfma_f32_16x16x32_bf16 v[208:211], v[200:203], v[120:123], v[208:211]
    v_fmac_f32 v134, v220, v220
    v_fmac_f32 v135, v221, v221
    v_mfma_f32_16x16x32_bf16 v[212:215], v[200:203], v[124:127], v[212:215]
    v_lshlrev_b32 v222, 16, v81
    v_and_b32 v223, s75, v81
    v_mfma_f32_16x16x32_bf16 v[216:219], v[200:203], v[128:131], v[216:219]
    v_fmac_f32 v134, v222, v222
    v_fmac_f32 v135, v223, v223
    v_mfma_f32_32x32x16_bf16 v[64:79], v[80:83], v[128:131], v[64:79]
    buffer_load_dword v25, v26, s[24:27], 0 offen sc1
    v_lshlrev_b32 v220, 16, v82
    v_and_b32 v221, s75, v82
    v_fmac_f32 v134, v220, v220
    v_fmac_f32 v135, v221, v221
    v_mfma_f32_32x32x16_bf16 v[32:47], v[120:123], v[80:83], v[32:47]
    v_lshlrev_b32 v222, 16, v83
    v_and_b32 v223, s75, v83
    v_fmac_f32 v134, v222, v222
    v_fmac_f32 v135, v223, v223
    s_waitcnt lgkmcnt(8)
    v_mfma_f32_32x32x16_bf16 v[48:63], v[100:103], v[84:87], v[48:63]
    ds_read_b32 v226, v225 offset:24
    ds_read_b128 v[92:95], v11 offset:0
    ds_read_b64_tr_b16 v[120:121], v15 offset:0
    ds_read_b64_tr_b16 v[122:123], v15 offset:768
    ds_read_b64_tr_b16 v[124:125], v15 offset:64
    ds_read_b64_tr_b16 v[126:127], v15 offset:832
    ds_read_b64_tr_b16 v[128:129], v15 offset:128
    ds_read_b64_tr_b16 v[130:131], v15 offset:896
    v_mfma_f32_16x16x32_bf16 v[204:207], v[200:203], v[84:87], v[204:207]
    v_lshlrev_b32 v220, 16, v84
    v_and_b32 v221, s75, v84
    v_fmac_f32 v134, v220, v220
    v_fmac_f32 v135, v221, v221
    v_mfma_f32_32x32x16_bf16 v[64:79], v[84:87], v[104:107], v[64:79]
    v_lshlrev_b32 v222, 16, v85
    v_and_b32 v223, s75, v85
    v_fmac_f32 v134, v222, v222
    v_fmac_f32 v135, v223, v223
    v_lshlrev_b32 v220, 16, v86
    v_and_b32 v221, s75, v86
    v_mfma_f32_32x32x16_bf16 v[32:47], v[96:99], v[84:87], v[32:47]
    v_fmac_f32 v134, v220, v220
    v_fmac_f32 v135, v221, v221
    v_lshlrev_b32 v222, 16, v87
    v_and_b32 v223, s75, v87
    v_fmac_f32 v134, v222, v222
    v_fmac_f32 v135, v223, v223
    s_waitcnt lgkmcnt(7)
    v_mfma_f32_32x32x16_bf16 v[48:63], v[112:115], v[88:91], v[48:63]
    v_cmp_ne_u32 vcc, s74, v226
    s_cbranch_vccnz F_ls6
F_lb6:
    s_waitcnt vmcnt(9)
    ds_read_b128 v[80:83], v8 offset:4096
    ds_read_b64_tr_b16 v[96:97], v12 offset:12288
    ds_read_b64_tr_b16 v[98:99], v12 offset:13056
    ds_read_b64_tr_b16 v[100:101], v12 offset:12352
    ds_read_b64_tr_b16 v[102:103], v12 offset:13120
    ds_read_b64_tr_b16 v[104:105], v12 offset:12416
    ds_read_b64_tr_b16 v[106:107], v12 offset:13184
    s_waitcnt vmcnt(6)
    ds_read_b64_tr_b16 v[184:185], v12 offset:24576
    ds_read_b64_tr_b16 v[186:187], v12 offset:25344
    ds_read_b64_tr_b16 v[188:189], v12 offset:24640
    ds_read_b64_tr_b16 v[190:191], v12 offset:25408
    ds_read_b64_tr_b16 v[192:193], v12 offset:24704
    ds_read_b64_tr_b16 v[194:195], v12 offset:25472
    v_mfma_f32_16x16x32_bf16 v[204:207], v[200:203], v[88:91], v[204:207]
    v_lshlrev_b32 v220, 16, v88
    v_and_b32 v221, s75, v88
    v_fmac_f32 v134, v220, v220
    v_fmac_f32 v135, v221, v221
    v_mfma_f32_32x32x16_bf16 v[64:79], v[88:91], v[116:119], v[64:79]
    v_lshlrev_b32 v222, 16, v89
    v_and_b32 v223, s75, v89
    v_fmac_f32 v134, v222, v222
    v_fmac_f32 v135, v223, v223
    v_lshlrev_b32 v220, 16, v90
    v_and_b32 v221, s75, v90
    v_mfma_f32_32x32x16_bf16 v[32:47], v[108:111], v[88:91], v[32:47]
    v_fmac_f32 v134, v220, v220
    v_fmac_f32 v135, v221, v221
    v_lshlrev_b32 v222, 16, v91
    v_and_b32 v223, s75, v91
    v_fmac_f32 v134, v222, v222
    v_fmac_f32 v135, v223, v223
    s_waitcnt lgkmcnt(13)
    v_mfma_f32_32x32x16_bf16 v[48:63], v[124:127], v[92:95], v[48:63]
    ds_read_b128 v[84:87], v9 offset:4096
    ds_read_b64_tr_b16 v[108:109], v13 offset:12288
    ds_read_b64_tr_b16 v[110:111], v13 offset:13056
    ds_read_b64_tr_b16 v[112:113], v13 offset:12352
    ds_read_b64_tr_b16 v[114:115], v13 offset:13120
    ds_read_b64_tr_b16 v[116:117], v13 offset:12416
    ds_read_b64_tr_b16 v[118:119], v13 offset:13184
    v_mfma_f32_16x16x32_bf16 v[204:207], v[200:203], v[92:95], v[204:207]
    v_lshlrev_b32 v220, 16, v92
    v_and_b32 v221, s75, v92
    v_fmac_f32 v134, v220, v220
    v_fmac_f32 v135, v221, v221
    v_mfma_f32_32x32x16_bf16 v[64:79], v[92:95], v[128:131], v[64:79]
    v_lshlrev_b32 v222, 16, v93
    v_and_b32 v223, s75, v93
    v_fmac_f32 v134, v222, v222
    v_fmac_f32 v135, v223, v223
    v_lshlrev_b32 v220, 16, v94
    v_and_b32 v221, s75, v94
    v_mfma_f32_32x32x16_bf16 v[32:47], v[120:123], v[92:95], v[32:47]
    v_fmac_f32 v134, v220, v220
    v_fmac_f32 v135, v221, v221
    v_lshlrev_b32 v222, 16, v95
    v_and_b32 v223, s75, v95
    v_fmac_f32 v134, v222, v222
    v_fmac_f32 v135, v223, v223
    s_waitcnt lgkmcnt(7)
    v_mfma_f32_32x32x16_bf16 v[48:63], v[100:103], v[80:83], v[48:63]
    ds_read_b128 v[88:91], v10 offset:4096
    ds_read_b64_tr_b16 v[120:121], v14 offset:12288
    ds_read_b64_tr_b16 v[122:123], v14 offset:13056
    ds_read_b64_tr_b16 v[124:125], v14 offset:12352
    ds_read_b64_tr_b16 v[126:127], v14 offset:13120
    ds_read_b64_tr_b16 v[128:129], v14 offset:12416
    ds_read_b64_tr_b16 v[130:131], v14 offset:13184
    ds_write_b8 v224, v227 offset:28
    v_mfma_f32_16x16x32_bf16 v[204:207], v[200:203], v[80:83], v[204:207]
    v_lshlrev_b32 v220, 16, v80
    v_and_b32 v221, s75, v80
    v_mfma_f32_16x16x32_bf16 v[208:211], v[200:203], v[96:99], v[208:211]
    v_fmac_f32 v134, v220, v220
    v_mfma_f32_16x16x32_bf16 v[212:215], v[200:203], v[100:103], v[212:215]
    v_fmac_f32 v135, v221, v221
    v_lshlrev_b32 v222, 16, v81
    v_mfma_f32_16x16x32_bf16 v[216:219], v[200:203], v[104:107], v[216:219]
    v_and_b32 v223, s75, v81
    v_mfma_f32_16x16x32_bf16 v[208:211], v[200:203], v[184:187], v[208:211]
    v_fmac_f32 v134, v222, v222
    v_fmac_f32 v135, v223, v223
    v_mfma_f32_16x16x32_bf16 v[212:215], v[200:203], v[188:191], v[212:215]
    v_lshlrev_b32 v220, 16, v82
    v_mfma_f32_16x16x32_bf16 v[216:219], v[200:203], v[192:195], v[216:219]
    v_and_b32 v221, s75, v82
    v_fmac_f32 v134, v220, v220
    v_mfma_f32_32x32x16_bf16 v[64:79], v[80:83], v[104:107], v[64:79]
    v_fmac_f32 v135, v221, v221
    v_lshlrev_b32 v222, 16, v83
    v_and_b32 v223, s75, v83
    v_mfma_f32_32x32x16_bf16 v[32:47], v[96:99], v[80:83], v[32:47]
    v_fmac_f32 v134, v222, v222
    v_fmac_f32 v135, v223, v223
    s_waitcnt lgkmcnt(8)
    v_mfma_f32_32x32x16_bf16 v[48:63], v[112:115], v[84:87], v[48:63]
    ds_read_b32 v226, v225 offset:28
    ds_read_b128 v[92:95], v11 offset:4096
    ds_read_b64_tr_b16 v[96:97], v15 offset:12288
    ds_read_b64_tr_b16 v[98:99], v15 offset:13056
    ds_read_b64_tr_b16 v[100:101], v15 offset:12352
    ds_read_b64_tr_b16 v[102:103], v15 offset:13120
    ds_read_b64_tr_b16 v[104:105], v15 offset:12416
    ds_read_b64_tr_b16 v[106:107], v15 offset:13184
    ds_write_b32 v28, v208 offset:0
    ds_write_b32 v28, v212 offset:512
    ds_write_b32 v28, v216 offset:1024
    ds_write_b8 v224, v227 offset:32
    v_mfma_f32_16x16x32_bf16 v[204:207], v[200:203], v[84:87], v[204:207]
    v_lshlrev_b32 v220, 16, v84
    v_and_b32 v221, s75, v84
    v_fmac_f32 v134, v220, v220
    v_fmac_f32 v135, v221, v221
    v_mfma_f32_32x32x16_bf16 v[64:79], v[84:87], v[116:119], v[64:79]
    v_lshlrev_b32 v222, 16, v85
    v_and_b32 v223, s75, v85
    v_fmac_f32 v134, v222, v222
    v_fmac_f32 v135, v223, v223
    v_lshlrev_b32 v220, 16, v86
    v_and_b32 v221, s75, v86
    v_mfma_f32_32x32x16_bf16 v[32:47], v[108:111], v[84:87], v[32:47]
    v_fmac_f32 v134, v220, v220
    v_fmac_f32 v135, v221, v221
    v_lshlrev_b32 v222, 16, v87
    v_and_b32 v223, s75, v87
    v_fmac_f32 v134, v222, v222
    v_fmac_f32 v135, v223, v223
    s_waitcnt lgkmcnt(11)
    v_mfma_f32_32x32x16_bf16 v[48:63], v[124:127], v[88:91], v[48:63]
    v_cmp_ne_u32 vcc, s74, v226
    s_cbranch_vccnz F_ls7
F_lb7:
    s_waitcnt vmcnt(2)
    ds_read_b32 v226, v225 offset:32
    ds_read_b128 v[80:83], v8 offset:8192
    v_mfma_f32_16x16x32_bf16 v[204:207], v[200:203], v[88:91], v[204:207]
    v_lshlrev_b32 v220, 16, v88
    v_and_b32 v221, s75, v88
    v_fmac_f32 v134, v220, v220
    v_fmac_f32 v135, v221, v221
    v_mfma_f32_32x32x16_bf16 v[64:79], v[88:91], v[128:131], v[64:79]
    v_lshlrev_b32 v222, 16, v89
    v_and_b32 v223, s75, v89
    v_fmac_f32 v134, v222, v222
    v_fmac_f32 v135, v223, v223
    v_lshlrev_b32 v220, 16, v90
    v_and_b32 v221, s75, v90
    v_mfma_f32_32x32x16_bf16 v[32:47], v[120:123], v[88:91], v[32:47]
    v_fmac_f32 v134, v220, v220
    v_fmac_f32 v135, v221, v221
    v_lshlrev_b32 v222, 16, v91
    v_and_b32 v223, s75, v91
    v_fmac_f32 v134, v222, v222
    v_fmac_f32 v135, v223, v223
    s_waitcnt lgkmcnt(1)
    v_mfma_f32_32x32x16_bf16 v[48:63], v[100:103], v[92:95], v[48:63]
    v_cmp_ne_u32 vcc, s74, v226
    s_cbranch_vccnz F_ls8
F_lb8:
    ds_read_b128 v[140:143], v27 offset:0
    ds_read_b128 v[144:147], v27 offset:512
    ds_read_b128 v[148:151], v27 offset:1024
    ds_read_b128 v[84:87], v9 offset:8192
    ds_read_b64_tr_b16 v[120:121], v13 offset:24576
    ds_read_b64_tr_b16 v[122:123], v13 offset:25344
    ds_read_b64_tr_b16 v[124:125], v13 offset:24640
    ds_read_b64_tr_b16 v[126:127], v13 offset:25408
    ds_read_b64_tr_b16 v[128:129], v13 offset:24704
    ds_read_b64_tr_b16 v[130:131], v13 offset:25472
    v_mfma_f32_16x16x32_bf16 v[204:207], v[200:203], v[92:95], v[204:207]
    v_lshlrev_b32 v220, 16, v92
    v_and_b32 v221, s75, v92
    v_fmac_f32 v134, v220, v220
    v_fmac_f32 v135, v221, v221
    v_mfma_f32_32x32x16_bf16 v[64:79], v[92:95], v[104:107], v[64:79]
    v_lshlrev_b32 v222, 16, v93
    v_and_b32 v223, s75, v93
    v_fmac_f32 v134, v222, v222
    v_fmac_f32 v135, v223, v223
    v_lshlrev_b32 v220, 16, v94
    v_and_b32 v221, s75, v94
    v_mfma_f32_32x32x16_bf16 v[32:47], v[96:99], v[92:95], v[32:47]
    v_fmac_f32 v134, v220, v220
    v_fmac_f32 v135, v221, v221
    v_lshlrev_b32 v222, 16, v95
    v_and_b32 v223, s75, v95
    v_fmac_f32 v134, v222, v222
    v_fmac_f32 v135, v223, v223
    s_waitcnt lgkmcnt(7)
    v_mfma_f32_32x32x16_bf16 v[48:63], v[188:191], v[80:83], v[48:63]
    ds_read_b128 v[88:91], v10 offset:8192
    ds_read_b64_tr_b16 v[96:97], v14 offset:24576
    ds_read_b64_tr_b16 v[98:99], v14 offset:25344
    ds_read_b64_tr_b16 v[100:101], v14 offset:24640
    ds_read_b64_tr_b16 v[102:103], v14 offset:25408
    ds_read_b64_tr_b16 v[104:105], v14 offset:24704
    ds_read_b64_tr_b16 v[106:107], v14 offset:25472
    ds_read_b128 v[92:95], v11 offset:8192
    v_mfma_f32_16x16x32_bf16 v[204:207], v[200:203], v[80:83], v[204:207]
    v_lshlrev_b32 v220, 16, v80
    v_and_b32 v221, s75, v80
    v_fmac_f32 v134, v220, v220
    v_fmac_f32 v135, v221, v221
    v_lshlrev_b32 v222, 16, v81
    v_and_b32 v223, s75, v81
    v_fmac_f32 v134, v222, v222
    v_mfma_f32_32x32x16_bf16 v[64:79], v[80:83], v[192:195], v[64:79]
    v_fmac_f32 v135, v223, v223
    v_lshlrev_b32 v220, 16, v82
    v_and_b32 v221, s75, v82
    v_fmac_f32 v134, v220, v220
    v_fmac_f32 v135, v221, v221
    v_lshlrev_b32 v222, 16, v83
    v_and_b32 v223, s75, v83
    v_fmac_f32 v134, v222, v222
    v_fmac_f32 v135, v223, v223
    v_add_f32 v140, v140, v141
    v_add_f32 v142, v142, v143
    v_add_f32 v140, v140, v142
    v_and_b32 v197, 0xffff0000, v140
    v_mfma_f32_32x32x16_bf16 v[32:47], v[184:187], v[80:83], v[32:47]
    v_sub_f32 v199, v140, v197
    v_and_b32 v198, 0xffff0000, v199
    v_sub_f32 v199, v199, v198
    v_perm_b32 v152, v197, v197, s29
    v_perm_b32 v153, v197, v198, s29
    v_perm_b32 v154, v199, v198, s29
    v_mov_b32 v155, 0
    v_add_f32 v144, v144, v145
    v_add_f32 v146, v146, v147
    v_add_f32 v144, v144, v146
    v_and_b32 v197, 0xffff0000, v144
    v_sub_f32 v199, v144, v197
    v_and_b32 v198, 0xffff0000, v199
    s_waitcnt lgkmcnt(7)
    v_mfma_f32_32x32x16_bf16 v[48:63], v[124:127], v[84:87], v[48:63]
    ds_read_b64_tr_b16 v[108:109], v15 offset:24576
    ds_read_b64_tr_b16 v[110:111], v15 offset:25344
    ds_read_b64_tr_b16 v[112:113], v15 offset:24640
    ds_read_b64_tr_b16 v[114:115], v15 offset:25408
    ds_read_b64_tr_b16 v[116:117], v15 offset:24704
    ds_read_b64_tr_b16 v[118:119], v15 offset:25472
    v_mfma_f32_16x16x32_bf16 v[204:207], v[200:203], v[84:87], v[204:207]
    v_lshlrev_b32 v220, 16, v84
    v_and_b32 v221, s75, v84
    v_fmac_f32 v134, v220, v220
    v_fmac_f32 v135, v221, v221
    v_lshlrev_b32 v222, 16, v85
    v_and_b32 v223, s75, v85
    v_fmac_f32 v134, v222, v222
    v_fmac_f32 v135, v223, v223
    v_mfma_f32_16x16x32_bf16 v[204:207], v[200:203], v[88:91], v[204:207]
    v_lshlrev_b32 v220, 16, v86
    v_and_b32 v221, s75, v86
    v_fmac_f32 v134, v220, v220
    v_fmac_f32 v135, v221, v221
    v_lshlrev_b32 v222, 16, v87
    v_and_b32 v223, s75, v87
    v_fmac_f32 v134, v222, v222
    v_fmac_f32 v135, v223, v223
    v_mfma_f32_32x32x16_bf16 v[64:79], v[84:87], v[128:131], v[64:79]
    v_sub_f32 v199, v199, v198
    v_perm_b32 v156, v197, v197, s29
    v_perm_b32 v157, v197, v198, s29
    v_perm_b32 v158, v199, v198, s29
    v_mov_b32 v159, 0
    v_add_f32 v148, v148, v149
    v_add_f32 v150, v150, v151
    v_add_f32 v148, v148, v150
    v_and_b32 v197, 0xffff0000, v148
    v_sub_f32 v199, v148, v197
    v_and_b32 v198, 0xffff0000, v199
    v_sub_f32 v199, v199, v198
    v_perm_b32 v160, v197, v197, s29
    v_perm_b32 v161, v197, v198, s29
    v_perm_b32 v162, v199, v198, s29
    v_mov_b32 v163, 0
    v_mfma_f32_32x32x16_bf16 v[32:47], v[120:123], v[84:87], v[32:47]
    v_lshlrev_b32 v220, 16, v88
    v_and_b32 v221, s75, v88
    v_fmac_f32 v134, v220, v220
    v_fmac_f32 v135, v221, v221
    v_lshlrev_b32 v222, 16, v89
    v_and_b32 v223, s75, v89
    v_fmac_f32 v134, v222, v222
    v_fmac_f32 v135, v223, v223
    v_lshlrev_b32 v220, 16, v90
    v_and_b32 v221, s75, v90
    v_fmac_f32 v134, v220, v220
    v_fmac_f32 v135, v221, v221
    v_lshlrev_b32 v222, 16, v91
    v_and_b32 v223, s75, v91
    v_fmac_f32 v134, v222, v222
    v_fmac_f32 v135, v223, v223
    s_waitcnt lgkmcnt(6)
    v_mfma_f32_32x32x16_bf16 v[48:63], v[100:103], v[88:91], v[48:63]
    v_lshlrev_b32 v220, 16, v92
    v_and_b32 v221, s75, v92
    v_fmac_f32 v134, v220, v220
    v_fmac_f32 v135, v221, v221
    v_lshlrev_b32 v222, 16, v93
    v_and_b32 v223, s75, v93
    v_mfma_f32_16x16x32_bf16 v[204:207], v[200:203], v[92:95], v[204:207]
    v_fmac_f32 v134, v222, v222
    v_fmac_f32 v135, v223, v223
    v_lshlrev_b32 v220, 16, v94
    v_mfma_f32_32x32x16_bf16 v[64:79], v[88:91], v[104:107], v[64:79]
    v_and_b32 v221, s75, v94
    v_fmac_f32 v134, v220, v220
    v_fmac_f32 v135, v221, v221
    v_lshlrev_b32 v222, 16, v95
    v_and_b32 v223, s75, v95
    v_fmac_f32 v134, v222, v222
    v_mfma_f32_32x32x16_bf16 v[32:47], v[96:99], v[88:91], v[32:47]
    v_fmac_f32 v135, v223, v223
    v_add_f32 v134, v134, v135
    v_mov_b32 v140, v134
    s_nop 1
    v_permlane32_swap_b32 v140, v134
    v_add_f32 v134, v134, v140
    v_mul_f32 v132, 0.001953125, v204
    s_waitcnt lgkmcnt(0)
    v_mfma_f32_32x32x16_bf16 v[48:63], v[112:115], v[92:95], v[48:63]
    v_mul_f32 v134, 0.001953125, v134
    v_fma_f32 v134, -v132, v132, v134
    v_cndmask_b32 v132, 0, v132, s[76:77]
    v_max_f32 v134, 0, v134
    v_sub_f32 v132, 0, v132
    v_add_f32 v134, 0x3727c5ac, v134
    v_rsq_f32 v134, v134
    v_mfma_f32_32x32x16_bf16 v[64:79], v[92:95], v[116:119], v[64:79]
    v_and_b32 v197, 0xffff0000, v132
    v_sub_f32 v199, v132, v197
    v_and_b32 v198, 0xffff0000, v199
    v_sub_f32 v199, v199, v198
    ds_write_b32 v29, v134
    ds_read_b128 v[168:171], v30 offset:0
    ds_read_b128 v[172:175], v30 offset:32
    v_mfma_f32_32x32x16_bf16 v[32:47], v[108:111], v[92:95], v[32:47]
    ds_read_b128 v[176:179], v30 offset:64
    ds_read_b128 v[180:183], v30 offset:96
    v_perm_b32 v164, v198, v197, s29
    v_perm_b32 v165, v199, v197, s29
    v_perm_b32 v166, v197, v198, s29
    v_mov_b32 v167, 0
    v_mul_f32 v136, 0.36067376022224085, v134
    s_nop 0
    v_mfma_f32_32x32x16_bf16 v[48:63], v[156:159], v[164:167], v[48:63]
    v_mfma_f32_32x32x16_bf16 v[64:79], v[164:167], v[160:163], v[64:79]
    v_mfma_f32_32x32x16_bf16 v[32:47], v[152:155], v[164:167], v[32:47]
    s_xor_b32 s54, s52, 0
    s_lshl_b32 s54, s54, 1
    s_lshr_b32 s31, s53, 3
    s_and_b32 s31, s31, 1
    s_add_u32 s54, s54, s31
    s_and_b32 s31, s53, 16
    s_add_u32 s54, s54, s31
    s_and_b32 s55, s53, 7
    s_lshl_b32 s56, s55, 3
    s_lshl_b32 s31, s3, 1
    s_add_u32 s56, s56, s31
    s_add_u32 s31, s52, 1
    s_cmp_eq_u32 s31, s70
    s_waitcnt lgkmcnt(0)
    v_pk_mul_f32 v[48:49], v[48:49], v[134:135] op_sel_hi:[1,0]
    v_pk_mul_f32 v[50:51], v[50:51], v[134:135] op_sel_hi:[1,0]
    v_pk_mul_f32 v[52:53], v[52:53], v[134:135] op_sel_hi:[1,0]
    v_pk_mul_f32 v[54:55], v[54:55], v[134:135] op_sel_hi:[1,0]
    v_pk_mul_f32 v[56:57], v[56:57], v[134:135] op_sel_hi:[1,0]
    v_pk_mul_f32 v[58:59], v[58:59], v[134:135] op_sel_hi:[1,0]
    v_pk_mul_f32 v[60:61], v[60:61], v[134:135] op_sel_hi:[1,0]
    v_pk_mul_f32 v[62:63], v[62:63], v[134:135] op_sel_hi:[1,0]
    v_cvt_pk_bf16_f32 v48, v48, v49
    v_cvt_pk_bf16_f32 v49, v50, v51
    v_cvt_pk_bf16_f32 v50, v52, v53
    v_cvt_pk_bf16_f32 v51, v54, v55
    v_cvt_pk_bf16_f32 v52, v56, v57
    v_cvt_pk_bf16_f32 v53, v58, v59
    v_cvt_pk_bf16_f32 v54, v60, v61
    v_cvt_pk_bf16_f32 v55, v62, v63
    s_cbranch_scc0 F_qsk
    buffer_store_dwordx4 v[48:51], v1, s[4:7], s49 offen
    buffer_store_dwordx4 v[52:55], v1, s[4:7], s50 offen
F_qbk:
    v_pk_mul_f32 v[64:65], v[64:65], v[168:169]
    v_pk_mul_f32 v[66:67], v[66:67], v[170:171]
    v_pk_mul_f32 v[68:69], v[68:69], v[172:173]
    v_pk_mul_f32 v[70:71], v[70:71], v[174:175]
    v_pk_mul_f32 v[72:73], v[72:73], v[176:177]
    v_pk_mul_f32 v[74:75], v[74:75], v[178:179]
    v_pk_mul_f32 v[76:77], v[76:77], v[180:181]
    v_pk_mul_f32 v[78:79], v[78:79], v[182:183]
    v_cvt_pk_bf16_f32 v64, v64, v65
    v_cvt_pk_bf16_f32 v65, v66, v67
    v_cvt_pk_bf16_f32 v66, v68, v69
    v_cvt_pk_bf16_f32 v67, v70, v71
    v_cvt_pk_bf16_f32 v68, v72, v73
    v_cvt_pk_bf16_f32 v69, v74, v75
    v_cvt_pk_bf16_f32 v70, v76, v77
    v_cvt_pk_bf16_f32 v71, v78, v79
    s_cbranch_scc0 F_qsv
    buffer_store_dwordx4 v[64:67], v31, s[4:7], s49 offen offset:1024
    buffer_store_dwordx4 v[68:71], v31, s[4:7], s49 offen offset:1040
F_qbv:
    v_pk_mul_f32 v[32:33], v[32:33], v[136:137] op_sel_hi:[1,0]
    v_pk_mul_f32 v[34:35], v[34:35], v[136:137] op_sel_hi:[1,0]
    v_pk_mul_f32 v[36:37], v[36:37], v[136:137] op_sel_hi:[1,0]
    v_pk_mul_f32 v[38:39], v[38:39], v[136:137] op_sel_hi:[1,0]
    v_pk_mul_f32 v[40:41], v[40:41], v[136:137] op_sel_hi:[1,0]
    v_pk_mul_f32 v[42:43], v[42:43], v[136:137] op_sel_hi:[1,0]
    v_pk_mul_f32 v[44:45], v[44:45], v[136:137] op_sel_hi:[1,0]
    v_pk_mul_f32 v[46:47], v[46:47], v[136:137] op_sel_hi:[1,0]
    v_cvt_pk_bf16_f32 v32, v32, v33
    v_cvt_pk_bf16_f32 v33, v34, v35
    v_cvt_pk_bf16_f32 v34, v36, v37
    v_cvt_pk_bf16_f32 v35, v38, v39
    v_cvt_pk_bf16_f32 v36, v40, v41
    v_cvt_pk_bf16_f32 v37, v42, v43
    v_cvt_pk_bf16_f32 v38, v44, v45
    v_cvt_pk_bf16_f32 v39, v46, v47
    s_cbranch_scc0 F_qsq
    buffer_store_dwordx4 v[32:35], v1, s[4:7], s47 offen
    buffer_store_dwordx4 v[36:39], v1, s[4:7], s48 offen
F_qbq:
    v_mov_b32 v6, 1065369472
    v_mov_b32 v7, 1065369472
    v_mul_u32_u24 v16, 2080, v2
    v_and_b32 v3, 15, v2
    v_lshlrev_b32 v3, 4, v3
    s_lshr_b32 s80, s54, 1
    s_mul_i32 s80, s80, 256
    s_add_u32 s80, s80, 25714688
    s_lshl_b32 s57, s54, 17
    s_lshl_b32 s58, s3, 12
    s_add_u32 s57, s57, s58
    s_add_u32 s57, s57, 2097120
    s_mul_i32 s58, s3, 4160
    s_lshl_b32 s59, s54, 6
    s_add_u32 s59, s59, s56
    s_lshl_b32 s59, s59, 10
    v_add_u32 v231, 32, v1
    v_mov_b32 v4, v1
    v_and_b32 v17, 15, v2
    v_lshrrev_b32 v18, 5, v2
    v_lshl_add_u32 v17, v18, 4, v17
    v_lshlrev_b32 v17, 5, v17
    v_and_b32 v18, 16, v2
    v_cmp_eq_u32 vcc, 0, v18
    v_mov_b32 v19, 1024
    s_nop 0
    v_cndmask_b32 v5, v19, v17, vcc
    v_add_u32 v5, 1024, v5
    v_add_u32 v224, 4096, v1
    v_add_u32 v225, 8192, v1
    v_add_u32 v226, 12288, v1
    v_add_u32 v227, 16384, v1
    v_add_u32 v228, 20480, v1
    v_add_u32 v229, 24576, v1
    v_add_u32 v230, 28672, v1
    s_lshl_b32 s72, s52, 5
    s_add_u32 s72, s72, s53
    s_lshl_b32 s78, s72, 4
    s_add_u32 s78, s78, 25690112
    v_mov_b32 v21, s70
    s_mov_b32 s81, 24
    s_add_u32 s82, s52, 1
    v_add_u32 v237, 66560, v4
    v_add_u32 v238, 66560, v5
    s_and_b32 s38, s3, 1
    s_lshl_b32 s74, s3, 13
    s_lshl_b32 s41, s38, 15
    s_add_u32 s74, s74, s41
    s_add_u32 s74, s74, 17825792
    s_mul_i32 s75, s3, 28672
    s_add_u32 s75, s75, 23068672
    s_mul_i32 s41, s38, 114688
    s_sub_u32 s76, s75, s41
    s_add_u32 s76, s76, 114688
    s_add_u32 s75, s75, s41
    s_lshr_b32 s77, s3, 1
    s_lshl_b32 s71, s70, 8
    s_add_u32 s71, s71, s72
    s_mov_b32 s79, 25690112
    s_mov_b32 s73, 1
    v_and_b32 v12, 31, v2
    v_lshrrev_b32 v13, 5, v2
    v_lshlrev_b32 v236, 10, v12
    v_lshl_add_u32 v236, v13, 4, v236
    v_min_u32 v233, 17, v2
    v_lshlrev_b32 v233, 4, v233
    v_mov_b32 v246, 0x07050301
    v_mov_b32 v14, 0x08060402
    v_cmp_eq_u32 vcc, 0, v13
    s_nop 1
    v_cndmask_b32 v246, v14, v246, vcc
    s_lshr_b32 s60, s72, 3
    s_and_b32 s61, s72, 7
    s_lshr_b32 s62, s72, 4
    s_and_b32 s63, s72, 15
    s_lshl1_add_u32 s39, s61, s38
    s_lshl1_add_u32 s40, s60, s77
    s_lshl_b32 s41, s61, 16
    s_add_u32 s32, s74, s41
    s_xor_b32 s33, s32, 0x8000
    s_mul_i32 s41, s61, 229376
    s_add_u32 s34, s75, s41
    s_add_u32 s35, s76, s41
    s_mul_i32 s36, s63, 7168
    s_add_u32 s36, s36, 22544384
    s_lshl_b32 s37, s40, 15
    s_lshl_b32 s41, s39, 6
    s_add_u32 s37, s37, s41
    s_mul_i32 s42, s61, 512
    s_add_u32 s42, s42, 25706496
    s_mul_i32 s43, s63, 256
    s_add_u32 s43, s43, 25710592
    s_add_u32 s41, s63, 1
    s_bitcmp1_b32 s41, 1
    s_cselect_b32 s41, 11, 7
    v_min_u32 v234, s41, v2
    v_lshlrev_b32 v234, 4, v234
    v_mov_b32 v112, 0
    v_mov_b32 v32, 0
    v_mov_b32 v113, 0
    v_mov_b32 v33, 0
    v_mov_b32 v114, 0
    v_mov_b32 v34, 0
    v_mov_b32 v115, 0
    v_mov_b32 v35, 0
    v_mov_b32 v116, 0
    v_mov_b32 v36, 0
    v_mov_b32 v117, 0
    v_mov_b32 v37, 0
    v_mov_b32 v118, 0
    v_mov_b32 v38, 0
    v_mov_b32 v119, 0
    v_mov_b32 v39, 0
    v_mov_b32 v120, 0
    v_mov_b32 v121, 0
    v_mov_b32 v122, 0
    v_mov_b32 v123, 0
    v_mov_b32 v124, 0
    v_mov_b32 v125, 0
    v_mov_b32 v126, 0
    v_mov_b32 v127, 0
    v_mov_b32 v128, 0
    v_mov_b32 v129, 0
    v_mov_b32 v130, 0
    v_mov_b32 v131, 0
    v_mov_b32 v132, 0
    v_mov_b32 v133, 0
    v_mov_b32 v134, 0
    v_mov_b32 v135, 0
    v_mov_b32 v136, 0
    v_mov_b32 v137, 0
    v_mov_b32 v138, 0
    v_mov_b32 v139, 0
    v_mov_b32 v140, 0
    v_mov_b32 v141, 0
    v_mov_b32 v142, 0
    v_mov_b32 v143, 0
    v_mov_b32 v144, 0
    v_mov_b32 v145, 0
    v_mov_b32 v146, 0
    v_mov_b32 v147, 0
    v_mov_b32 v148, 0
    v_mov_b32 v149, 0
    v_mov_b32 v150, 0
    v_mov_b32 v151, 0
    v_mov_b32 v27, 1
    s_waitcnt vmcnt(0)
    v_cmp_eq_u32 vcc, 1, v25
    s_cmp_eq_u64 vcc, -1
    s_cbranch_scc1 F_dbg_ok
F_dbg:
    buffer_load_dword v25, v26, s[24:27], 0 offen sc1
    s_waitcnt vmcnt(0)
    v_cmp_ne_u32 vcc, 0, v25
    s_cmp_eq_u64 vcc, -1
    s_cbranch_scc1 F_dbg_ok
    s_cmp_eq_u32 s30, 0
    s_cbranch_scc1 F_dbg_ok
    s_sub_u32 s30, s30, 1
    s_sleep 1
    s_branch F_dbg
F_dbg_ok:
    s_barrier
    s_cmp_lg_u32 s3, 0
    s_cbranch_scc1 F_f1
    s_add_u32 s31, s52, 1
    s_cmp_eq_u32 s31, s70
    s_cbranch_scc0 F_f1r
    s_mov_b64 exec, 1
    buffer_store_dword v27, v26, s[4:7], s83 offen
    s_mov_b64 exec, -1
F_f1:
    ds_write_b64 v16, v[6:7] offset:2048
    ds_write_b64 v16, v[6:7] offset:2056
    ds_write_b64 v16, v[6:7] offset:2064
    ds_write_b64 v16, v[6:7] offset:2072
    s_cmp_eq_u32 s82, s70
    s_cbranch_scc0 F_p1slow
F_p1:
    buffer_load_dword v20, v3, s[4:7], s80 offen sc1
    s_waitcnt vmcnt(0)
    v_cmp_ne_u32 vcc, 0, v20
    s_cmp_eq_u64 vcc, -1
    s_cbranch_scc1 F_p1_ok
    s_sub_u32 s81, s81, 1
    s_cbranch_scc1 F_p1slow
    s_sleep 1
    s_branch F_p1
F_p1_ok:
    s_add_u32 m0, s58, 0
    s_nop 0
    buffer_load_dwordx4 v231, s[4:7], s57 offen sc1 lds
    buffer_load_dwordx4 v231, s[4:7], s57 offen offset:1024 sc1 lds
    buffer_load_dwordx4 v1, s[4:7], s57 offen offset:2080 sc1 lds
    buffer_load_dwordx4 v1, s[4:7], s57 offen offset:3104 sc1 lds
    s_add_u32 s57, s57, 16384
    buffer_load_dwordx4 v[8:11], v1, s[4:7], s59 offen offset:0 sc1
    buffer_load_dwordx4 v[12:15], v1, s[4:7], s59 offen offset:1024 sc1
    s_add_u32 m0, s58, 16640
    s_nop 0
    buffer_load_dwordx4 v231, s[4:7], s57 offen sc1 lds
    buffer_load_dwordx4 v231, s[4:7], s57 offen offset:1024 sc1 lds
    buffer_load_dwordx4 v1, s[4:7], s57 offen offset:2080 sc1 lds
    buffer_load_dwordx4 v1, s[4:7], s57 offen offset:3104 sc1 lds
    s_add_u32 s57, s57, 16384
    s_lshl_b32 s31, s40, 4
    s_add_u32 s31, s31, s39
    s_lshl_b32 s31, s31, 11
    s_add_u32 s31, s31, 8388608
    v_lshl_add_u32 v247, v2, 7, s31
    s_lshl2_add_u32 s31, s62, s3
    s_lshl_b32 s31, s31, 4
    s_add_u32 s31, s31, s63
    s_mul_i32 s31, s31, 7168
    s_add_u32 s31, s31, 10488832
    v_lshl_add_u32 v248, v2, 7, s31
    v_cmp_gt_u32 vcc, 16, v2
    s_nop 1
    v_cndmask_b32 v247, v248, v247, vcc
    s_and_b32 s31, s61, 3
    s_lshl2_add_u32 s31, s40, s31
    s_lshr_b32 s41, s61, 2
    s_lshl1_add_u32 s31, s31, s41
    s_lshl_b32 s31, s31, 9
    s_add_u32 s31, s31, 25165824
    v_and_b32 v248, 3, v2
    v_lshl_add_u32 v248, v248, 7, s31
    v_cmp_gt_u32 vcc, 32, v2
    s_nop 1
    v_cndmask_b32 v247, v248, v247, vcc
    v_mov_b32 v250, 0x7fffff00
    v_cmp_gt_u32 vcc, 36, v2
    s_nop 1
    v_cndmask_b32 v247, v250, v247, vcc
    s_waitcnt vmcnt(4) lgkmcnt(0)
    s_barrier
    s_cmp_lg_u32 s3, 1
    s_cbranch_scc1 F_tabst
    s_mov_b64 exec, 1
    buffer_store_dword v21, v26, s[4:7], s78 offen sc1
    s_mov_b64 exec, -1
F_tabst:
    ds_read_b128 v[16:19], v4
    ds_read_b128 v[20:23], v4 offset:2080
    ds_read_b128 v[24:27], v5
    ds_read_b128 v[28:31], v5 offset:16
    s_waitcnt lgkmcnt(3)
    v_mfma_f32_32x32x16_bf16 v[72:87], v[16:19], v[8:11], 0
    v_mfma_f32_32x32x16_bf16 v[88:103], v[16:19], v[12:15], 0
    s_nop 10
    v_max3_f32 v6, v72, v73, v74
    v_max3_f32 v6, v6, v75, v76
    v_max3_f32 v6, v6, v77, v78
    v_max3_f32 v6, v6, v79, v80
    v_max3_f32 v6, v6, v81, v82
    v_max3_f32 v6, v6, v83, v84
    v_max3_f32 v6, v6, v85, v86
    v_max_f32 v6, v6, v87
    v_max3_f32 v7, v88, v89, v90
    v_max3_f32 v7, v7, v91, v92
    v_max3_f32 v7, v7, v93, v94
    v_max3_f32 v7, v7, v95, v96
    v_max3_f32 v7, v7, v97, v98
    v_max3_f32 v7, v7, v99, v100
    v_max3_f32 v7, v7, v101, v102
    v_max_f32 v7, v7, v103
    v_mov_b32 v104, v6
    v_mov_b32 v105, v7
    s_nop 0
    v_permlane32_swap_b32 v104, v6
    v_permlane32_swap_b32 v105, v7
    v_max_f32 v6, v6, v104
    v_max_f32 v7, v7, v105
    v_sub_f32 v40, 0, v6
    v_sub_f32 v41, 0, v6
    v_sub_f32 v42, 0, v6
    v_sub_f32 v43, 0, v6
    v_sub_f32 v44, 0, v6
    v_sub_f32 v45, 0, v6
    v_sub_f32 v46, 0, v6
    v_sub_f32 v47, 0, v6
    v_sub_f32 v48, 0, v6
    v_sub_f32 v49, 0, v6
    v_sub_f32 v50, 0, v6
    v_sub_f32 v51, 0, v6
    v_sub_f32 v52, 0, v6
    v_sub_f32 v53, 0, v6
    v_sub_f32 v54, 0, v6
    v_sub_f32 v55, 0, v6
    s_nop 1
    v_mfma_f32_32x32x16_bf16 v[72:87], v[16:19], v[8:11], v[40:55]
    v_sub_f32 v56, 0, v7
    v_sub_f32 v57, 0, v7
    v_sub_f32 v58, 0, v7
    v_sub_f32 v59, 0, v7
    v_sub_f32 v60, 0, v7
    v_sub_f32 v61, 0, v7
    v_sub_f32 v62, 0, v7
    v_sub_f32 v63, 0, v7
    v_sub_f32 v64, 0, v7
    v_sub_f32 v65, 0, v7
    v_sub_f32 v66, 0, v7
    v_sub_f32 v67, 0, v7
    v_sub_f32 v68, 0, v7
    v_sub_f32 v69, 0, v7
    v_sub_f32 v70, 0, v7
    v_sub_f32 v71, 0, v7
    v_mov_b32 v100, 0
    v_mov_b32 v101, 0
    v_mov_b32 v102, 0
    v_mov_b32 v103, 0
    s_waitcnt lgkmcnt(0)
    s_add_u32 m0, s44, 0
    s_lshl_b32 s31, s3, 2
    v_add_u32 v212, s31, v242
    s_lshl_b32 s31, s3, 9
    v_add_u32 v213, s31, v242
.p2align 3
    v_exp_f32 v72, v72
    v_exp_f32 v73, v73
    v_cvt_pk_bf16_f32 v118, v100, v101
    v_exp_f32 v74, v74
    v_exp_f32 v75, v75
    v_cvt_pk_bf16_f32 v119, v102, v103
    v_cvt_pk_bf16_f32 v104, v72, v73
    v_mfma_f32_32x32x16_bf16 v[88:103], v[16:19], v[12:15], v[56:71]
    buffer_load_dwordx4 v239, s[20:23], s96 offen lds
    s_add_u32 m0, s44, 1024
    v_exp_f32 v76, v76
    v_exp_f32 v77, v77
    v_cvt_pk_bf16_f32 v105, v74, v75
    v_exp_f32 v78, v78
    v_exp_f32 v79, v79
    v_cvt_pk_bf16_f32 v106, v76, v77
    v_mfma_f32_32x32x16_bf16 v[136:151], v[32:35], v[112:115], v[136:151]
    buffer_load_dwordx4 v240, s[64:67], s96 offen lds
    s_add_u32 s96, s96, s97
    s_add_u32 m0, s44, 2080
    v_exp_f32 v80, v80
    v_exp_f32 v81, v81
    v_cvt_pk_bf16_f32 v107, v78, v79
    v_exp_f32 v82, v82
    v_exp_f32 v83, v83
    v_cvt_pk_bf16_f32 v108, v80, v81
    v_mfma_f32_32x32x16_bf16 v[136:151], v[36:39], v[116:119], v[136:151]
    s_waitcnt lgkmcnt(0)
    v_exp_f32 v84, v84
    v_exp_f32 v85, v85
    v_cvt_pk_bf16_f32 v109, v82, v83
    v_exp_f32 v86, v86
    v_exp_f32 v87, v87
    v_exp_f32 v88, v88
    v_exp_f32 v89, v89
    v_cvt_pk_bf16_f32 v110, v84, v85
    v_exp_f32 v90, v90
    v_exp_f32 v91, v91
    v_cvt_pk_bf16_f32 v111, v86, v87
    v_cvt_pk_bf16_f32 v112, v88, v89
    v_mfma_f32_32x32x16_bf16 v[72:87], v[20:23], v[8:11], v[40:55]
    ds_read_b128 v[32:35], v5 offset:2080
    v_exp_f32 v92, v92
    v_exp_f32 v93, v93
    v_cvt_pk_bf16_f32 v113, v90, v91
    v_exp_f32 v94, v94
    v_exp_f32 v95, v95
    v_cvt_pk_bf16_f32 v114, v92, v93
    v_mfma_f32_32x32x16_bf16 v[120:135], v[24:27], v[104:107], v[120:135]
    ds_read_b128 v[36:39], v5 offset:2096
    v_exp_f32 v96, v96
    v_exp_f32 v97, v97
    v_cvt_pk_bf16_f32 v115, v94, v95
    v_exp_f32 v98, v98
    v_exp_f32 v99, v99
    v_cvt_pk_bf16_f32 v116, v96, v97
    v_mfma_f32_32x32x16_bf16 v[120:135], v[28:31], v[108:111], v[120:135]
    ds_read_b128 v[16:19], v4 offset:4160
    v_exp_f32 v100, v100
    v_exp_f32 v101, v101
    v_cvt_pk_bf16_f32 v117, v98, v99
    v_exp_f32 v102, v102
    v_exp_f32 v103, v103
    v_exp_f32 v72, v72
    v_exp_f32 v73, v73
    v_cvt_pk_bf16_f32 v118, v100, v101
    v_exp_f32 v74, v74
    v_exp_f32 v75, v75
    v_cvt_pk_bf16_f32 v119, v102, v103
    v_cvt_pk_bf16_f32 v104, v72, v73
    v_mfma_f32_32x32x16_bf16 v[88:103], v[20:23], v[12:15], v[56:71]
    buffer_load_dwordx4 v239, s[20:23], s96 offen lds
    s_add_u32 m0, s44, 3104
    v_exp_f32 v76, v76
    v_exp_f32 v77, v77
    v_cvt_pk_bf16_f32 v105, v74, v75
    v_exp_f32 v78, v78
    v_exp_f32 v79, v79
    v_cvt_pk_bf16_f32 v106, v76, v77
    v_mfma_f32_32x32x16_bf16 v[136:151], v[24:27], v[112:115], v[136:151]
    buffer_load_dwordx4 v240, s[64:67], s96 offen lds
    s_add_u32 s96, s96, s97
    s_mov_b32 s22, s99
    s_mov_b32 s66, s99
    s_add_u32 m0, s44, 4160
    v_exp_f32 v80, v80
    v_exp_f32 v81, v81
    v_cvt_pk_bf16_f32 v107, v78, v79
    v_exp_f32 v82, v82
    v_exp_f32 v83, v83
    v_cvt_pk_bf16_f32 v108, v80, v81
    v_mfma_f32_32x32x16_bf16 v[136:151], v[28:31], v[116:119], v[136:151]
    s_waitcnt lgkmcnt(0)
    v_exp_f32 v84, v84
    v_exp_f32 v85, v85
    v_cvt_pk_bf16_f32 v109, v82, v83
    v_exp_f32 v86, v86
    v_exp_f32 v87, v87
    v_exp_f32 v88, v88
    v_exp_f32 v89, v89
    v_cvt_pk_bf16_f32 v110, v84, v85
    v_exp_f32 v90, v90
    v_exp_f32 v91, v91
    v_cvt_pk_bf16_f32 v111, v86, v87
    v_cvt_pk_bf16_f32 v112, v88, v89
    v_mfma_f32_32x32x16_bf16 v[72:87], v[16:19], v[8:11], v[40:55]
    ds_read_b128 v[24:27], v5 offset:4160
    v_exp_f32 v92, v92
    v_exp_f32 v93, v93
    v_cvt_pk_bf16_f32 v113, v90, v91
    v_exp_f32 v94, v94
    v_exp_f32 v95, v95
    v_cvt_pk_bf16_f32 v114, v92, v93
    v_mfma_f32_32x32x16_bf16 v[120:135], v[32:35], v[104:107], v[120:135]
    ds_read_b128 v[28:31], v5 offset:4176
    v_exp_f32 v96, v96
    v_exp_f32 v97, v97
    v_cvt_pk_bf16_f32 v115, v94, v95
    v_exp_f32 v98, v98
    v_exp_f32 v99, v99
    v_cvt_pk_bf16_f32 v116, v96, v97
    v_mfma_f32_32x32x16_bf16 v[120:135], v[36:39], v[108:111], v[120:135]
    ds_read_b128 v[20:23], v4 offset:6240
    v_exp_f32 v100, v100
    v_exp_f32 v101, v101
    v_cvt_pk_bf16_f32 v117, v98, v99
    v_exp_f32 v102, v102
    v_exp_f32 v103, v103
    v_exp_f32 v72, v72
    v_exp_f32 v73, v73
    v_cvt_pk_bf16_f32 v118, v100, v101
    v_exp_f32 v74, v74
    v_exp_f32 v75, v75
    v_cvt_pk_bf16_f32 v119, v102, v103
    v_cvt_pk_bf16_f32 v104, v72, v73
    v_mfma_f32_32x32x16_bf16 v[88:103], v[16:19], v[12:15], v[56:71]
    buffer_load_dwordx4 v239, s[20:23], s96 offen lds
    s_add_u32 m0, s44, 5184
    v_exp_f32 v76, v76
    v_exp_f32 v77, v77
    v_cvt_pk_bf16_f32 v105, v74, v75
    v_exp_f32 v78, v78
    v_exp_f32 v79, v79
    v_cvt_pk_bf16_f32 v106, v76, v77
    v_mfma_f32_32x32x16_bf16 v[136:151], v[32:35], v[112:115], v[136:151]
    buffer_load_dwordx4 v240, s[64:67], s96 offen lds
    s_add_u32 s96, s96, s97
    s_add_u32 m0, s44, 6240
    v_exp_f32 v80, v80
    v_exp_f32 v81, v81
    v_cvt_pk_bf16_f32 v107, v78, v79
    v_exp_f32 v82, v82
    v_exp_f32 v83, v83
    v_cvt_pk_bf16_f32 v108, v80, v81
    v_mfma_f32_32x32x16_bf16 v[136:151], v[36:39], v[116:119], v[136:151]
    s_waitcnt lgkmcnt(0)
    v_exp_f32 v84, v84
    v_exp_f32 v85, v85
    v_cvt_pk_bf16_f32 v109, v82, v83
    v_exp_f32 v86, v86
    v_exp_f32 v87, v87
    v_exp_f32 v88, v88
    v_exp_f32 v89, v89
    v_cvt_pk_bf16_f32 v110, v84, v85
    v_exp_f32 v90, v90
    v_exp_f32 v91, v91
    v_cvt_pk_bf16_f32 v111, v86, v87
    v_cvt_pk_bf16_f32 v112, v88, v89
    v_mfma_f32_32x32x16_bf16 v[72:87], v[20:23], v[8:11], v[40:55]
    ds_read_b128 v[32:35], v5 offset:6240
    v_exp_f32 v92, v92
    v_exp_f32 v93, v93
    v_cvt_pk_bf16_f32 v113, v90, v91
    v_exp_f32 v94, v94
    v_exp_f32 v95, v95
    v_cvt_pk_bf16_f32 v114, v92, v93
    v_mfma_f32_32x32x16_bf16 v[120:135], v[24:27], v[104:107], v[120:135]
    ds_read_b128 v[36:39], v5 offset:6256
    v_exp_f32 v96, v96
    v_exp_f32 v97, v97
    v_cvt_pk_bf16_f32 v115, v94, v95
    v_exp_f32 v98, v98
    v_exp_f32 v99, v99
    v_cvt_pk_bf16_f32 v116, v96, v97
    v_mfma_f32_32x32x16_bf16 v[120:135], v[28:31], v[108:111], v[120:135]
    ds_read_b128 v[16:19], v4 offset:8320
    v_exp_f32 v100, v100
    v_exp_f32 v101, v101
    v_cvt_pk_bf16_f32 v117, v98, v99
    v_exp_f32 v102, v102
    v_exp_f32 v103, v103
    v_exp_f32 v72, v72
    v_exp_f32 v73, v73
    v_cvt_pk_bf16_f32 v118, v100, v101
    v_exp_f32 v74, v74
    v_exp_f32 v75, v75
    v_cvt_pk_bf16_f32 v119, v102, v103
    v_cvt_pk_bf16_f32 v104, v72, v73
    v_mfma_f32_32x32x16_bf16 v[88:103], v[20:23], v[12:15], v[56:71]
    buffer_load_dwordx4 v239, s[20:23], s96 offen lds
    s_add_u32 m0, s44, 7264
    v_exp_f32 v76, v76
    v_exp_f32 v77, v77
    v_cvt_pk_bf16_f32 v105, v74, v75
    v_exp_f32 v78, v78
    v_exp_f32 v79, v79
    v_cvt_pk_bf16_f32 v106, v76, v77
    v_mfma_f32_32x32x16_bf16 v[136:151], v[24:27], v[112:115], v[136:151]
    buffer_load_dwordx4 v240, s[64:67], s96 offen lds
    s_add_u32 s96, s96, s97
    s_mov_b32 s20, s4
    s_mov_b32 s21, s5
    s_cmp_eq_u32 s99, 0
    s_cselect_b32 s22, 0, 33554432
    v_exp_f32 v80, v80
    v_exp_f32 v81, v81
    v_cvt_pk_bf16_f32 v107, v78, v79
    v_exp_f32 v82, v82
    v_exp_f32 v83, v83
    v_cvt_pk_bf16_f32 v108, v80, v81
    v_mfma_f32_32x32x16_bf16 v[136:151], v[28:31], v[116:119], v[136:151]
    s_waitcnt lgkmcnt(0)
    v_exp_f32 v84, v84
    v_exp_f32 v85, v85
    v_cvt_pk_bf16_f32 v109, v82, v83
    v_exp_f32 v86, v86
    v_exp_f32 v87, v87
    v_exp_f32 v88, v88
    v_exp_f32 v89, v89
    v_cvt_pk_bf16_f32 v110, v84, v85
    v_exp_f32 v90, v90
    v_exp_f32 v91, v91
    v_cvt_pk_bf16_f32 v111, v86, v87
    v_cvt_pk_bf16_f32 v112, v88, v89
    v_mfma_f32_32x32x16_bf16 v[72:87], v[16:19], v[8:11], v[40:55]
    ds_read_b128 v[24:27], v5 offset:8320
    v_exp_f32 v92, v92
    v_exp_f32 v93, v93
    v_cvt_pk_bf16_f32 v113, v90, v91
    v_exp_f32 v94, v94
    v_exp_f32 v95, v95
    v_cvt_pk_bf16_f32 v114, v92, v93
    v_mfma_f32_32x32x16_bf16 v[120:135], v[32:35], v[104:107], v[120:135]
    ds_read_b128 v[28:31], v5 offset:8336
    v_exp_f32 v96, v96
    v_exp_f32 v97, v97
    v_cvt_pk_bf16_f32 v115, v94, v95
    v_exp_f32 v98, v98
    v_exp_f32 v99, v99
    v_cvt_pk_bf16_f32 v116, v96, v97
    v_mfma_f32_32x32x16_bf16 v[120:135], v[36:39], v[108:111], v[120:135]
    ds_read_b128 v[20:23], v4 offset:10400
    v_exp_f32 v100, v100
    v_exp_f32 v101, v101
    v_cvt_pk_bf16_f32 v117, v98, v99
    v_exp_f32 v102, v102
    v_exp_f32 v103, v103
    v_exp_f32 v72, v72
    v_exp_f32 v73, v73
    v_cvt_pk_bf16_f32 v118, v100, v101
    v_exp_f32 v74, v74
    v_exp_f32 v75, v75
    v_cvt_pk_bf16_f32 v119, v102, v103
    v_cvt_pk_bf16_f32 v104, v72, v73
    v_mfma_f32_32x32x16_bf16 v[88:103], v[16:19], v[12:15], v[56:71]
    v_exp_f32 v76, v76
    v_exp_f32 v77, v77
    v_cvt_pk_bf16_f32 v105, v74, v75
    v_exp_f32 v78, v78
    v_exp_f32 v79, v79
    v_cvt_pk_bf16_f32 v106, v76, v77
    v_mfma_f32_32x32x16_bf16 v[136:151], v[32:35], v[112:115], v[136:151]
    v_exp_f32 v80, v80
    v_exp_f32 v81, v81
    v_cvt_pk_bf16_f32 v107, v78, v79
    v_exp_f32 v82, v82
    v_exp_f32 v83, v83
    v_cvt_pk_bf16_f32 v108, v80, v81
    v_mfma_f32_32x32x16_bf16 v[136:151], v[36:39], v[116:119], v[136:151]
    s_waitcnt lgkmcnt(0)
    v_exp_f32 v84, v84
    v_exp_f32 v85, v85
    v_cvt_pk_bf16_f32 v109, v82, v83
    v_exp_f32 v86, v86
    v_exp_f32 v87, v87
    v_exp_f32 v88, v88
    v_exp_f32 v89, v89
    v_cvt_pk_bf16_f32 v110, v84, v85
    v_exp_f32 v90, v90
    v_exp_f32 v91, v91
    v_cvt_pk_bf16_f32 v111, v86, v87
    v_cvt_pk_bf16_f32 v112, v88, v89
    v_mfma_f32_32x32x16_bf16 v[72:87], v[20:23], v[8:11], v[40:55]
    ds_read_b128 v[32:35], v5 offset:10400
    v_exp_f32 v92, v92
    v_exp_f32 v93, v93
    v_cvt_pk_bf16_f32 v113, v90, v91
    v_exp_f32 v94, v94
    v_exp_f32 v95, v95
    v_cvt_pk_bf16_f32 v114, v92, v93
    v_mfma_f32_32x32x16_bf16 v[120:135], v[24:27], v[104:107], v[120:135]
    ds_read_b128 v[36:39], v5 offset:10416
    v_exp_f32 v96, v96
    v_exp_f32 v97, v97
    v_cvt_pk_bf16_f32 v115, v94, v95
    v_exp_f32 v98, v98
    v_exp_f32 v99, v99
    v_cvt_pk_bf16_f32 v116, v96, v97
    v_mfma_f32_32x32x16_bf16 v[120:135], v[28:31], v[108:111], v[120:135]
    ds_read_b128 v[16:19], v4 offset:12480
    v_exp_f32 v100, v100
    v_exp_f32 v101, v101
    v_cvt_pk_bf16_f32 v117, v98, v99
    v_exp_f32 v102, v102
    v_exp_f32 v103, v103
    v_exp_f32 v72, v72
    v_exp_f32 v73, v73
    v_cvt_pk_bf16_f32 v118, v100, v101
    v_exp_f32 v74, v74
    v_exp_f32 v75, v75
    v_cvt_pk_bf16_f32 v119, v102, v103
    v_cvt_pk_bf16_f32 v104, v72, v73
    v_mfma_f32_32x32x16_bf16 v[88:103], v[20:23], v[12:15], v[56:71]
    v_exp_f32 v76, v76
    v_exp_f32 v77, v77
    v_cvt_pk_bf16_f32 v105, v74, v75
    v_exp_f32 v78, v78
    v_exp_f32 v79, v79
    v_cvt_pk_bf16_f32 v106, v76, v77
    v_mfma_f32_32x32x16_bf16 v[136:151], v[24:27], v[112:115], v[136:151]
    v_exp_f32 v80, v80
    v_exp_f32 v81, v81
    v_cvt_pk_bf16_f32 v107, v78, v79
    v_exp_f32 v82, v82
    v_exp_f32 v83, v83
    v_cvt_pk_bf16_f32 v108, v80, v81
    v_mfma_f32_32x32x16_bf16 v[136:151], v[28:31], v[116:119], v[136:151]
    s_waitcnt lgkmcnt(0)
    v_exp_f32 v84, v84
    v_exp_f32 v85, v85
    v_cvt_pk_bf16_f32 v109, v82, v83
    v_exp_f32 v86, v86
    v_exp_f32 v87, v87
    v_exp_f32 v88, v88
    v_exp_f32 v89, v89
    v_cvt_pk_bf16_f32 v110, v84, v85
    v_exp_f32 v90, v90
    v_exp_f32 v91, v91
    v_cvt_pk_bf16_f32 v111, v86, v87
    v_cvt_pk_bf16_f32 v112, v88, v89
    v_mfma_f32_32x32x16_bf16 v[72:87], v[16:19], v[8:11], v[40:55]
    ds_read_b128 v[24:27], v5 offset:12480
    v_exp_f32 v92, v92
    v_exp_f32 v93, v93
    v_cvt_pk_bf16_f32 v113, v90, v91
    v_exp_f32 v94, v94
    v_exp_f32 v95, v95
    v_cvt_pk_bf16_f32 v114, v92, v93
    v_mfma_f32_32x32x16_bf16 v[120:135], v[32:35], v[104:107], v[120:135]
    ds_read_b128 v[28:31], v5 offset:12496
    v_exp_f32 v96, v96
    v_exp_f32 v97, v97
    v_cvt_pk_bf16_f32 v115, v94, v95
    v_exp_f32 v98, v98
    v_exp_f32 v99, v99
    v_cvt_pk_bf16_f32 v116, v96, v97
    v_mfma_f32_32x32x16_bf16 v[120:135], v[36:39], v[108:111], v[120:135]
    ds_read_b128 v[20:23], v4 offset:14560
    v_exp_f32 v100, v100
    v_exp_f32 v101, v101
    v_cvt_pk_bf16_f32 v117, v98, v99
    v_exp_f32 v102, v102
    v_exp_f32 v103, v103
    v_exp_f32 v72, v72
    v_exp_f32 v73, v73
    v_cvt_pk_bf16_f32 v118, v100, v101
    v_exp_f32 v74, v74
    v_exp_f32 v75, v75
    v_cvt_pk_bf16_f32 v119, v102, v103
    v_cvt_pk_bf16_f32 v104, v72, v73
    v_mfma_f32_32x32x16_bf16 v[88:103], v[16:19], v[12:15], v[56:71]
    v_exp_f32 v76, v76
    v_exp_f32 v77, v77
    v_cvt_pk_bf16_f32 v105, v74, v75
    v_exp_f32 v78, v78
    v_exp_f32 v79, v79
    v_cvt_pk_bf16_f32 v106, v76, v77
    v_mfma_f32_32x32x16_bf16 v[136:151], v[32:35], v[112:115], v[136:151]
    s_add_u32 m0, s58, 33280
    v_exp_f32 v80, v80
    v_exp_f32 v81, v81
    v_cvt_pk_bf16_f32 v107, v78, v79
    v_exp_f32 v82, v82
    v_exp_f32 v83, v83
    v_cvt_pk_bf16_f32 v108, v80, v81
    v_mfma_f32_32x32x16_bf16 v[136:151], v[36:39], v[116:119], v[136:151]
    s_waitcnt vmcnt(8) lgkmcnt(0)
    s_barrier
    v_exp_f32 v84, v84
    v_exp_f32 v85, v85
    v_cvt_pk_bf16_f32 v109, v82, v83
    v_exp_f32 v86, v86
    v_exp_f32 v87, v87
    v_exp_f32 v88, v88
    v_exp_f32 v89, v89
    v_cvt_pk_bf16_f32 v110, v84, v85
    v_exp_f32 v90, v90
    v_exp_f32 v91, v91
    v_cvt_pk_bf16_f32 v111, v86, v87
    v_cvt_pk_bf16_f32 v112, v88, v89
    v_mfma_f32_32x32x16_bf16 v[72:87], v[20:23], v[8:11], v[40:55]
    ds_read_b128 v[32:35], v5 offset:14560
    v_exp_f32 v92, v92
    v_exp_f32 v93, v93
    v_cvt_pk_bf16_f32 v113, v90, v91
    v_exp_f32 v94, v94
    v_exp_f32 v95, v95
    v_cvt_pk_bf16_f32 v114, v92, v93
    v_mfma_f32_32x32x16_bf16 v[120:135], v[24:27], v[104:107], v[120:135]
    ds_read_b128 v[36:39], v5 offset:14576
    v_exp_f32 v96, v96
    v_exp_f32 v97, v97
    v_cvt_pk_bf16_f32 v115, v94, v95
    v_exp_f32 v98, v98
    v_exp_f32 v99, v99
    v_cvt_pk_bf16_f32 v116, v96, v97
    v_mfma_f32_32x32x16_bf16 v[120:135], v[28:31], v[108:111], v[120:135]
    ds_read_b128 v[16:19], v4 offset:16640
    v_exp_f32 v100, v100
    v_exp_f32 v101, v101
    v_cvt_pk_bf16_f32 v117, v98, v99
    v_exp_f32 v102, v102
    v_exp_f32 v103, v103
    v_exp_f32 v72, v72
    v_exp_f32 v73, v73
    v_cvt_pk_bf16_f32 v118, v100, v101
    v_exp_f32 v74, v74
    v_exp_f32 v75, v75
    v_cvt_pk_bf16_f32 v119, v102, v103
    v_cvt_pk_bf16_f32 v104, v72, v73
    v_mfma_f32_32x32x16_bf16 v[88:103], v[20:23], v[12:15], v[56:71]
    buffer_load_dwordx4 v231, s[4:7], s57 offen sc1 lds
    v_exp_f32 v76, v76
    v_exp_f32 v77, v77
    v_cvt_pk_bf16_f32 v105, v74, v75
    v_exp_f32 v78, v78
    v_exp_f32 v79, v79
    v_cvt_pk_bf16_f32 v106, v76, v77
    v_mfma_f32_32x32x16_bf16 v[136:151], v[24:27], v[112:115], v[136:151]
    buffer_load_dwordx4 v231, s[4:7], s57 offen offset:1024 sc1 lds
    v_exp_f32 v80, v80
    v_exp_f32 v81, v81
    v_cvt_pk_bf16_f32 v107, v78, v79
    v_exp_f32 v82, v82
    v_exp_f32 v83, v83
    v_cvt_pk_bf16_f32 v108, v80, v81
    v_mfma_f32_32x32x16_bf16 v[136:151], v[28:31], v[116:119], v[136:151]
    s_waitcnt lgkmcnt(0)
    v_exp_f32 v84, v84
    v_exp_f32 v85, v85
    v_cvt_pk_bf16_f32 v109, v82, v83
    v_exp_f32 v86, v86
    v_exp_f32 v87, v87
    v_exp_f32 v88, v88
    v_exp_f32 v89, v89
    v_cvt_pk_bf16_f32 v110, v84, v85
    v_exp_f32 v90, v90
    v_exp_f32 v91, v91
    v_cvt_pk_bf16_f32 v111, v86, v87
    v_cvt_pk_bf16_f32 v112, v88, v89
    v_mfma_f32_32x32x16_bf16 v[72:87], v[16:19], v[8:11], v[40:55]
    ds_read_b128 v[24:27], v5 offset:16640
    v_exp_f32 v92, v92
    v_exp_f32 v93, v93
    v_cvt_pk_bf16_f32 v113, v90, v91
    v_exp_f32 v94, v94
    v_exp_f32 v95, v95
    v_cvt_pk_bf16_f32 v114, v92, v93
    v_mfma_f32_32x32x16_bf16 v[120:135], v[32:35], v[104:107], v[120:135]
    ds_read_b128 v[28:31], v5 offset:16656
    v_exp_f32 v96, v96
    v_exp_f32 v97, v97
    v_cvt_pk_bf16_f32 v115, v94, v95
    v_exp_f32 v98, v98
    v_exp_f32 v99, v99
    v_cvt_pk_bf16_f32 v116, v96, v97
    v_mfma_f32_32x32x16_bf16 v[120:135], v[36:39], v[108:111], v[120:135]
    ds_read_b128 v[20:23], v4 offset:18720
    v_exp_f32 v100, v100
    v_exp_f32 v101, v101
    v_cvt_pk_bf16_f32 v117, v98, v99
    v_exp_f32 v102, v102
    v_exp_f32 v103, v103
    v_exp_f32 v72, v72
    v_exp_f32 v73, v73
    v_cvt_pk_bf16_f32 v118, v100, v101
    v_exp_f32 v74, v74
    v_exp_f32 v75, v75
    v_cvt_pk_bf16_f32 v119, v102, v103
    v_cvt_pk_bf16_f32 v104, v72, v73
    v_mfma_f32_32x32x16_bf16 v[88:103], v[16:19], v[12:15], v[56:71]
    buffer_load_dwordx4 v1, s[4:7], s57 offen offset:2080 sc1 lds
    v_exp_f32 v76, v76
    v_exp_f32 v77, v77
    v_cvt_pk_bf16_f32 v105, v74, v75
    v_exp_f32 v78, v78
    v_exp_f32 v79, v79
    v_cvt_pk_bf16_f32 v106, v76, v77
    v_mfma_f32_32x32x16_bf16 v[136:151], v[32:35], v[112:115], v[136:151]
    buffer_load_dwordx4 v1, s[4:7], s57 offen offset:3104 sc1 lds
    s_add_u32 s57, s57, 16384
    v_exp_f32 v80, v80
    v_exp_f32 v81, v81
    v_cvt_pk_bf16_f32 v107, v78, v79
    v_exp_f32 v82, v82
    v_exp_f32 v83, v83
    v_cvt_pk_bf16_f32 v108, v80, v81
    v_mfma_f32_32x32x16_bf16 v[136:151], v[36:39], v[116:119], v[136:151]
    s_waitcnt vmcnt(10) lgkmcnt(0)
    v_exp_f32 v84, v84
    v_exp_f32 v85, v85
    v_cvt_pk_bf16_f32 v109, v82, v83
    v_exp_f32 v86, v86
    v_exp_f32 v87, v87
    v_exp_f32 v88, v88
    v_exp_f32 v89, v89
    v_cvt_pk_bf16_f32 v110, v84, v85
    v_exp_f32 v90, v90
    v_exp_f32 v91, v91
    v_cvt_pk_bf16_f32 v111, v86, v87
    v_cvt_pk_bf16_f32 v112, v88, v89
    v_mfma_f32_32x32x16_bf16 v[72:87], v[20:23], v[8:11], v[40:55]
    ds_read_b128 v[32:35], v5 offset:18720
    ds_read_b64_tr_b16 v[152:153], v241 offset:0
    v_exp_f32 v92, v92
    v_exp_f32 v93, v93
    v_cvt_pk_bf16_f32 v113, v90, v91
    v_exp_f32 v94, v94
    v_exp_f32 v95, v95
    v_cvt_pk_bf16_f32 v114, v92, v93
    v_mfma_f32_32x32x16_bf16 v[120:135], v[24:27], v[104:107], v[120:135]
    ds_read_b128 v[36:39], v5 offset:18736
    ds_read_b64_tr_b16 v[156:157], v241 offset:64
    v_exp_f32 v96, v96
    v_exp_f32 v97, v97
    v_cvt_pk_bf16_f32 v115, v94, v95
    v_exp_f32 v98, v98
    v_exp_f32 v99, v99
    v_cvt_pk_bf16_f32 v116, v96, v97
    v_mfma_f32_32x32x16_bf16 v[120:135], v[28:31], v[108:111], v[120:135]
    ds_read_b128 v[16:19], v4 offset:20800
    v_exp_f32 v100, v100
    v_exp_f32 v101, v101
    v_cvt_pk_bf16_f32 v117, v98, v99
    v_exp_f32 v102, v102
    v_exp_f32 v103, v103
    v_exp_f32 v72, v72
    v_exp_f32 v73, v73
    v_cvt_pk_bf16_f32 v118, v100, v101
    v_exp_f32 v74, v74
    v_exp_f32 v75, v75
    v_cvt_pk_bf16_f32 v119, v102, v103
    v_cvt_pk_bf16_f32 v104, v72, v73
    v_mfma_f32_32x32x16_bf16 v[88:103], v[20:23], v[12:15], v[56:71]
    v_exp_f32 v76, v76
    v_exp_f32 v77, v77
    v_cvt_pk_bf16_f32 v105, v74, v75
    v_exp_f32 v78, v78
    v_exp_f32 v79, v79
    v_cvt_pk_bf16_f32 v106, v76, v77
    v_mfma_f32_32x32x16_bf16 v[136:151], v[24:27], v[112:115], v[136:151]
    v_exp_f32 v80, v80
    v_exp_f32 v81, v81
    v_cvt_pk_bf16_f32 v107, v78, v79
    v_exp_f32 v82, v82
    v_exp_f32 v83, v83
    v_cvt_pk_bf16_f32 v108, v80, v81
    v_mfma_f32_32x32x16_bf16 v[136:151], v[28:31], v[116:119], v[136:151]
    s_waitcnt lgkmcnt(0)
    v_exp_f32 v84, v84
    v_exp_f32 v85, v85
    v_cvt_pk_bf16_f32 v109, v82, v83
    v_exp_f32 v86, v86
    v_exp_f32 v87, v87
    v_exp_f32 v88, v88
    v_exp_f32 v89, v89
    v_cvt_pk_bf16_f32 v110, v84, v85
    v_exp_f32 v90, v90
    v_exp_f32 v91, v91
    v_cvt_pk_bf16_f32 v111, v86, v87
    v_cvt_pk_bf16_f32 v112, v88, v89
    v_mfma_f32_32x32x16_bf16 v[72:87], v[16:19], v[8:11], v[40:55]
    ds_read_b128 v[24:27], v5 offset:20800
    ds_read_b64_tr_b16 v[160:161], v243 offset:0
    v_exp_f32 v92, v92
    v_exp_f32 v93, v93
    v_cvt_pk_bf16_f32 v113, v90, v91
    v_exp_f32 v94, v94
    v_exp_f32 v95, v95
    v_cvt_pk_bf16_f32 v114, v92, v93
    v_mfma_f32_32x32x16_bf16 v[120:135], v[32:35], v[104:107], v[120:135]
    ds_read_b128 v[28:31], v5 offset:20816
    ds_read_b64_tr_b16 v[164:165], v243 offset:64
    v_exp_f32 v96, v96
    v_exp_f32 v97, v97
    v_cvt_pk_bf16_f32 v115, v94, v95
    v_exp_f32 v98, v98
    v_exp_f32 v99, v99
    v_cvt_pk_bf16_f32 v116, v96, v97
    v_mfma_f32_32x32x16_bf16 v[120:135], v[36:39], v[108:111], v[120:135]
    ds_read_b128 v[20:23], v4 offset:22880
    v_exp_f32 v100, v100
    v_exp_f32 v101, v101
    v_cvt_pk_bf16_f32 v117, v98, v99
    v_exp_f32 v102, v102
    v_exp_f32 v103, v103
    v_exp_f32 v72, v72
    v_exp_f32 v73, v73
    v_cvt_pk_bf16_f32 v118, v100, v101
    v_exp_f32 v74, v74
    v_exp_f32 v75, v75
    v_cvt_pk_bf16_f32 v119, v102, v103
    v_cvt_pk_bf16_f32 v104, v72, v73
    v_mfma_f32_32x32x16_bf16 v[88:103], v[16:19], v[12:15], v[56:71]
    buffer_load_dword v192, v1, s[4:7], s79 offen offset:0 sc1
    v_exp_f32 v76, v76
    v_exp_f32 v77, v77
    v_cvt_pk_bf16_f32 v105, v74, v75
    v_exp_f32 v78, v78
    v_exp_f32 v79, v79
    v_cvt_pk_bf16_f32 v106, v76, v77
    v_mfma_f32_32x32x16_bf16 v[136:151], v[32:35], v[112:115], v[136:151]
    buffer_load_dword v193, v1, s[4:7], s79 offen offset:1024 sc1
    v_exp_f32 v80, v80
    v_exp_f32 v81, v81
    v_cvt_pk_bf16_f32 v107, v78, v79
    v_exp_f32 v82, v82
    v_exp_f32 v83, v83
    v_cvt_pk_bf16_f32 v108, v80, v81
    v_mfma_f32_32x32x16_bf16 v[136:151], v[36:39], v[116:119], v[136:151]
    s_waitcnt vmcnt(10) lgkmcnt(0)
    v_exp_f32 v84, v84
    v_exp_f32 v85, v85
    v_cvt_pk_bf16_f32 v109, v82, v83
    v_exp_f32 v86, v86
    v_exp_f32 v87, v87
    v_exp_f32 v88, v88
    v_exp_f32 v89, v89
    v_cvt_pk_bf16_f32 v110, v84, v85
    v_exp_f32 v90, v90
    v_exp_f32 v91, v91
    v_cvt_pk_bf16_f32 v111, v86, v87
    v_cvt_pk_bf16_f32 v112, v88, v89
    v_mfma_f32_32x32x16_bf16 v[72:87], v[20:23], v[8:11], v[40:55]
    ds_read_b128 v[32:35], v5 offset:22880
    ds_read_b64_tr_b16 v[154:155], v241 offset:2080
    v_exp_f32 v92, v92
    v_exp_f32 v93, v93
    v_cvt_pk_bf16_f32 v113, v90, v91
    v_exp_f32 v94, v94
    v_exp_f32 v95, v95
    v_cvt_pk_bf16_f32 v114, v92, v93
    v_mfma_f32_32x32x16_bf16 v[120:135], v[24:27], v[104:107], v[120:135]
    ds_read_b128 v[36:39], v5 offset:22896
    ds_read_b64_tr_b16 v[158:159], v241 offset:2144
    v_exp_f32 v96, v96
    v_exp_f32 v97, v97
    v_cvt_pk_bf16_f32 v115, v94, v95
    v_exp_f32 v98, v98
    v_exp_f32 v99, v99
    v_cvt_pk_bf16_f32 v116, v96, v97
    v_mfma_f32_32x32x16_bf16 v[120:135], v[28:31], v[108:111], v[120:135]
    ds_read_b128 v[16:19], v4 offset:24960
    v_exp_f32 v100, v100
    v_exp_f32 v101, v101
    v_cvt_pk_bf16_f32 v117, v98, v99
    v_exp_f32 v102, v102
    v_exp_f32 v103, v103
    v_exp_f32 v72, v72
    v_exp_f32 v73, v73
    v_cvt_pk_bf16_f32 v118, v100, v101
    v_exp_f32 v74, v74
    v_exp_f32 v75, v75
    v_cvt_pk_bf16_f32 v119, v102, v103
    v_cvt_pk_bf16_f32 v104, v72, v73
    v_mfma_f32_32x32x16_bf16 v[88:103], v[20:23], v[12:15], v[56:71]
    buffer_load_dword v194, v1, s[4:7], s79 offen offset:2048 sc1
    v_exp_f32 v76, v76
    v_exp_f32 v77, v77
    v_cvt_pk_bf16_f32 v105, v74, v75
    v_exp_f32 v78, v78
    v_exp_f32 v79, v79
    v_cvt_pk_bf16_f32 v106, v76, v77
    v_mfma_f32_32x32x16_bf16 v[136:151], v[24:27], v[112:115], v[136:151]
    buffer_load_dword v195, v1, s[4:7], s79 offen offset:3072 sc1
    v_exp_f32 v80, v80
    v_exp_f32 v81, v81
    v_cvt_pk_bf16_f32 v107, v78, v79
    v_exp_f32 v82, v82
    v_exp_f32 v83, v83
    v_cvt_pk_bf16_f32 v108, v80, v81
    v_mfma_f32_32x32x16_bf16 v[136:151], v[28:31], v[116:119], v[136:151]
    s_waitcnt lgkmcnt(0)
    v_exp_f32 v84, v84
    v_exp_f32 v85, v85
    v_cvt_pk_bf16_f32 v109, v82, v83
    v_exp_f32 v86, v86
    v_exp_f32 v87, v87
    v_exp_f32 v88, v88
    v_exp_f32 v89, v89
    v_cvt_pk_bf16_f32 v110, v84, v85
    v_exp_f32 v90, v90
    v_exp_f32 v91, v91
    v_cvt_pk_bf16_f32 v111, v86, v87
    v_cvt_pk_bf16_f32 v112, v88, v89
    v_mfma_f32_32x32x16_bf16 v[72:87], v[16:19], v[8:11], v[40:55]
    ds_read_b128 v[24:27], v5 offset:24960
    ds_read_b64_tr_b16 v[162:163], v243 offset:2080
    v_exp_f32 v92, v92
    v_exp_f32 v93, v93
    v_cvt_pk_bf16_f32 v113, v90, v91
    v_exp_f32 v94, v94
    v_exp_f32 v95, v95
    v_cvt_pk_bf16_f32 v114, v92, v93
    v_mfma_f32_32x32x16_bf16 v[120:135], v[32:35], v[104:107], v[120:135]
    ds_read_b128 v[28:31], v5 offset:24976
    ds_read_b64_tr_b16 v[166:167], v243 offset:2144
    v_exp_f32 v96, v96
    v_exp_f32 v97, v97
    v_cvt_pk_bf16_f32 v115, v94, v95
    v_exp_f32 v98, v98
    v_exp_f32 v99, v99
    v_cvt_pk_bf16_f32 v116, v96, v97
    v_mfma_f32_32x32x16_bf16 v[120:135], v[36:39], v[108:111], v[120:135]
    ds_read_b128 v[20:23], v4 offset:27040
    v_exp_f32 v100, v100
    v_exp_f32 v101, v101
    v_cvt_pk_bf16_f32 v117, v98, v99
    v_exp_f32 v102, v102
    v_exp_f32 v103, v103
    v_exp_f32 v72, v72
    v_exp_f32 v73, v73
    v_cvt_pk_bf16_f32 v118, v100, v101
    v_exp_f32 v74, v74
    v_exp_f32 v75, v75
    v_cvt_pk_bf16_f32 v119, v102, v103
    v_cvt_pk_bf16_f32 v104, v72, v73
    v_mfma_f32_32x32x16_bf16 v[88:103], v[16:19], v[12:15], v[56:71]
    v_exp_f32 v76, v76
    v_exp_f32 v77, v77
    v_cvt_pk_bf16_f32 v105, v74, v75
    v_exp_f32 v78, v78
    v_exp_f32 v79, v79
    v_cvt_pk_bf16_f32 v106, v76, v77
    v_mfma_f32_32x32x16_bf16 v[136:151], v[32:35], v[112:115], v[136:151]
    v_exp_f32 v80, v80
    v_exp_f32 v81, v81
    v_cvt_pk_bf16_f32 v107, v78, v79
    v_exp_f32 v82, v82
    v_exp_f32 v83, v83
    v_cvt_pk_bf16_f32 v108, v80, v81
    v_mfma_f32_32x32x16_bf16 v[136:151], v[36:39], v[116:119], v[136:151]
    s_waitcnt vmcnt(10) lgkmcnt(0)
    v_exp_f32 v84, v84
    v_exp_f32 v85, v85
    v_cvt_pk_bf16_f32 v109, v82, v83
    v_exp_f32 v86, v86
    v_exp_f32 v87, v87
    v_exp_f32 v88, v88
    v_exp_f32 v89, v89
    v_cvt_pk_bf16_f32 v110, v84, v85
    v_exp_f32 v90, v90
    v_exp_f32 v91, v91
    v_cvt_pk_bf16_f32 v111, v86, v87
    v_cvt_pk_bf16_f32 v112, v88, v89
    v_mfma_f32_32x32x16_bf16 v[72:87], v[20:23], v[8:11], v[40:55]
    ds_read_b128 v[32:35], v5 offset:27040
    ds_read_b64_tr_b16 v[168:169], v241 offset:4160
    v_exp_f32 v92, v92
    v_exp_f32 v93, v93
    v_cvt_pk_bf16_f32 v113, v90, v91
    v_exp_f32 v94, v94
    v_exp_f32 v95, v95
    v_cvt_pk_bf16_f32 v114, v92, v93
    v_mfma_f32_32x32x16_bf16 v[120:135], v[24:27], v[104:107], v[120:135]
    ds_read_b128 v[36:39], v5 offset:27056
    ds_read_b64_tr_b16 v[172:173], v241 offset:4224
    v_exp_f32 v96, v96
    v_exp_f32 v97, v97
    v_cvt_pk_bf16_f32 v115, v94, v95
    v_exp_f32 v98, v98
    v_exp_f32 v99, v99
    v_cvt_pk_bf16_f32 v116, v96, v97
    v_mfma_f32_32x32x16_bf16 v[120:135], v[28:31], v[108:111], v[120:135]
    ds_read_b128 v[16:19], v4 offset:29120
    v_exp_f32 v100, v100
    v_exp_f32 v101, v101
    v_cvt_pk_bf16_f32 v117, v98, v99
    v_exp_f32 v102, v102
    v_exp_f32 v103, v103
    v_exp_f32 v72, v72
    v_exp_f32 v73, v73
    v_cvt_pk_bf16_f32 v118, v100, v101
    v_exp_f32 v74, v74
    v_exp_f32 v75, v75
    v_cvt_pk_bf16_f32 v119, v102, v103
    v_cvt_pk_bf16_f32 v104, v72, v73
    v_mfma_f32_32x32x16_bf16 v[88:103], v[20:23], v[12:15], v[56:71]
    buffer_store_dwordx4 v[152:155], v1, s[4:7], s98 offen offset:0 sc1
    s_add_u32 s46, s98, s100
    v_exp_f32 v76, v76
    v_exp_f32 v77, v77
    v_cvt_pk_bf16_f32 v105, v74, v75
    v_exp_f32 v78, v78
    v_exp_f32 v79, v79
    v_cvt_pk_bf16_f32 v106, v76, v77
    v_mfma_f32_32x32x16_bf16 v[136:151], v[24:27], v[112:115], v[136:151]
    buffer_store_dwordx4 v[156:159], v1, s[4:7], s46 offen offset:0 sc1
    s_add_u32 s46, s98, s101
    v_exp_f32 v80, v80
    v_exp_f32 v81, v81
    v_cvt_pk_bf16_f32 v107, v78, v79
    v_exp_f32 v82, v82
    v_exp_f32 v83, v83
    v_cvt_pk_bf16_f32 v108, v80, v81
    v_mfma_f32_32x32x16_bf16 v[136:151], v[28:31], v[116:119], v[136:151]
    s_waitcnt lgkmcnt(0)
    v_exp_f32 v84, v84
    v_exp_f32 v85, v85
    v_cvt_pk_bf16_f32 v109, v82, v83
    v_mfma_f32_16x16x32_bf16 v[184:187], v[200:203], v[152:155], 0
    v_exp_f32 v86, v86
    v_exp_f32 v87, v87
    v_exp_f32 v88, v88
    v_exp_f32 v89, v89
    v_cvt_pk_bf16_f32 v110, v84, v85
    v_exp_f32 v90, v90
    v_exp_f32 v91, v91
    v_cvt_pk_bf16_f32 v111, v86, v87
    v_cvt_pk_bf16_f32 v112, v88, v89
    v_mfma_f32_32x32x16_bf16 v[72:87], v[16:19], v[8:11], v[40:55]
    ds_read_b128 v[24:27], v5 offset:29120
    ds_read_b64_tr_b16 v[176:177], v243 offset:4160
    v_exp_f32 v92, v92
    v_exp_f32 v93, v93
    v_cvt_pk_bf16_f32 v113, v90, v91
    v_exp_f32 v94, v94
    v_exp_f32 v95, v95
    v_cvt_pk_bf16_f32 v114, v92, v93
    v_mfma_f32_32x32x16_bf16 v[120:135], v[32:35], v[104:107], v[120:135]
    ds_read_b128 v[28:31], v5 offset:29136
    ds_read_b64_tr_b16 v[180:181], v243 offset:4224
    v_exp_f32 v96, v96
    v_exp_f32 v97, v97
    v_cvt_pk_bf16_f32 v115, v94, v95
    v_exp_f32 v98, v98
    v_exp_f32 v99, v99
    v_cvt_pk_bf16_f32 v116, v96, v97
    v_mfma_f32_32x32x16_bf16 v[120:135], v[36:39], v[108:111], v[120:135]
    ds_read_b128 v[20:23], v4 offset:31200
    v_exp_f32 v100, v100
    v_exp_f32 v101, v101
    v_cvt_pk_bf16_f32 v117, v98, v99
    v_mfma_f32_16x16x32_bf16 v[188:191], v[200:203], v[156:159], 0
    v_exp_f32 v102, v102
    v_exp_f32 v103, v103
    v_exp_f32 v72, v72
    v_exp_f32 v73, v73
    v_cvt_pk_bf16_f32 v118, v100, v101
    v_exp_f32 v74, v74
    v_exp_f32 v75, v75
    v_cvt_pk_bf16_f32 v119, v102, v103
    v_cvt_pk_bf16_f32 v104, v72, v73
    v_mfma_f32_32x32x16_bf16 v[88:103], v[16:19], v[12:15], v[56:71]
    buffer_store_dwordx4 v[160:163], v1, s[4:7], s46 offen offset:0 sc1
    s_add_u32 s46, s46, s100
    v_exp_f32 v76, v76
    v_exp_f32 v77, v77
    v_cvt_pk_bf16_f32 v105, v74, v75
    v_exp_f32 v78, v78
    v_exp_f32 v79, v79
    v_cvt_pk_bf16_f32 v106, v76, v77
    v_mfma_f32_32x32x16_bf16 v[136:151], v[32:35], v[112:115], v[136:151]
    buffer_store_dwordx4 v[164:167], v1, s[4:7], s46 offen offset:0 sc1
    s_add_u32 m0, s58, 49920
    v_exp_f32 v80, v80
    v_exp_f32 v81, v81
    v_cvt_pk_bf16_f32 v107, v78, v79
    v_exp_f32 v82, v82
    v_exp_f32 v83, v83
    v_cvt_pk_bf16_f32 v108, v80, v81
    v_mfma_f32_32x32x16_bf16 v[136:151], v[36:39], v[116:119], v[136:151]
    s_waitcnt vmcnt(8) lgkmcnt(0)
    s_barrier
    v_exp_f32 v84, v84
    v_exp_f32 v85, v85
    v_cvt_pk_bf16_f32 v109, v82, v83
    v_mfma_f32_16x16x32_bf16 v[204:207], v[200:203], v[160:163], 0
    v_exp_f32 v86, v86
    v_exp_f32 v87, v87
    v_exp_f32 v88, v88
    v_exp_f32 v89, v89
    v_cvt_pk_bf16_f32 v110, v84, v85
    v_exp_f32 v90, v90
    v_exp_f32 v91, v91
    v_cvt_pk_bf16_f32 v111, v86, v87
    v_cvt_pk_bf16_f32 v112, v88, v89
    v_mfma_f32_32x32x16_bf16 v[72:87], v[20:23], v[8:11], v[40:55]
    ds_read_b128 v[32:35], v5 offset:31200
    ds_read_b64_tr_b16 v[170:171], v241 offset:6240
    v_exp_f32 v92, v92
    v_exp_f32 v93, v93
    v_cvt_pk_bf16_f32 v113, v90, v91
    v_exp_f32 v94, v94
    v_exp_f32 v95, v95
    v_cvt_pk_bf16_f32 v114, v92, v93
    v_mfma_f32_32x32x16_bf16 v[120:135], v[24:27], v[104:107], v[120:135]
    ds_read_b128 v[36:39], v5 offset:31216
    ds_read_b64_tr_b16 v[174:175], v241 offset:6304
    v_exp_f32 v96, v96
    v_exp_f32 v97, v97
    v_cvt_pk_bf16_f32 v115, v94, v95
    v_exp_f32 v98, v98
    v_exp_f32 v99, v99
    v_cvt_pk_bf16_f32 v116, v96, v97
    v_mfma_f32_32x32x16_bf16 v[120:135], v[28:31], v[108:111], v[120:135]
    ds_read_b128 v[16:19], v4 offset:33280
    v_exp_f32 v100, v100
    v_exp_f32 v101, v101
    v_cvt_pk_bf16_f32 v117, v98, v99
    v_mfma_f32_16x16x32_bf16 v[208:211], v[200:203], v[164:167], 0
    v_exp_f32 v102, v102
    v_exp_f32 v103, v103
    v_exp_f32 v72, v72
    v_exp_f32 v73, v73
    v_cvt_pk_bf16_f32 v118, v100, v101
    v_exp_f32 v74, v74
    v_exp_f32 v75, v75
    v_cvt_pk_bf16_f32 v119, v102, v103
    v_cvt_pk_bf16_f32 v104, v72, v73
    v_mfma_f32_32x32x16_bf16 v[88:103], v[20:23], v[12:15], v[56:71]
    buffer_load_dwordx4 v231, s[4:7], s57 offen sc1 lds
    v_exp_f32 v76, v76
    v_exp_f32 v77, v77
    v_cvt_pk_bf16_f32 v105, v74, v75
    v_exp_f32 v78, v78
    v_exp_f32 v79, v79
    v_cvt_pk_bf16_f32 v106, v76, v77
    v_mfma_f32_32x32x16_bf16 v[136:151], v[24:27], v[112:115], v[136:151]
    buffer_load_dwordx4 v231, s[4:7], s57 offen offset:1024 sc1 lds
    v_exp_f32 v80, v80
    v_exp_f32 v81, v81
    v_cvt_pk_bf16_f32 v107, v78, v79
    v_exp_f32 v82, v82
    v_exp_f32 v83, v83
    v_cvt_pk_bf16_f32 v108, v80, v81
    v_mfma_f32_32x32x16_bf16 v[136:151], v[28:31], v[116:119], v[136:151]
    s_waitcnt lgkmcnt(0)
    v_exp_f32 v84, v84
    v_exp_f32 v85, v85
    v_cvt_pk_bf16_f32 v109, v82, v83
    v_exp_f32 v86, v86
    v_exp_f32 v87, v87
    v_exp_f32 v88, v88
    v_exp_f32 v89, v89
    v_cvt_pk_bf16_f32 v110, v84, v85
    v_exp_f32 v90, v90
    v_exp_f32 v91, v91
    v_cvt_pk_bf16_f32 v111, v86, v87
    v_cvt_pk_bf16_f32 v112, v88, v89
    v_mfma_f32_32x32x16_bf16 v[72:87], v[16:19], v[8:11], v[40:55]
    ds_read_b128 v[24:27], v5 offset:33280
    ds_read_b64_tr_b16 v[178:179], v243 offset:6240
    v_exp_f32 v92, v92
    v_exp_f32 v93, v93
    v_cvt_pk_bf16_f32 v113, v90, v91
    v_exp_f32 v94, v94
    v_exp_f32 v95, v95
    v_cvt_pk_bf16_f32 v114, v92, v93
    v_mfma_f32_32x32x16_bf16 v[120:135], v[32:35], v[104:107], v[120:135]
    ds_read_b128 v[28:31], v5 offset:33296
    ds_read_b64_tr_b16 v[182:183], v243 offset:6304
    v_exp_f32 v96, v96
    v_exp_f32 v97, v97
    v_cvt_pk_bf16_f32 v115, v94, v95
    v_exp_f32 v98, v98
    v_exp_f32 v99, v99
    v_cvt_pk_bf16_f32 v116, v96, v97
    v_mfma_f32_32x32x16_bf16 v[120:135], v[36:39], v[108:111], v[120:135]
    ds_read_b128 v[20:23], v4 offset:35360
    v_exp_f32 v100, v100
    v_exp_f32 v101, v101
    v_cvt_pk_bf16_f32 v117, v98, v99
    v_exp_f32 v102, v102
    v_exp_f32 v103, v103
    v_exp_f32 v72, v72
    v_exp_f32 v73, v73
    v_cvt_pk_bf16_f32 v118, v100, v101
    v_exp_f32 v74, v74
    v_exp_f32 v75, v75
    v_cvt_pk_bf16_f32 v119, v102, v103
    v_cvt_pk_bf16_f32 v104, v72, v73
    v_mfma_f32_32x32x16_bf16 v[88:103], v[16:19], v[12:15], v[56:71]
    buffer_load_dwordx4 v1, s[4:7], s57 offen offset:2080 sc1 lds
    v_exp_f32 v76, v76
    v_exp_f32 v77, v77
    v_cvt_pk_bf16_f32 v105, v74, v75
    v_exp_f32 v78, v78
    v_exp_f32 v79, v79
    v_cvt_pk_bf16_f32 v106, v76, v77
    v_mfma_f32_32x32x16_bf16 v[136:151], v[32:35], v[112:115], v[136:151]
    buffer_load_dwordx4 v1, s[4:7], s57 offen offset:3104 sc1 lds
    s_add_u32 s57, s57, 16384
    v_exp_f32 v80, v80
    v_exp_f32 v81, v81
    v_cvt_pk_bf16_f32 v107, v78, v79
    v_exp_f32 v82, v82
    v_exp_f32 v83, v83
    v_cvt_pk_bf16_f32 v108, v80, v81
    v_mfma_f32_32x32x16_bf16 v[136:151], v[36:39], v[116:119], v[136:151]
    s_waitcnt lgkmcnt(0)
    v_exp_f32 v84, v84
    v_exp_f32 v85, v85
    v_cvt_pk_bf16_f32 v109, v82, v83
    v_mfma_f32_16x16x32_bf16 v[184:187], v[200:203], v[168:171], v[184:187]
    v_exp_f32 v86, v86
    v_exp_f32 v87, v87
    v_mfma_f32_16x16x32_bf16 v[188:191], v[200:203], v[172:175], v[188:191]
    v_exp_f32 v88, v88
    v_exp_f32 v89, v89
    v_cvt_pk_bf16_f32 v110, v84, v85
    v_exp_f32 v90, v90
    v_exp_f32 v91, v91
    v_cvt_pk_bf16_f32 v111, v86, v87
    v_cvt_pk_bf16_f32 v112, v88, v89
    v_mfma_f32_32x32x16_bf16 v[72:87], v[20:23], v[8:11], v[40:55]
    ds_read_b128 v[32:35], v5 offset:35360
    v_exp_f32 v92, v92
    v_exp_f32 v93, v93
    v_cvt_pk_bf16_f32 v113, v90, v91
    v_exp_f32 v94, v94
    v_exp_f32 v95, v95
    v_cvt_pk_bf16_f32 v114, v92, v93
    v_mfma_f32_32x32x16_bf16 v[120:135], v[24:27], v[104:107], v[120:135]
    ds_read_b128 v[36:39], v5 offset:35376
    v_exp_f32 v96, v96
    v_exp_f32 v97, v97
    v_cvt_pk_bf16_f32 v115, v94, v95
    v_exp_f32 v98, v98
    v_exp_f32 v99, v99
    v_cvt_pk_bf16_f32 v116, v96, v97
    v_mfma_f32_32x32x16_bf16 v[120:135], v[28:31], v[108:111], v[120:135]
    ds_read_b128 v[16:19], v4 offset:37440
    v_exp_f32 v100, v100
    v_exp_f32 v101, v101
    v_cvt_pk_bf16_f32 v117, v98, v99
    v_mfma_f32_16x16x32_bf16 v[204:207], v[200:203], v[176:179], v[204:207]
    v_exp_f32 v102, v102
    v_exp_f32 v103, v103
    v_mfma_f32_16x16x32_bf16 v[208:211], v[200:203], v[180:183], v[208:211]
    v_exp_f32 v72, v72
    v_exp_f32 v73, v73
    v_cvt_pk_bf16_f32 v118, v100, v101
    v_exp_f32 v74, v74
    v_exp_f32 v75, v75
    v_cvt_pk_bf16_f32 v119, v102, v103
    v_cvt_pk_bf16_f32 v104, v72, v73
    v_mfma_f32_32x32x16_bf16 v[88:103], v[20:23], v[12:15], v[56:71]
    buffer_store_dwordx4 v[168:171], v1, s[20:23], s98 offen offset:1024 sc1
    s_add_u32 s46, s98, s100
    v_exp_f32 v76, v76
    v_exp_f32 v77, v77
    v_cvt_pk_bf16_f32 v105, v74, v75
    v_exp_f32 v78, v78
    v_exp_f32 v79, v79
    v_cvt_pk_bf16_f32 v106, v76, v77
    v_mfma_f32_32x32x16_bf16 v[136:151], v[24:27], v[112:115], v[136:151]
    buffer_store_dwordx4 v[172:175], v1, s[20:23], s46 offen offset:1024 sc1
    s_add_u32 s46, s98, s101
    v_exp_f32 v80, v80
    v_exp_f32 v81, v81
    v_cvt_pk_bf16_f32 v107, v78, v79
    v_exp_f32 v82, v82
    v_exp_f32 v83, v83
    v_cvt_pk_bf16_f32 v108, v80, v81
    v_mfma_f32_32x32x16_bf16 v[136:151], v[28:31], v[116:119], v[136:151]
    s_waitcnt lgkmcnt(0)
    v_exp_f32 v84, v84
    v_exp_f32 v85, v85
    v_cvt_pk_bf16_f32 v109, v82, v83
    v_exp_f32 v86, v86
    v_exp_f32 v87, v87
    v_exp_f32 v88, v88
    v_exp_f32 v89, v89
    v_cvt_pk_bf16_f32 v110, v84, v85
    v_exp_f32 v90, v90
    v_exp_f32 v91, v91
    v_cvt_pk_bf16_f32 v111, v86, v87
    v_cvt_pk_bf16_f32 v112, v88, v89
    v_mfma_f32_32x32x16_bf16 v[72:87], v[16:19], v[8:11], v[40:55]
    ds_read_b128 v[24:27], v5 offset:37440
    v_exp_f32 v92, v92
    v_exp_f32 v93, v93
    v_cvt_pk_bf16_f32 v113, v90, v91
    v_exp_f32 v94, v94
    v_exp_f32 v95, v95
    v_cvt_pk_bf16_f32 v114, v92, v93
    v_mfma_f32_32x32x16_bf16 v[120:135], v[32:35], v[104:107], v[120:135]
    ds_read_b128 v[28:31], v5 offset:37456
    v_exp_f32 v96, v96
    v_exp_f32 v97, v97
    v_cvt_pk_bf16_f32 v115, v94, v95
    v_exp_f32 v98, v98
    v_exp_f32 v99, v99
    v_cvt_pk_bf16_f32 v116, v96, v97
    v_mfma_f32_32x32x16_bf16 v[120:135], v[36:39], v[108:111], v[120:135]
    ds_read_b128 v[20:23], v4 offset:39520
    ds_write_b32 v212, v184 offset:0
    ds_write_b32 v212, v188 offset:512
    ds_write_b32 v212, v204 offset:1024
    ds_write_b32 v212, v208 offset:1536
    v_exp_f32 v100, v100
    v_exp_f32 v101, v101
    v_cvt_pk_bf16_f32 v117, v98, v99
    v_exp_f32 v102, v102
    v_exp_f32 v103, v103
    v_exp_f32 v72, v72
    v_exp_f32 v73, v73
    v_cvt_pk_bf16_f32 v118, v100, v101
    v_exp_f32 v74, v74
    v_exp_f32 v75, v75
    v_cvt_pk_bf16_f32 v119, v102, v103
    v_cvt_pk_bf16_f32 v104, v72, v73
    v_mfma_f32_32x32x16_bf16 v[88:103], v[16:19], v[12:15], v[56:71]
    buffer_store_dwordx4 v[176:179], v1, s[20:23], s46 offen offset:1024 sc1
    s_add_u32 s46, s46, s100
    v_exp_f32 v76, v76
    v_exp_f32 v77, v77
    v_cvt_pk_bf16_f32 v105, v74, v75
    v_exp_f32 v78, v78
    v_exp_f32 v79, v79
    v_cvt_pk_bf16_f32 v106, v76, v77
    v_mfma_f32_32x32x16_bf16 v[136:151], v[32:35], v[112:115], v[136:151]
    buffer_store_dwordx4 v[180:183], v1, s[20:23], s46 offen offset:1024 sc1
    s_add_u32 m0, s58, 66560
    v_exp_f32 v80, v80
    v_exp_f32 v81, v81
    v_cvt_pk_bf16_f32 v107, v78, v79
    v_exp_f32 v82, v82
    v_exp_f32 v83, v83
    v_cvt_pk_bf16_f32 v108, v80, v81
    v_mfma_f32_32x32x16_bf16 v[136:151], v[36:39], v[116:119], v[136:151]
    s_waitcnt lgkmcnt(0)
    s_barrier
    v_exp_f32 v84, v84
    v_exp_f32 v85, v85
    v_cvt_pk_bf16_f32 v109, v82, v83
    v_exp_f32 v86, v86
    v_exp_f32 v87, v87
    v_exp_f32 v88, v88
    v_exp_f32 v89, v89
    v_cvt_pk_bf16_f32 v110, v84, v85
    v_exp_f32 v90, v90
    v_exp_f32 v91, v91
    v_cvt_pk_bf16_f32 v111, v86, v87
    v_cvt_pk_bf16_f32 v112, v88, v89
    v_mfma_f32_32x32x16_bf16 v[72:87], v[20:23], v[8:11], v[40:55]
    ds_read_b128 v[32:35], v5 offset:39520
    v_exp_f32 v92, v92
    v_exp_f32 v93, v93
    v_cvt_pk_bf16_f32 v113, v90, v91
    v_exp_f32 v94, v94
    v_exp_f32 v95, v95
    v_cvt_pk_bf16_f32 v114, v92, v93
    v_mfma_f32_32x32x16_bf16 v[120:135], v[24:27], v[104:107], v[120:135]
    ds_read_b128 v[36:39], v5 offset:39536
    v_exp_f32 v96, v96
    v_exp_f32 v97, v97
    v_cvt_pk_bf16_f32 v115, v94, v95
    v_exp_f32 v98, v98
    v_exp_f32 v99, v99
    v_cvt_pk_bf16_f32 v116, v96, v97
    v_mfma_f32_32x32x16_bf16 v[120:135], v[28:31], v[108:111], v[120:135]
    ds_read_b128 v[16:19], v4 offset:41600
    ds_read_b128 v[184:187], v213
    v_exp_f32 v100, v100
    v_exp_f32 v101, v101
    v_cvt_pk_bf16_f32 v117, v98, v99
    v_exp_f32 v102, v102
    v_exp_f32 v103, v103
    v_exp_f32 v72, v72
    v_exp_f32 v73, v73
    v_cvt_pk_bf16_f32 v118, v100, v101
    v_exp_f32 v74, v74
    v_exp_f32 v75, v75
    v_cvt_pk_bf16_f32 v119, v102, v103
    v_cvt_pk_bf16_f32 v104, v72, v73
    v_mfma_f32_32x32x16_bf16 v[88:103], v[20:23], v[12:15], v[56:71]
    buffer_load_dwordx4 v231, s[4:7], s57 offen sc1 lds
    v_exp_f32 v76, v76
    v_exp_f32 v77, v77
    v_cvt_pk_bf16_f32 v105, v74, v75
    v_exp_f32 v78, v78
    v_exp_f32 v79, v79
    v_cvt_pk_bf16_f32 v106, v76, v77
    v_mfma_f32_32x32x16_bf16 v[136:151], v[24:27], v[112:115], v[136:151]
    buffer_load_dwordx4 v231, s[4:7], s57 offen offset:1024 sc1 lds
    v_exp_f32 v80, v80
    v_exp_f32 v81, v81
    v_cvt_pk_bf16_f32 v107, v78, v79
    v_exp_f32 v82, v82
    v_exp_f32 v83, v83
    v_cvt_pk_bf16_f32 v108, v80, v81
    v_mfma_f32_32x32x16_bf16 v[136:151], v[28:31], v[116:119], v[136:151]
    s_waitcnt vmcnt(14) lgkmcnt(0)
    v_add_f32 v184, v184, v185
    v_add_f32 v186, v186, v187
    v_add_f32 v184, v184, v186
    v_cvt_pk_bf16_f32 v188, v184, v184
    v_and_b32 v185, 0xffff0000, v188
    v_sub_f32 v184, v184, v185
    v_cvt_pk_bf16_f32 v189, v184, v184
    buffer_store_dwordx2 v[188:189], v245, s[20:23], s45 offen sc1
    v_lshl_or_b32 v196, v193, 8, v192
    v_lshl_or_b32 v197, v195, 8, v194
    v_lshl_or_b32 v196, v197, 16, v196
    v_cmp_ne_u32 vcc, v196, v246
    s_cbranch_vccnz F_tabslow
F_tabback:
    s_mul_i32 s46, s63, 229376
    s_add_u32 s46, s46, 18874368
    s_lshl_b32 s31, s3, 10
    s_add_u32 s44, s46, s31
    s_lshl_b32 s45, s3, 12
    s_add_u32 s46, s46, s45
    v_add_u32 v239, 31744, v1
    v_add_u32 v240, 63488, v1
    v_add_u32 v241, 95232, v1
    s_add_u32 s80, s44, 28672
    s_add_u32 s81, s46, 131072
    s_add_u32 s82, s46, 147456
    v_exp_f32 v84, v84
    v_exp_f32 v85, v85
    v_cvt_pk_bf16_f32 v109, v82, v83
    v_exp_f32 v86, v86
    v_exp_f32 v87, v87
    v_exp_f32 v88, v88
    v_exp_f32 v89, v89
    v_cvt_pk_bf16_f32 v110, v84, v85
    v_exp_f32 v90, v90
    v_exp_f32 v91, v91
    v_cvt_pk_bf16_f32 v111, v86, v87
    v_cvt_pk_bf16_f32 v112, v88, v89
    v_mfma_f32_32x32x16_bf16 v[72:87], v[16:19], v[8:11], v[40:55]
    ds_read_b128 v[24:27], v5 offset:41600
    v_exp_f32 v92, v92
    v_exp_f32 v93, v93
    v_cvt_pk_bf16_f32 v113, v90, v91
    v_exp_f32 v94, v94
    v_exp_f32 v95, v95
    v_cvt_pk_bf16_f32 v114, v92, v93
    v_mfma_f32_32x32x16_bf16 v[120:135], v[32:35], v[104:107], v[120:135]
    ds_read_b128 v[28:31], v5 offset:41616
    v_exp_f32 v96, v96
    v_exp_f32 v97, v97
    v_cvt_pk_bf16_f32 v115, v94, v95
    v_exp_f32 v98, v98
    v_exp_f32 v99, v99
    v_cvt_pk_bf16_f32 v116, v96, v97
    v_mfma_f32_32x32x16_bf16 v[120:135], v[36:39], v[108:111], v[120:135]
    ds_read_b128 v[20:23], v4 offset:43680
    v_exp_f32 v100, v100
    v_exp_f32 v101, v101
    v_cvt_pk_bf16_f32 v117, v98, v99
    v_exp_f32 v102, v102
    v_exp_f32 v103, v103
    v_exp_f32 v72, v72
    v_exp_f32 v73, v73
    v_cvt_pk_bf16_f32 v118, v100, v101
    v_exp_f32 v74, v74
    v_exp_f32 v75, v75
    v_cvt_pk_bf16_f32 v119, v102, v103
    v_cvt_pk_bf16_f32 v104, v72, v73
    v_mfma_f32_32x32x16_bf16 v[88:103], v[16:19], v[12:15], v[56:71]
    buffer_load_dwordx4 v1, s[4:7], s57 offen offset:2080 sc1 lds
    v_exp_f32 v76, v76
    v_exp_f32 v77, v77
    v_cvt_pk_bf16_f32 v105, v74, v75
    v_exp_f32 v78, v78
    v_exp_f32 v79, v79
    v_cvt_pk_bf16_f32 v106, v76, v77
    v_mfma_f32_32x32x16_bf16 v[136:151], v[32:35], v[112:115], v[136:151]
    buffer_load_dwordx4 v1, s[4:7], s57 offen offset:3104 sc1 lds
    s_add_u32 s57, s57, 16384
    s_add_u32 m0, s58, 83200
    v_exp_f32 v80, v80
    v_exp_f32 v81, v81
    v_cvt_pk_bf16_f32 v107, v78, v79
    v_exp_f32 v82, v82
    v_exp_f32 v83, v83
    v_cvt_pk_bf16_f32 v108, v80, v81
    v_mfma_f32_32x32x16_bf16 v[136:151], v[36:39], v[116:119], v[136:151]
    s_waitcnt vmcnt(9) lgkmcnt(0)
    s_barrier
    s_cmp_lg_u32 s99, 0
    s_cbranch_scc1 F_f0b
    s_cmp_lg_u32 s3, 1
    s_cbranch_scc1 F_f0b
    v_mov_b32 v184, s68
    v_mov_b32 v185, 1
    v_writelane_b32 v184, s69, 1
    s_mov_b64 exec, 3
    buffer_store_dword v185, v184, s[4:7], 0 offen sc1
    s_mov_b64 exec, -1
F_f0b:
    v_exp_f32 v84, v84
    v_exp_f32 v85, v85
    v_cvt_pk_bf16_f32 v109, v82, v83
    v_exp_f32 v86, v86
    v_exp_f32 v87, v87
    v_exp_f32 v88, v88
    v_exp_f32 v89, v89
    v_cvt_pk_bf16_f32 v110, v84, v85
    v_exp_f32 v90, v90
    v_exp_f32 v91, v91
    v_cvt_pk_bf16_f32 v111, v86, v87
    v_cvt_pk_bf16_f32 v112, v88, v89
    v_mfma_f32_32x32x16_bf16 v[72:87], v[20:23], v[8:11], v[40:55]
    ds_read_b128 v[32:35], v5 offset:43680
    v_exp_f32 v92, v92
    v_exp_f32 v93, v93
    v_cvt_pk_bf16_f32 v113, v90, v91
    v_exp_f32 v94, v94
    v_exp_f32 v95, v95
    v_cvt_pk_bf16_f32 v114, v92, v93
    v_mfma_f32_32x32x16_bf16 v[120:135], v[24:27], v[104:107], v[120:135]
    ds_read_b128 v[36:39], v5 offset:43696
    v_exp_f32 v96, v96
    v_exp_f32 v97, v97
    v_cvt_pk_bf16_f32 v115, v94, v95
    v_exp_f32 v98, v98
    v_exp_f32 v99, v99
    v_cvt_pk_bf16_f32 v116, v96, v97
    v_mfma_f32_32x32x16_bf16 v[120:135], v[28:31], v[108:111], v[120:135]
    ds_read_b128 v[16:19], v4 offset:45760
    v_exp_f32 v100, v100
    v_exp_f32 v101, v101
    v_cvt_pk_bf16_f32 v117, v98, v99
    v_exp_f32 v102, v102
    v_exp_f32 v103, v103
    v_exp_f32 v72, v72
    v_exp_f32 v73, v73
    v_cvt_pk_bf16_f32 v118, v100, v101
    v_exp_f32 v74, v74
    v_exp_f32 v75, v75
    v_cvt_pk_bf16_f32 v119, v102, v103
    v_cvt_pk_bf16_f32 v104, v72, v73
    v_mfma_f32_32x32x16_bf16 v[88:103], v[20:23], v[12:15], v[56:71]
    buffer_load_dwordx4 v231, s[4:7], s57 offen sc1 lds
    v_exp_f32 v76, v76
    v_exp_f32 v77, v77
    v_cvt_pk_bf16_f32 v105, v74, v75
    v_exp_f32 v78, v78
    v_exp_f32 v79, v79
    v_cvt_pk_bf16_f32 v106, v76, v77
    v_mfma_f32_32x32x16_bf16 v[136:151], v[24:27], v[112:115], v[136:151]
    buffer_load_dwordx4 v231, s[4:7], s57 offen offset:1024 sc1 lds
    v_exp_f32 v80, v80
    v_exp_f32 v81, v81
    v_cvt_pk_bf16_f32 v107, v78, v79
    v_exp_f32 v82, v82
    v_exp_f32 v83, v83
    v_cvt_pk_bf16_f32 v108, v80, v81
    v_mfma_f32_32x32x16_bf16 v[136:151], v[28:31], v[116:119], v[136:151]
    s_waitcnt lgkmcnt(0)
    v_exp_f32 v84, v84
    v_exp_f32 v85, v85
    v_cvt_pk_bf16_f32 v109, v82, v83
    v_exp_f32 v86, v86
    v_exp_f32 v87, v87
    v_exp_f32 v88, v88
    v_exp_f32 v89, v89
    v_cvt_pk_bf16_f32 v110, v84, v85
    v_exp_f32 v90, v90
    v_exp_f32 v91, v91
    v_cvt_pk_bf16_f32 v111, v86, v87
    v_cvt_pk_bf16_f32 v112, v88, v89
    v_mfma_f32_32x32x16_bf16 v[72:87], v[16:19], v[8:11], v[40:55]
    ds_read_b128 v[24:27], v5 offset:45760
    v_exp_f32 v92, v92
    v_exp_f32 v93, v93
    v_cvt_pk_bf16_f32 v113, v90, v91
    v_exp_f32 v94, v94
    v_exp_f32 v95, v95
    v_cvt_pk_bf16_f32 v114, v92, v93
    v_mfma_f32_32x32x16_bf16 v[120:135], v[32:35], v[104:107], v[120:135]
    ds_read_b128 v[28:31], v5 offset:45776
    v_exp_f32 v96, v96
    v_exp_f32 v97, v97
    v_cvt_pk_bf16_f32 v115, v94, v95
    v_exp_f32 v98, v98
    v_exp_f32 v99, v99
    v_cvt_pk_bf16_f32 v116, v96, v97
    v_mfma_f32_32x32x16_bf16 v[120:135], v[36:39], v[108:111], v[120:135]
    ds_read_b128 v[20:23], v4 offset:47840
    v_exp_f32 v100, v100
    v_exp_f32 v101, v101
    v_cvt_pk_bf16_f32 v117, v98, v99
    v_exp_f32 v102, v102
    v_exp_f32 v103, v103
    v_exp_f32 v72, v72
    v_exp_f32 v73, v73
    v_cvt_pk_bf16_f32 v118, v100, v101
    v_exp_f32 v74, v74
    v_exp_f32 v75, v75
    v_cvt_pk_bf16_f32 v119, v102, v103
    v_cvt_pk_bf16_f32 v104, v72, v73
    v_mfma_f32_32x32x16_bf16 v[88:103], v[16:19], v[12:15], v[56:71]
    buffer_load_dwordx4 v1, s[4:7], s57 offen offset:2080 sc1 lds
    v_exp_f32 v76, v76
    v_exp_f32 v77, v77
    v_cvt_pk_bf16_f32 v105, v74, v75
    v_exp_f32 v78, v78
    v_exp_f32 v79, v79
    v_cvt_pk_bf16_f32 v106, v76, v77
    v_mfma_f32_32x32x16_bf16 v[136:151], v[32:35], v[112:115], v[136:151]
    buffer_load_dwordx4 v1, s[4:7], s57 offen offset:3104 sc1 lds
    s_add_u32 s57, s57, 16384
    s_add_u32 m0, s58, 99840
    v_exp_f32 v80, v80
    v_exp_f32 v81, v81
    v_cvt_pk_bf16_f32 v107, v78, v79
    v_exp_f32 v82, v82
    v_exp_f32 v83, v83
    v_cvt_pk_bf16_f32 v108, v80, v81
    v_mfma_f32_32x32x16_bf16 v[136:151], v[36:39], v[116:119], v[136:151]
    s_waitcnt lgkmcnt(0)
    v_exp_f32 v84, v84
    v_exp_f32 v85, v85
    v_cvt_pk_bf16_f32 v109, v82, v83
    v_exp_f32 v86, v86
    v_exp_f32 v87, v87
    v_exp_f32 v88, v88
    v_exp_f32 v89, v89
    v_cvt_pk_bf16_f32 v110, v84, v85
    v_exp_f32 v90, v90
    v_exp_f32 v91, v91
    v_cvt_pk_bf16_f32 v111, v86, v87
    v_cvt_pk_bf16_f32 v112, v88, v89
    v_mfma_f32_32x32x16_bf16 v[72:87], v[20:23], v[8:11], v[40:55]
    ds_read_b128 v[32:35], v5 offset:47840
    v_exp_f32 v92, v92
    v_exp_f32 v93, v93
    v_cvt_pk_bf16_f32 v113, v90, v91
    v_exp_f32 v94, v94
    v_exp_f32 v95, v95
    v_cvt_pk_bf16_f32 v114, v92, v93
    v_mfma_f32_32x32x16_bf16 v[120:135], v[24:27], v[104:107], v[120:135]
    ds_read_b128 v[36:39], v5 offset:47856
    v_exp_f32 v96, v96
    v_exp_f32 v97, v97
    v_cvt_pk_bf16_f32 v115, v94, v95
    v_exp_f32 v98, v98
    v_exp_f32 v99, v99
    v_cvt_pk_bf16_f32 v116, v96, v97
    v_mfma_f32_32x32x16_bf16 v[120:135], v[28:31], v[108:111], v[120:135]
    ds_read_b128 v[16:19], v4 offset:49920
    v_exp_f32 v100, v100
    v_exp_f32 v101, v101
    v_cvt_pk_bf16_f32 v117, v98, v99
    v_exp_f32 v102, v102
    v_exp_f32 v103, v103
    v_exp_f32 v72, v72
    v_exp_f32 v73, v73
    v_cvt_pk_bf16_f32 v118, v100, v101
    v_exp_f32 v74, v74
    v_exp_f32 v75, v75
    v_cvt_pk_bf16_f32 v119, v102, v103
    v_cvt_pk_bf16_f32 v104, v72, v73
    v_mfma_f32_32x32x16_bf16 v[88:103], v[20:23], v[12:15], v[56:71]
    buffer_load_dwordx4 v231, s[4:7], s57 offen sc1 lds
    v_exp_f32 v76, v76
    v_exp_f32 v77, v77
    v_cvt_pk_bf16_f32 v105, v74, v75
    v_exp_f32 v78, v78
    v_exp_f32 v79, v79
    v_cvt_pk_bf16_f32 v106, v76, v77
    v_mfma_f32_32x32x16_bf16 v[136:151], v[24:27], v[112:115], v[136:151]
    buffer_load_dwordx4 v231, s[4:7], s57 offen offset:1024 sc1 lds
    v_exp_f32 v80, v80
    v_exp_f32 v81, v81
    v_cvt_pk_bf16_f32 v107, v78, v79
    v_exp_f32 v82, v82
    v_exp_f32 v83, v83
    v_cvt_pk_bf16_f32 v108, v80, v81
    v_mfma_f32_32x32x16_bf16 v[136:151], v[28:31], v[116:119], v[136:151]
    s_waitcnt lgkmcnt(0)
    v_exp_f32 v84, v84
    v_exp_f32 v85, v85
    v_cvt_pk_bf16_f32 v109, v82, v83
    v_exp_f32 v86, v86
    v_exp_f32 v87, v87
    v_exp_f32 v88, v88
    v_exp_f32 v89, v89
    v_cvt_pk_bf16_f32 v110, v84, v85
    v_exp_f32 v90, v90
    v_exp_f32 v91, v91
    v_cvt_pk_bf16_f32 v111, v86, v87
    v_cvt_pk_bf16_f32 v112, v88, v89
    v_mfma_f32_32x32x16_bf16 v[72:87], v[16:19], v[8:11], v[40:55]
    ds_read_b128 v[24:27], v5 offset:49920
    v_exp_f32 v92, v92
    v_exp_f32 v93, v93
    v_cvt_pk_bf16_f32 v113, v90, v91
    v_exp_f32 v94, v94
    v_exp_f32 v95, v95
    v_cvt_pk_bf16_f32 v114, v92, v93
    v_mfma_f32_32x32x16_bf16 v[120:135], v[32:35], v[104:107], v[120:135]
    ds_read_b128 v[28:31], v5 offset:49936
    v_exp_f32 v96, v96
    v_exp_f32 v97, v97
    v_cvt_pk_bf16_f32 v115, v94, v95
    v_exp_f32 v98, v98
    v_exp_f32 v99, v99
    v_cvt_pk_bf16_f32 v116, v96, v97
    v_mfma_f32_32x32x16_bf16 v[120:135], v[36:39], v[108:111], v[120:135]
    ds_read_b128 v[20:23], v4 offset:52000
    v_exp_f32 v100, v100
    v_exp_f32 v101, v101
    v_cvt_pk_bf16_f32 v117, v98, v99
    v_exp_f32 v102, v102
    v_exp_f32 v103, v103
    v_exp_f32 v72, v72
    v_exp_f32 v73, v73
    v_cvt_pk_bf16_f32 v118, v100, v101
    v_exp_f32 v74, v74
    v_exp_f32 v75, v75
    v_cvt_pk_bf16_f32 v119, v102, v103
    v_cvt_pk_bf16_f32 v104, v72, v73
    v_mfma_f32_32x32x16_bf16 v[88:103], v[16:19], v[12:15], v[56:71]
    buffer_load_dword v232, v233, s[4:7], s42 offen sc1
    v_exp_f32 v76, v76
    v_exp_f32 v77, v77
    v_cvt_pk_bf16_f32 v105, v74, v75
    v_exp_f32 v78, v78
    v_exp_f32 v79, v79
    v_cvt_pk_bf16_f32 v106, v76, v77
    v_mfma_f32_32x32x16_bf16 v[136:151], v[32:35], v[112:115], v[136:151]
    buffer_load_dwordx4 v[216:219], v236, s[8:11], s37 offen offset:0
    v_exp_f32 v80, v80
    v_exp_f32 v81, v81
    v_cvt_pk_bf16_f32 v107, v78, v79
    v_exp_f32 v82, v82
    v_exp_f32 v83, v83
    v_cvt_pk_bf16_f32 v108, v80, v81
    v_mfma_f32_32x32x16_bf16 v[136:151], v[36:39], v[116:119], v[136:151]
    s_waitcnt lgkmcnt(0)
    v_exp_f32 v84, v84
    v_exp_f32 v85, v85
    v_cvt_pk_bf16_f32 v109, v82, v83
    v_exp_f32 v86, v86
    v_exp_f32 v87, v87
    v_exp_f32 v88, v88
    v_exp_f32 v89, v89
    v_cvt_pk_bf16_f32 v110, v84, v85
    v_exp_f32 v90, v90
    v_exp_f32 v91, v91
    v_cvt_pk_bf16_f32 v111, v86, v87
    v_cvt_pk_bf16_f32 v112, v88, v89
    v_mfma_f32_32x32x16_bf16 v[72:87], v[20:23], v[8:11], v[40:55]
    ds_read_b128 v[32:35], v5 offset:52000
    v_exp_f32 v92, v92
    v_exp_f32 v93, v93
    v_cvt_pk_bf16_f32 v113, v90, v91
    v_exp_f32 v94, v94
    v_exp_f32 v95, v95
    v_cvt_pk_bf16_f32 v114, v92, v93
    v_mfma_f32_32x32x16_bf16 v[120:135], v[24:27], v[104:107], v[120:135]
    ds_read_b128 v[36:39], v5 offset:52016
    v_exp_f32 v96, v96
    v_exp_f32 v97, v97
    v_cvt_pk_bf16_f32 v115, v94, v95
    v_exp_f32 v98, v98
    v_exp_f32 v99, v99
    v_cvt_pk_bf16_f32 v116, v96, v97
    v_mfma_f32_32x32x16_bf16 v[120:135], v[28:31], v[108:111], v[120:135]
    ds_read_b128 v[16:19], v4 offset:54080
    v_exp_f32 v100, v100
    v_exp_f32 v101, v101
    v_cvt_pk_bf16_f32 v117, v98, v99
    v_exp_f32 v102, v102
    v_exp_f32 v103, v103
    v_exp_f32 v72, v72
    v_exp_f32 v73, v73
    v_cvt_pk_bf16_f32 v118, v100, v101
    v_exp_f32 v74, v74
    v_exp_f32 v75, v75
    v_cvt_pk_bf16_f32 v119, v102, v103
    v_cvt_pk_bf16_f32 v104, v72, v73
    v_mfma_f32_32x32x16_bf16 v[88:103], v[20:23], v[12:15], v[56:71]
    buffer_load_dwordx4 v[220:223], v236, s[8:11], s37 offen offset:32
    s_mov_b64 exec, 15
    global_load_dword v248, v254, s[94:95]
    s_mov_b64 exec, -1
    v_exp_f32 v76, v76
    v_exp_f32 v77, v77
    v_cvt_pk_bf16_f32 v105, v74, v75
    v_exp_f32 v78, v78
    v_exp_f32 v79, v79
    v_cvt_pk_bf16_f32 v106, v76, v77
    v_mfma_f32_32x32x16_bf16 v[136:151], v[24:27], v[112:115], v[136:151]
    buffer_load_dwordx4 v1, s[4:7], s57 offen offset:2080 sc1 lds
    v_exp_f32 v80, v80
    v_exp_f32 v81, v81
    v_cvt_pk_bf16_f32 v107, v78, v79
    v_exp_f32 v82, v82
    v_exp_f32 v83, v83
    v_cvt_pk_bf16_f32 v108, v80, v81
    v_mfma_f32_32x32x16_bf16 v[136:151], v[28:31], v[116:119], v[136:151]
    s_waitcnt lgkmcnt(0)
    v_exp_f32 v84, v84
    v_exp_f32 v85, v85
    v_cvt_pk_bf16_f32 v109, v82, v83
    v_exp_f32 v86, v86
    v_exp_f32 v87, v87
    v_exp_f32 v88, v88
    v_exp_f32 v89, v89
    v_cvt_pk_bf16_f32 v110, v84, v85
    v_exp_f32 v90, v90
    v_exp_f32 v91, v91
    v_cvt_pk_bf16_f32 v111, v86, v87
    v_cvt_pk_bf16_f32 v112, v88, v89
    v_mfma_f32_32x32x16_bf16 v[72:87], v[16:19], v[8:11], v[40:55]
    ds_read_b128 v[24:27], v5 offset:54080
    v_exp_f32 v92, v92
    v_exp_f32 v93, v93
    v_cvt_pk_bf16_f32 v113, v90, v91
    v_exp_f32 v94, v94
    v_exp_f32 v95, v95
    v_cvt_pk_bf16_f32 v114, v92, v93
    v_mfma_f32_32x32x16_bf16 v[120:135], v[32:35], v[104:107], v[120:135]
    ds_read_b128 v[28:31], v5 offset:54096
    v_exp_f32 v96, v96
    v_exp_f32 v97, v97
    v_cvt_pk_bf16_f32 v115, v94, v95
    v_exp_f32 v98, v98
    v_exp_f32 v99, v99
    v_cvt_pk_bf16_f32 v116, v96, v97
    v_mfma_f32_32x32x16_bf16 v[120:135], v[36:39], v[108:111], v[120:135]
    ds_read_b128 v[20:23], v4 offset:56160
    v_exp_f32 v100, v100
    v_exp_f32 v101, v101
    v_cvt_pk_bf16_f32 v117, v98, v99
    v_exp_f32 v102, v102
    v_exp_f32 v103, v103
    v_exp_f32 v72, v72
    v_exp_f32 v73, v73
    v_cvt_pk_bf16_f32 v118, v100, v101
    v_exp_f32 v74, v74
    v_exp_f32 v75, v75
    v_cvt_pk_bf16_f32 v119, v102, v103
    v_cvt_pk_bf16_f32 v104, v72, v73
    v_mfma_f32_32x32x16_bf16 v[88:103], v[16:19], v[12:15], v[56:71]
    buffer_load_dwordx4 v1, s[4:7], s57 offen offset:3104 sc1 lds
    s_add_u32 s57, s57, 16384
    s_add_u32 m0, s58, 116480
    v_exp_f32 v76, v76
    v_exp_f32 v77, v77
    v_cvt_pk_bf16_f32 v105, v74, v75
    v_exp_f32 v78, v78
    v_exp_f32 v79, v79
    v_cvt_pk_bf16_f32 v106, v76, v77
    v_mfma_f32_32x32x16_bf16 v[136:151], v[32:35], v[112:115], v[136:151]
    buffer_load_dwordx4 v231, s[4:7], s57 offen sc1 lds
    v_exp_f32 v80, v80
    v_exp_f32 v81, v81
    v_cvt_pk_bf16_f32 v107, v78, v79
    v_exp_f32 v82, v82
    v_exp_f32 v83, v83
    v_cvt_pk_bf16_f32 v108, v80, v81
    v_mfma_f32_32x32x16_bf16 v[136:151], v[36:39], v[116:119], v[136:151]
    s_waitcnt vmcnt(8) lgkmcnt(0)
    s_barrier
    s_cmp_eq_u32 s99, 0
    s_cbranch_scc1 F_f0a
    s_cmp_lg_u32 s3, 1
    s_cbranch_scc1 F_f0a
    v_mov_b32 v184, s68
    v_mov_b32 v185, 1
    v_writelane_b32 v184, s69, 1
    s_mov_b64 exec, 3
    buffer_store_dword v185, v184, s[4:7], 0 offen sc1
    s_mov_b64 exec, -1
F_f0a:
    v_exp_f32 v84, v84
    v_exp_f32 v85, v85
    v_cvt_pk_bf16_f32 v109, v82, v83
    v_exp_f32 v86, v86
    v_exp_f32 v87, v87
    v_exp_f32 v88, v88
    v_exp_f32 v89, v89
    v_cvt_pk_bf16_f32 v110, v84, v85
    v_exp_f32 v90, v90
    v_exp_f32 v91, v91
    v_cvt_pk_bf16_f32 v111, v86, v87
    v_cvt_pk_bf16_f32 v112, v88, v89
    v_mfma_f32_32x32x16_bf16 v[72:87], v[20:23], v[8:11], v[40:55]
    ds_read_b128 v[32:35], v5 offset:56160
    v_exp_f32 v92, v92
    v_exp_f32 v93, v93
    v_cvt_pk_bf16_f32 v113, v90, v91
    v_exp_f32 v94, v94
    v_exp_f32 v95, v95
    v_cvt_pk_bf16_f32 v114, v92, v93
    v_mfma_f32_32x32x16_bf16 v[120:135], v[24:27], v[104:107], v[120:135]
    ds_read_b128 v[36:39], v5 offset:56176
    v_exp_f32 v96, v96
    v_exp_f32 v97, v97
    v_cvt_pk_bf16_f32 v115, v94, v95
    v_exp_f32 v98, v98
    v_exp_f32 v99, v99
    v_cvt_pk_bf16_f32 v116, v96, v97
    v_mfma_f32_32x32x16_bf16 v[120:135], v[28:31], v[108:111], v[120:135]
    ds_read_b128 v[16:19], v4 offset:58240
    v_exp_f32 v100, v100
    v_exp_f32 v101, v101
    v_cvt_pk_bf16_f32 v117, v98, v99
    v_exp_f32 v102, v102
    v_exp_f32 v103, v103
    v_exp_f32 v72, v72
    v_exp_f32 v73, v73
    v_cvt_pk_bf16_f32 v118, v100, v101
    v_exp_f32 v74, v74
    v_exp_f32 v75, v75
    v_cvt_pk_bf16_f32 v119, v102, v103
    v_cvt_pk_bf16_f32 v104, v72, v73
    v_mfma_f32_32x32x16_bf16 v[88:103], v[20:23], v[12:15], v[56:71]
    buffer_load_dwordx4 v231, s[4:7], s57 offen offset:1024 sc1 lds
    v_exp_f32 v76, v76
    v_exp_f32 v77, v77
    v_cvt_pk_bf16_f32 v105, v74, v75
    v_exp_f32 v78, v78
    v_exp_f32 v79, v79
    v_cvt_pk_bf16_f32 v106, v76, v77
    v_mfma_f32_32x32x16_bf16 v[136:151], v[24:27], v[112:115], v[136:151]
    buffer_load_dwordx4 v1, s[4:7], s57 offen offset:2080 sc1 lds
    v_exp_f32 v80, v80
    v_exp_f32 v81, v81
    v_cvt_pk_bf16_f32 v107, v78, v79
    v_exp_f32 v82, v82
    v_exp_f32 v83, v83
    v_cvt_pk_bf16_f32 v108, v80, v81
    v_mfma_f32_32x32x16_bf16 v[136:151], v[28:31], v[116:119], v[136:151]
    s_waitcnt vmcnt(7) lgkmcnt(0)
    v_cmp_eq_u32 vcc, 1, v232
    s_cmp_eq_u64 vcc, -1
    s_cbranch_scc0 F_f0slowb
F_f0backb:
    v_exp_f32 v84, v84
    v_exp_f32 v85, v85
    v_cvt_pk_bf16_f32 v109, v82, v83
    v_exp_f32 v86, v86
    v_exp_f32 v87, v87
    v_exp_f32 v88, v88
    v_exp_f32 v89, v89
    v_cvt_pk_bf16_f32 v110, v84, v85
    v_exp_f32 v90, v90
    v_exp_f32 v91, v91
    v_cvt_pk_bf16_f32 v111, v86, v87
    v_cvt_pk_bf16_f32 v112, v88, v89
    v_mfma_f32_32x32x16_bf16 v[72:87], v[16:19], v[8:11], v[40:55]
    ds_read_b128 v[24:27], v5 offset:58240
    v_exp_f32 v92, v92
    v_exp_f32 v93, v93
    v_cvt_pk_bf16_f32 v113, v90, v91
    v_exp_f32 v94, v94
    v_exp_f32 v95, v95
    v_cvt_pk_bf16_f32 v114, v92, v93
    v_mfma_f32_32x32x16_bf16 v[120:135], v[32:35], v[104:107], v[120:135]
    ds_read_b128 v[28:31], v5 offset:58256
    v_exp_f32 v96, v96
    v_exp_f32 v97, v97
    v_cvt_pk_bf16_f32 v115, v94, v95
    v_exp_f32 v98, v98
    v_exp_f32 v99, v99
    v_cvt_pk_bf16_f32 v116, v96, v97
    v_mfma_f32_32x32x16_bf16 v[120:135], v[36:39], v[108:111], v[120:135]
    ds_read_b128 v[20:23], v4 offset:60320
    buffer_load_dwordx4 a[20:23], v1, s[4:7], s35 offen offset:2048 sc1
    v_exp_f32 v100, v100
    v_exp_f32 v101, v101
    v_cvt_pk_bf16_f32 v117, v98, v99
    v_exp_f32 v102, v102
    v_exp_f32 v103, v103
    v_exp_f32 v72, v72
    v_exp_f32 v73, v73
    v_cvt_pk_bf16_f32 v118, v100, v101
    v_exp_f32 v74, v74
    v_exp_f32 v75, v75
    v_cvt_pk_bf16_f32 v119, v102, v103
    v_cvt_pk_bf16_f32 v104, v72, v73
    v_mfma_f32_32x32x16_bf16 v[88:103], v[16:19], v[12:15], v[56:71]
    buffer_load_dwordx4 v1, s[4:7], s57 offen offset:3104 sc1 lds
    s_add_u32 s57, s57, 16384
    v_exp_f32 v76, v76
    v_exp_f32 v77, v77
    v_cvt_pk_bf16_f32 v105, v74, v75
    v_exp_f32 v78, v78
    v_exp_f32 v79, v79
    v_cvt_pk_bf16_f32 v106, v76, v77
    v_mfma_f32_32x32x16_bf16 v[136:151], v[32:35], v[112:115], v[136:151]
    buffer_load_dwordx4 v[152:155], v1, s[4:7], s32 offen offset:0 sc1
    v_exp_f32 v80, v80
    v_exp_f32 v81, v81
    v_cvt_pk_bf16_f32 v107, v78, v79
    v_exp_f32 v82, v82
    v_exp_f32 v83, v83
    v_cvt_pk_bf16_f32 v108, v80, v81
    v_mfma_f32_32x32x16_bf16 v[136:151], v[36:39], v[116:119], v[136:151]
    s_waitcnt lgkmcnt(0)
    v_exp_f32 v84, v84
    v_exp_f32 v85, v85
    v_cvt_pk_bf16_f32 v109, v82, v83
    v_exp_f32 v86, v86
    v_exp_f32 v87, v87
    v_exp_f32 v88, v88
    v_exp_f32 v89, v89
    v_cvt_pk_bf16_f32 v110, v84, v85
    v_exp_f32 v90, v90
    v_exp_f32 v91, v91
    v_cvt_pk_bf16_f32 v111, v86, v87
    v_cvt_pk_bf16_f32 v112, v88, v89
    v_mfma_f32_32x32x16_bf16 v[72:87], v[20:23], v[8:11], v[40:55]
    ds_read_b128 v[32:35], v5 offset:60320
    v_exp_f32 v92, v92
    v_exp_f32 v93, v93
    v_cvt_pk_bf16_f32 v113, v90, v91
    v_exp_f32 v94, v94
    v_exp_f32 v95, v95
    v_cvt_pk_bf16_f32 v114, v92, v93
    v_mfma_f32_32x32x16_bf16 v[120:135], v[24:27], v[104:107], v[120:135]
    ds_read_b128 v[36:39], v5 offset:60336
    v_exp_f32 v96, v96
    v_exp_f32 v97, v97
    v_cvt_pk_bf16_f32 v115, v94, v95
    v_exp_f32 v98, v98
    v_exp_f32 v99, v99
    v_cvt_pk_bf16_f32 v116, v96, v97
    v_mfma_f32_32x32x16_bf16 v[120:135], v[28:31], v[108:111], v[120:135]
    ds_read_b128 v[16:19], v4 offset:62400
    buffer_load_dwordx4 a[24:27], v1, s[4:7], s34 offen offset:3072 sc1
    v_exp_f32 v100, v100
    v_exp_f32 v101, v101
    v_cvt_pk_bf16_f32 v117, v98, v99
    v_exp_f32 v102, v102
    v_exp_f32 v103, v103
    v_exp_f32 v72, v72
    v_exp_f32 v73, v73
    v_cvt_pk_bf16_f32 v118, v100, v101
    v_exp_f32 v74, v74
    v_exp_f32 v75, v75
    v_cvt_pk_bf16_f32 v119, v102, v103
    v_cvt_pk_bf16_f32 v104, v72, v73
    v_mfma_f32_32x32x16_bf16 v[88:103], v[20:23], v[12:15], v[56:71]
    buffer_load_dwordx4 v[156:159], v1, s[4:7], s33 offen offset:0 sc1
    v_exp_f32 v76, v76
    v_exp_f32 v77, v77
    v_cvt_pk_bf16_f32 v105, v74, v75
    v_exp_f32 v78, v78
    v_exp_f32 v79, v79
    v_cvt_pk_bf16_f32 v106, v76, v77
    v_mfma_f32_32x32x16_bf16 v[136:151], v[24:27], v[112:115], v[136:151]
    buffer_load_dwordx4 v[160:163], v1, s[4:7], s32 offen offset:1024 sc1
    v_exp_f32 v80, v80
    v_exp_f32 v81, v81
    v_cvt_pk_bf16_f32 v107, v78, v79
    v_exp_f32 v82, v82
    v_exp_f32 v83, v83
    v_cvt_pk_bf16_f32 v108, v80, v81
    v_mfma_f32_32x32x16_bf16 v[136:151], v[28:31], v[116:119], v[136:151]
    s_waitcnt lgkmcnt(0)
    v_exp_f32 v84, v84
    v_exp_f32 v85, v85
    v_cvt_pk_bf16_f32 v109, v82, v83
    v_exp_f32 v86, v86
    v_exp_f32 v87, v87
    v_exp_f32 v88, v88
    v_exp_f32 v89, v89
    v_cvt_pk_bf16_f32 v110, v84, v85
    v_exp_f32 v90, v90
    v_exp_f32 v91, v91
    v_cvt_pk_bf16_f32 v111, v86, v87
    v_cvt_pk_bf16_f32 v112, v88, v89
    v_mfma_f32_32x32x16_bf16 v[72:87], v[16:19], v[8:11], v[40:55]
    ds_read_b128 v[24:27], v5 offset:62400
    v_exp_f32 v92, v92
    v_exp_f32 v93, v93
    v_cvt_pk_bf16_f32 v113, v90, v91
    v_exp_f32 v94, v94
    v_exp_f32 v95, v95
    v_cvt_pk_bf16_f32 v114, v92, v93
    v_mfma_f32_32x32x16_bf16 v[120:135], v[32:35], v[104:107], v[120:135]
    ds_read_b128 v[28:31], v5 offset:62416
    v_exp_f32 v96, v96
    v_exp_f32 v97, v97
    v_cvt_pk_bf16_f32 v115, v94, v95
    v_exp_f32 v98, v98
    v_exp_f32 v99, v99
    v_cvt_pk_bf16_f32 v116, v96, v97
    v_mfma_f32_32x32x16_bf16 v[120:135], v[36:39], v[108:111], v[120:135]
    ds_read_b128 v[20:23], v4 offset:64480
    buffer_load_dwordx4 a[28:31], v1, s[4:7], s35 offen offset:3072 sc1
    v_exp_f32 v100, v100
    v_exp_f32 v101, v101
    v_cvt_pk_bf16_f32 v117, v98, v99
    v_exp_f32 v102, v102
    v_exp_f32 v103, v103
    v_exp_f32 v72, v72
    v_exp_f32 v73, v73
    v_cvt_pk_bf16_f32 v118, v100, v101
    v_exp_f32 v74, v74
    v_exp_f32 v75, v75
    v_cvt_pk_bf16_f32 v119, v102, v103
    v_cvt_pk_bf16_f32 v104, v72, v73
    v_mfma_f32_32x32x16_bf16 v[88:103], v[16:19], v[12:15], v[56:71]
    buffer_load_dword v232, v234, s[4:7], s43 offen sc1
    v_exp_f32 v76, v76
    v_exp_f32 v77, v77
    v_cvt_pk_bf16_f32 v105, v74, v75
    v_exp_f32 v78, v78
    v_exp_f32 v79, v79
    v_cvt_pk_bf16_f32 v106, v76, v77
    v_mfma_f32_32x32x16_bf16 v[136:151], v[32:35], v[112:115], v[136:151]
    buffer_load_dwordx4 v[164:167], v1, s[4:7], s33 offen offset:1024 sc1
    v_exp_f32 v80, v80
    v_exp_f32 v81, v81
    v_cvt_pk_bf16_f32 v107, v78, v79
    v_exp_f32 v82, v82
    v_exp_f32 v83, v83
    v_cvt_pk_bf16_f32 v108, v80, v81
    v_mfma_f32_32x32x16_bf16 v[136:151], v[36:39], v[116:119], v[136:151]
    s_waitcnt lgkmcnt(0)
    v_exp_f32 v84, v84
    v_exp_f32 v85, v85
    v_cvt_pk_bf16_f32 v109, v82, v83
    v_exp_f32 v86, v86
    v_exp_f32 v87, v87
    v_exp_f32 v88, v88
    v_exp_f32 v89, v89
    v_cvt_pk_bf16_f32 v110, v84, v85
    v_exp_f32 v90, v90
    v_exp_f32 v91, v91
    v_cvt_pk_bf16_f32 v111, v86, v87
    v_cvt_pk_bf16_f32 v112, v88, v89
    v_mfma_f32_32x32x16_bf16 v[72:87], v[20:23], v[8:11], v[40:55]
    ds_read_b128 v[32:35], v5 offset:64480
    v_exp_f32 v92, v92
    v_exp_f32 v93, v93
    v_cvt_pk_bf16_f32 v113, v90, v91
    v_exp_f32 v94, v94
    v_exp_f32 v95, v95
    v_cvt_pk_bf16_f32 v114, v92, v93
    v_mfma_f32_32x32x16_bf16 v[120:135], v[24:27], v[104:107], v[120:135]
    ds_read_b128 v[36:39], v5 offset:64496
    v_exp_f32 v96, v96
    v_exp_f32 v97, v97
    v_cvt_pk_bf16_f32 v115, v94, v95
    v_exp_f32 v98, v98
    v_exp_f32 v99, v99
    v_cvt_pk_bf16_f32 v116, v96, v97
    v_mfma_f32_32x32x16_bf16 v[120:135], v[28:31], v[108:111], v[120:135]
    ds_read_b128 v[16:19], v237 offset:0
    buffer_load_dwordx4 a[32:35], v224, s[4:7], s34 offen offset:0 sc1
    v_exp_f32 v100, v100
    v_exp_f32 v101, v101
    v_cvt_pk_bf16_f32 v117, v98, v99
    v_exp_f32 v102, v102
    v_exp_f32 v103, v103
    v_exp_f32 v72, v72
    v_exp_f32 v73, v73
    v_cvt_pk_bf16_f32 v118, v100, v101
    v_exp_f32 v74, v74
    v_exp_f32 v75, v75
    v_cvt_pk_bf16_f32 v119, v102, v103
    v_cvt_pk_bf16_f32 v104, v72, v73
    v_mfma_f32_32x32x16_bf16 v[88:103], v[20:23], v[12:15], v[56:71]
    buffer_load_dwordx4 v[168:171], v1, s[4:7], s32 offen offset:2048 sc1
    v_exp_f32 v76, v76
    v_exp_f32 v77, v77
    v_cvt_pk_bf16_f32 v105, v74, v75
    v_exp_f32 v78, v78
    v_exp_f32 v79, v79
    v_cvt_pk_bf16_f32 v106, v76, v77
    v_mfma_f32_32x32x16_bf16 v[136:151], v[24:27], v[112:115], v[136:151]
    buffer_load_dwordx4 v[172:175], v1, s[4:7], s33 offen offset:2048 sc1
    v_exp_f32 v80, v80
    v_exp_f32 v81, v81
    v_cvt_pk_bf16_f32 v107, v78, v79
    v_exp_f32 v82, v82
    v_exp_f32 v83, v83
    v_cvt_pk_bf16_f32 v108, v80, v81
    v_mfma_f32_32x32x16_bf16 v[136:151], v[28:31], v[116:119], v[136:151]
    s_waitcnt lgkmcnt(0)
    v_exp_f32 v84, v84
    v_exp_f32 v85, v85
    v_cvt_pk_bf16_f32 v109, v82, v83
    v_exp_f32 v86, v86
    v_exp_f32 v87, v87
    v_exp_f32 v88, v88
    v_exp_f32 v89, v89
    v_cvt_pk_bf16_f32 v110, v84, v85
    v_exp_f32 v90, v90
    v_exp_f32 v91, v91
    v_cvt_pk_bf16_f32 v111, v86, v87
    v_cvt_pk_bf16_f32 v112, v88, v89
    v_mfma_f32_32x32x16_bf16 v[72:87], v[16:19], v[8:11], v[40:55]
    ds_read_b128 v[24:27], v238 offset:0
    v_exp_f32 v92, v92
    v_exp_f32 v93, v93
    v_cvt_pk_bf16_f32 v113, v90, v91
    v_exp_f32 v94, v94
    v_exp_f32 v95, v95
    v_cvt_pk_bf16_f32 v114, v92, v93
    v_mfma_f32_32x32x16_bf16 v[120:135], v[32:35], v[104:107], v[120:135]
    ds_read_b128 v[28:31], v238 offset:16
    v_exp_f32 v96, v96
    v_exp_f32 v97, v97
    v_cvt_pk_bf16_f32 v115, v94, v95
    v_exp_f32 v98, v98
    v_exp_f32 v99, v99
    v_cvt_pk_bf16_f32 v116, v96, v97
    v_mfma_f32_32x32x16_bf16 v[120:135], v[36:39], v[108:111], v[120:135]
    ds_read_b128 v[20:23], v237 offset:2080
    buffer_load_dwordx4 a[36:39], v224, s[4:7], s35 offen offset:0 sc1
    v_exp_f32 v100, v100
    v_exp_f32 v101, v101
    v_cvt_pk_bf16_f32 v117, v98, v99
    v_exp_f32 v102, v102
    v_exp_f32 v103, v103
    v_exp_f32 v72, v72
    v_exp_f32 v73, v73
    v_cvt_pk_bf16_f32 v118, v100, v101
    v_exp_f32 v74, v74
    v_exp_f32 v75, v75
    v_cvt_pk_bf16_f32 v119, v102, v103
    v_cvt_pk_bf16_f32 v104, v72, v73
    v_mfma_f32_32x32x16_bf16 v[88:103], v[16:19], v[12:15], v[56:71]
    buffer_load_dwordx4 v[176:179], v1, s[4:7], s32 offen offset:3072 sc1
    v_exp_f32 v76, v76
    v_exp_f32 v77, v77
    v_cvt_pk_bf16_f32 v105, v74, v75
    v_exp_f32 v78, v78
    v_exp_f32 v79, v79
    v_cvt_pk_bf16_f32 v106, v76, v77
    v_mfma_f32_32x32x16_bf16 v[136:151], v[32:35], v[112:115], v[136:151]
    buffer_load_dwordx4 v[180:183], v1, s[4:7], s33 offen offset:3072 sc1
    v_exp_f32 v80, v80
    v_exp_f32 v81, v81
    v_cvt_pk_bf16_f32 v107, v78, v79
    v_exp_f32 v82, v82
    v_exp_f32 v83, v83
    v_cvt_pk_bf16_f32 v108, v80, v81
    v_mfma_f32_32x32x16_bf16 v[136:151], v[36:39], v[116:119], v[136:151]
    s_waitcnt vmcnt(7) lgkmcnt(0)
    v_cmp_eq_u32 vcc, 1, v232
    s_cmp_eq_u64 vcc, -1
    s_cbranch_scc0 F_f0slowa
F_f0backa:
    v_exp_f32 v84, v84
    v_exp_f32 v85, v85
    v_cvt_pk_bf16_f32 v109, v82, v83
    v_exp_f32 v86, v86
    v_exp_f32 v87, v87
    v_exp_f32 v88, v88
    v_exp_f32 v89, v89
    v_cvt_pk_bf16_f32 v110, v84, v85
    v_exp_f32 v90, v90
    v_exp_f32 v91, v91
    v_cvt_pk_bf16_f32 v111, v86, v87
    v_cvt_pk_bf16_f32 v112, v88, v89
    v_mfma_f32_32x32x16_bf16 v[72:87], v[20:23], v[8:11], v[40:55]
    ds_read_b128 v[32:35], v238 offset:2080
    v_exp_f32 v92, v92
    v_exp_f32 v93, v93
    v_cvt_pk_bf16_f32 v113, v90, v91
    v_exp_f32 v94, v94
    v_exp_f32 v95, v95
    v_cvt_pk_bf16_f32 v114, v92, v93
    v_mfma_f32_32x32x16_bf16 v[120:135], v[24:27], v[104:107], v[120:135]
    ds_read_b128 v[36:39], v238 offset:2096
    v_exp_f32 v96, v96
    v_exp_f32 v97, v97
    v_cvt_pk_bf16_f32 v115, v94, v95
    v_exp_f32 v98, v98
    v_exp_f32 v99, v99
    v_cvt_pk_bf16_f32 v116, v96, v97
    v_mfma_f32_32x32x16_bf16 v[120:135], v[28:31], v[108:111], v[120:135]
    ds_read_b128 v[16:19], v237 offset:4160
    buffer_load_dwordx4 a[40:43], v224, s[4:7], s34 offen offset:1024 sc1
    v_exp_f32 v100, v100
    v_exp_f32 v101, v101
    v_cvt_pk_bf16_f32 v117, v98, v99
    v_exp_f32 v102, v102
    v_exp_f32 v103, v103
    v_exp_f32 v72, v72
    v_exp_f32 v73, v73
    v_cvt_pk_bf16_f32 v118, v100, v101
    v_exp_f32 v74, v74
    v_exp_f32 v75, v75
    v_cvt_pk_bf16_f32 v119, v102, v103
    v_cvt_pk_bf16_f32 v104, v72, v73
    v_mfma_f32_32x32x16_bf16 v[88:103], v[20:23], v[12:15], v[56:71]
    buffer_load_dwordx4 a[224:227], v1, s[4:7], s36 offen offset:0 sc1
    v_exp_f32 v76, v76
    v_exp_f32 v77, v77
    v_cvt_pk_bf16_f32 v105, v74, v75
    v_exp_f32 v78, v78
    v_exp_f32 v79, v79
    v_cvt_pk_bf16_f32 v106, v76, v77
    v_mfma_f32_32x32x16_bf16 v[136:151], v[24:27], v[112:115], v[136:151]
    buffer_load_dwordx4 a[228:231], v1, s[4:7], s36 offen offset:1024 sc1
    v_exp_f32 v80, v80
    v_exp_f32 v81, v81
    v_cvt_pk_bf16_f32 v107, v78, v79
    v_exp_f32 v82, v82
    v_exp_f32 v83, v83
    v_cvt_pk_bf16_f32 v108, v80, v81
    v_mfma_f32_32x32x16_bf16 v[136:151], v[28:31], v[116:119], v[136:151]
    s_waitcnt lgkmcnt(0)
    v_exp_f32 v84, v84
    v_exp_f32 v85, v85
    v_cvt_pk_bf16_f32 v109, v82, v83
    v_exp_f32 v86, v86
    v_exp_f32 v87, v87
    v_exp_f32 v88, v88
    v_exp_f32 v89, v89
    v_cvt_pk_bf16_f32 v110, v84, v85
    v_exp_f32 v90, v90
    v_exp_f32 v91, v91
    v_cvt_pk_bf16_f32 v111, v86, v87
    v_cvt_pk_bf16_f32 v112, v88, v89
    v_mfma_f32_32x32x16_bf16 v[72:87], v[16:19], v[8:11], v[40:55]
    ds_read_b128 v[24:27], v238 offset:4160
    v_exp_f32 v92, v92
    v_exp_f32 v93, v93
    v_cvt_pk_bf16_f32 v113, v90, v91
    v_exp_f32 v94, v94
    v_exp_f32 v95, v95
    v_cvt_pk_bf16_f32 v114, v92, v93
    v_mfma_f32_32x32x16_bf16 v[120:135], v[32:35], v[104:107], v[120:135]
    ds_read_b128 v[28:31], v238 offset:4176
    v_exp_f32 v96, v96
    v_exp_f32 v97, v97
    v_cvt_pk_bf16_f32 v115, v94, v95
    v_exp_f32 v98, v98
    v_exp_f32 v99, v99
    v_cvt_pk_bf16_f32 v116, v96, v97
    v_mfma_f32_32x32x16_bf16 v[120:135], v[36:39], v[108:111], v[120:135]
    ds_read_b128 v[20:23], v237 offset:6240
    buffer_load_dwordx4 a[44:47], v224, s[4:7], s35 offen offset:1024 sc1
    v_exp_f32 v100, v100
    v_exp_f32 v101, v101
    v_cvt_pk_bf16_f32 v117, v98, v99
    v_exp_f32 v102, v102
    v_exp_f32 v103, v103
    v_exp_f32 v72, v72
    v_exp_f32 v73, v73
    v_cvt_pk_bf16_f32 v118, v100, v101
    v_exp_f32 v74, v74
    v_exp_f32 v75, v75
    v_cvt_pk_bf16_f32 v119, v102, v103
    v_cvt_pk_bf16_f32 v104, v72, v73
    v_mfma_f32_32x32x16_bf16 v[88:103], v[16:19], v[12:15], v[56:71]
    buffer_load_dwordx4 a[232:235], v1, s[4:7], s36 offen offset:2048 sc1
    v_exp_f32 v76, v76
    v_exp_f32 v77, v77
    v_cvt_pk_bf16_f32 v105, v74, v75
    v_exp_f32 v78, v78
    v_exp_f32 v79, v79
    v_cvt_pk_bf16_f32 v106, v76, v77
    v_mfma_f32_32x32x16_bf16 v[136:151], v[32:35], v[112:115], v[136:151]
    buffer_load_dwordx4 a[236:239], v1, s[4:7], s36 offen offset:3072 sc1
    v_exp_f32 v80, v80
    v_exp_f32 v81, v81
    v_cvt_pk_bf16_f32 v107, v78, v79
    v_exp_f32 v82, v82
    v_exp_f32 v83, v83
    v_cvt_pk_bf16_f32 v108, v80, v81
    v_mfma_f32_32x32x16_bf16 v[136:151], v[36:39], v[116:119], v[136:151]
    s_waitcnt lgkmcnt(0)
    v_exp_f32 v84, v84
    v_exp_f32 v85, v85
    v_cvt_pk_bf16_f32 v109, v82, v83
    v_exp_f32 v86, v86
    v_exp_f32 v87, v87
    v_exp_f32 v88, v88
    v_exp_f32 v89, v89
    v_cvt_pk_bf16_f32 v110, v84, v85
    v_exp_f32 v90, v90
    v_exp_f32 v91, v91
    v_cvt_pk_bf16_f32 v111, v86, v87
    v_cvt_pk_bf16_f32 v112, v88, v89
    v_mfma_f32_32x32x16_bf16 v[72:87], v[20:23], v[8:11], v[40:55]
    ds_read_b128 v[32:35], v238 offset:6240
    v_exp_f32 v92, v92
    v_exp_f32 v93, v93
    v_cvt_pk_bf16_f32 v113, v90, v91
    v_exp_f32 v94, v94
    v_exp_f32 v95, v95
    v_cvt_pk_bf16_f32 v114, v92, v93
    v_mfma_f32_32x32x16_bf16 v[120:135], v[24:27], v[104:107], v[120:135]
    ds_read_b128 v[36:39], v238 offset:6256
    v_exp_f32 v96, v96
    v_exp_f32 v97, v97
    v_cvt_pk_bf16_f32 v115, v94, v95
    v_exp_f32 v98, v98
    v_exp_f32 v99, v99
    v_cvt_pk_bf16_f32 v116, v96, v97
    v_mfma_f32_32x32x16_bf16 v[120:135], v[28:31], v[108:111], v[120:135]
    ds_read_b128 v[16:19], v237 offset:8320
    buffer_load_dwordx4 a[48:51], v224, s[4:7], s34 offen offset:2048 sc1
    v_exp_f32 v100, v100
    v_exp_f32 v101, v101
    v_cvt_pk_bf16_f32 v117, v98, v99
    v_exp_f32 v102, v102
    v_exp_f32 v103, v103
    v_exp_f32 v72, v72
    v_exp_f32 v73, v73
    v_cvt_pk_bf16_f32 v118, v100, v101
    v_exp_f32 v74, v74
    v_exp_f32 v75, v75
    v_cvt_pk_bf16_f32 v119, v102, v103
    v_cvt_pk_bf16_f32 v104, v72, v73
    v_mfma_f32_32x32x16_bf16 v[88:103], v[20:23], v[12:15], v[56:71]
    buffer_load_dwordx4 a[240:243], v224, s[4:7], s36 offen offset:0 sc1
    v_exp_f32 v76, v76
    v_exp_f32 v77, v77
    v_cvt_pk_bf16_f32 v105, v74, v75
    v_exp_f32 v78, v78
    v_exp_f32 v79, v79
    v_cvt_pk_bf16_f32 v106, v76, v77
    v_mfma_f32_32x32x16_bf16 v[136:151], v[24:27], v[112:115], v[136:151]
    buffer_load_dwordx4 a[244:247], v224, s[4:7], s36 offen offset:1024 sc1
    v_exp_f32 v80, v80
    v_exp_f32 v81, v81
    v_cvt_pk_bf16_f32 v107, v78, v79
    v_exp_f32 v82, v82
    v_exp_f32 v83, v83
    v_cvt_pk_bf16_f32 v108, v80, v81
    v_mfma_f32_32x32x16_bf16 v[136:151], v[28:31], v[116:119], v[136:151]
    s_waitcnt lgkmcnt(0)
    v_exp_f32 v84, v84
    v_exp_f32 v85, v85
    v_cvt_pk_bf16_f32 v109, v82, v83
    v_exp_f32 v86, v86
    v_exp_f32 v87, v87
    v_exp_f32 v88, v88
    v_exp_f32 v89, v89
    v_cvt_pk_bf16_f32 v110, v84, v85
    v_exp_f32 v90, v90
    v_exp_f32 v91, v91
    v_cvt_pk_bf16_f32 v111, v86, v87
    v_cvt_pk_bf16_f32 v112, v88, v89
    v_mfma_f32_32x32x16_bf16 v[72:87], v[16:19], v[8:11], v[40:55]
    ds_read_b128 v[24:27], v238 offset:8320
    v_exp_f32 v92, v92
    v_exp_f32 v93, v93
    v_cvt_pk_bf16_f32 v113, v90, v91
    v_exp_f32 v94, v94
    v_exp_f32 v95, v95
    v_cvt_pk_bf16_f32 v114, v92, v93
    v_mfma_f32_32x32x16_bf16 v[120:135], v[32:35], v[104:107], v[120:135]
    ds_read_b128 v[28:31], v238 offset:8336
    v_exp_f32 v96, v96
    v_exp_f32 v97, v97
    v_cvt_pk_bf16_f32 v115, v94, v95
    v_exp_f32 v98, v98
    v_exp_f32 v99, v99
    v_cvt_pk_bf16_f32 v116, v96, v97
    v_mfma_f32_32x32x16_bf16 v[120:135], v[36:39], v[108:111], v[120:135]
    ds_read_b128 v[20:23], v237 offset:10400
    buffer_load_dwordx4 a[52:55], v224, s[4:7], s35 offen offset:2048 sc1
    v_exp_f32 v100, v100
    v_exp_f32 v101, v101
    v_cvt_pk_bf16_f32 v117, v98, v99
    v_exp_f32 v102, v102
    v_exp_f32 v103, v103
    v_exp_f32 v72, v72
    v_exp_f32 v73, v73
    v_cvt_pk_bf16_f32 v118, v100, v101
    v_exp_f32 v74, v74
    v_exp_f32 v75, v75
    v_cvt_pk_bf16_f32 v119, v102, v103
    v_cvt_pk_bf16_f32 v104, v72, v73
    v_mfma_f32_32x32x16_bf16 v[88:103], v[16:19], v[12:15], v[56:71]
    buffer_load_dwordx4 a[248:251], v224, s[4:7], s36 offen offset:2048 sc1
    v_exp_f32 v76, v76
    v_exp_f32 v77, v77
    v_cvt_pk_bf16_f32 v105, v74, v75
    v_exp_f32 v78, v78
    v_exp_f32 v79, v79
    v_cvt_pk_bf16_f32 v106, v76, v77
    v_mfma_f32_32x32x16_bf16 v[136:151], v[32:35], v[112:115], v[136:151]
    buffer_load_dwordx4 v[184:187], v224, s[4:7], s32 offen offset:0 sc1
    v_exp_f32 v80, v80
    v_exp_f32 v81, v81
    v_cvt_pk_bf16_f32 v107, v78, v79
    v_exp_f32 v82, v82
    v_exp_f32 v83, v83
    v_cvt_pk_bf16_f32 v108, v80, v81
    v_mfma_f32_32x32x16_bf16 v[136:151], v[36:39], v[116:119], v[136:151]
    s_waitcnt lgkmcnt(0)
    v_exp_f32 v84, v84
    v_exp_f32 v85, v85
    v_cvt_pk_bf16_f32 v109, v82, v83
    v_exp_f32 v86, v86
    v_exp_f32 v87, v87
    v_exp_f32 v88, v88
    v_exp_f32 v89, v89
    v_cvt_pk_bf16_f32 v110, v84, v85
    v_exp_f32 v90, v90
    v_exp_f32 v91, v91
    v_cvt_pk_bf16_f32 v111, v86, v87
    v_cvt_pk_bf16_f32 v112, v88, v89
    v_mfma_f32_32x32x16_bf16 v[72:87], v[20:23], v[8:11], v[40:55]
    ds_read_b128 v[32:35], v238 offset:10400
    v_exp_f32 v92, v92
    v_exp_f32 v93, v93
    v_cvt_pk_bf16_f32 v113, v90, v91
    v_exp_f32 v94, v94
    v_exp_f32 v95, v95
    v_cvt_pk_bf16_f32 v114, v92, v93
    v_mfma_f32_32x32x16_bf16 v[120:135], v[24:27], v[104:107], v[120:135]
    ds_read_b128 v[36:39], v238 offset:10416
    v_exp_f32 v96, v96
    v_exp_f32 v97, v97
    v_cvt_pk_bf16_f32 v115, v94, v95
    v_exp_f32 v98, v98
    v_exp_f32 v99, v99
    v_cvt_pk_bf16_f32 v116, v96, v97
    v_mfma_f32_32x32x16_bf16 v[120:135], v[28:31], v[108:111], v[120:135]
    ds_read_b128 v[16:19], v237 offset:12480
    buffer_load_dwordx4 a[56:59], v224, s[4:7], s34 offen offset:3072 sc1
    v_exp_f32 v100, v100
    v_exp_f32 v101, v101
    v_cvt_pk_bf16_f32 v117, v98, v99
    v_exp_f32 v102, v102
    v_exp_f32 v103, v103
    v_exp_f32 v72, v72
    v_exp_f32 v73, v73
    v_cvt_pk_bf16_f32 v118, v100, v101
    v_exp_f32 v74, v74
    v_exp_f32 v75, v75
    v_cvt_pk_bf16_f32 v119, v102, v103
    v_cvt_pk_bf16_f32 v104, v72, v73
    v_mfma_f32_32x32x16_bf16 v[88:103], v[20:23], v[12:15], v[56:71]
    buffer_load_dwordx4 v[188:191], v224, s[4:7], s33 offen offset:0 sc1
    v_exp_f32 v76, v76
    v_exp_f32 v77, v77
    v_cvt_pk_bf16_f32 v105, v74, v75
    v_exp_f32 v78, v78
    v_exp_f32 v79, v79
    v_cvt_pk_bf16_f32 v106, v76, v77
    v_mfma_f32_32x32x16_bf16 v[136:151], v[24:27], v[112:115], v[136:151]
    buffer_load_dwordx4 v[192:195], v224, s[4:7], s32 offen offset:1024 sc1
    v_exp_f32 v80, v80
    v_exp_f32 v81, v81
    v_cvt_pk_bf16_f32 v107, v78, v79
    v_exp_f32 v82, v82
    v_exp_f32 v83, v83
    v_cvt_pk_bf16_f32 v108, v80, v81
    v_mfma_f32_32x32x16_bf16 v[136:151], v[28:31], v[116:119], v[136:151]
    s_waitcnt lgkmcnt(0)
    v_exp_f32 v84, v84
    v_exp_f32 v85, v85
    v_cvt_pk_bf16_f32 v109, v82, v83
    v_exp_f32 v86, v86
    v_exp_f32 v87, v87
    v_exp_f32 v88, v88
    v_exp_f32 v89, v89
    v_cvt_pk_bf16_f32 v110, v84, v85
    v_exp_f32 v90, v90
    v_exp_f32 v91, v91
    v_cvt_pk_bf16_f32 v111, v86, v87
    v_cvt_pk_bf16_f32 v112, v88, v89
    v_mfma_f32_32x32x16_bf16 v[72:87], v[16:19], v[8:11], v[40:55]
    ds_read_b128 v[24:27], v238 offset:12480
    v_exp_f32 v92, v92
    v_exp_f32 v93, v93
    v_cvt_pk_bf16_f32 v113, v90, v91
    v_exp_f32 v94, v94
    v_exp_f32 v95, v95
    v_cvt_pk_bf16_f32 v114, v92, v93
    v_mfma_f32_32x32x16_bf16 v[120:135], v[32:35], v[104:107], v[120:135]
    ds_read_b128 v[28:31], v238 offset:12496
    v_exp_f32 v96, v96
    v_exp_f32 v97, v97
    v_cvt_pk_bf16_f32 v115, v94, v95
    v_exp_f32 v98, v98
    v_exp_f32 v99, v99
    v_cvt_pk_bf16_f32 v116, v96, v97
    v_mfma_f32_32x32x16_bf16 v[120:135], v[36:39], v[108:111], v[120:135]
    ds_read_b128 v[20:23], v237 offset:14560
    buffer_load_dwordx4 a[60:63], v224, s[4:7], s35 offen offset:3072 sc1
    v_exp_f32 v100, v100
    v_exp_f32 v101, v101
    v_cvt_pk_bf16_f32 v117, v98, v99
    v_exp_f32 v102, v102
    v_exp_f32 v103, v103
    v_exp_f32 v72, v72
    v_exp_f32 v73, v73
    v_cvt_pk_bf16_f32 v118, v100, v101
    v_exp_f32 v74, v74
    v_exp_f32 v75, v75
    v_cvt_pk_bf16_f32 v119, v102, v103
    v_cvt_pk_bf16_f32 v104, v72, v73
    v_mfma_f32_32x32x16_bf16 v[88:103], v[16:19], v[12:15], v[56:71]
    buffer_load_dwordx4 v[196:199], v224, s[4:7], s33 offen offset:1024 sc1
    v_exp_f32 v76, v76
    v_exp_f32 v77, v77
    v_cvt_pk_bf16_f32 v105, v74, v75
    v_exp_f32 v78, v78
    v_exp_f32 v79, v79
    v_cvt_pk_bf16_f32 v106, v76, v77
    v_mfma_f32_32x32x16_bf16 v[136:151], v[32:35], v[112:115], v[136:151]
    buffer_load_dwordx4 v[200:203], v224, s[4:7], s32 offen offset:2048 sc1
    v_exp_f32 v80, v80
    v_exp_f32 v81, v81
    v_cvt_pk_bf16_f32 v107, v78, v79
    v_exp_f32 v82, v82
    v_exp_f32 v83, v83
    v_cvt_pk_bf16_f32 v108, v80, v81
    v_mfma_f32_32x32x16_bf16 v[136:151], v[36:39], v[116:119], v[136:151]
    s_waitcnt lgkmcnt(0)
    v_exp_f32 v84, v84
    v_exp_f32 v85, v85
    v_cvt_pk_bf16_f32 v109, v82, v83
    v_exp_f32 v86, v86
    v_exp_f32 v87, v87
    v_exp_f32 v88, v88
    v_exp_f32 v89, v89
    v_cvt_pk_bf16_f32 v110, v84, v85
    v_exp_f32 v90, v90
    v_exp_f32 v91, v91
    v_cvt_pk_bf16_f32 v111, v86, v87
    v_cvt_pk_bf16_f32 v112, v88, v89
    v_mfma_f32_32x32x16_bf16 v[72:87], v[20:23], v[8:11], v[40:55]
    ds_read_b128 v[32:35], v238 offset:14560
    v_exp_f32 v92, v92
    v_exp_f32 v93, v93
    v_cvt_pk_bf16_f32 v113, v90, v91
    v_exp_f32 v94, v94
    v_exp_f32 v95, v95
    v_cvt_pk_bf16_f32 v114, v92, v93
    v_mfma_f32_32x32x16_bf16 v[120:135], v[24:27], v[104:107], v[120:135]
    ds_read_b128 v[36:39], v238 offset:14576
    v_exp_f32 v96, v96
    v_exp_f32 v97, v97
    v_cvt_pk_bf16_f32 v115, v94, v95
    v_exp_f32 v98, v98
    v_exp_f32 v99, v99
    v_cvt_pk_bf16_f32 v116, v96, v97
    v_mfma_f32_32x32x16_bf16 v[120:135], v[28:31], v[108:111], v[120:135]
    ds_read_b128 v[16:19], v237 offset:16640
    buffer_load_dwordx4 a[64:67], v225, s[4:7], s34 offen offset:0 sc1
    v_exp_f32 v100, v100
    v_exp_f32 v101, v101
    v_cvt_pk_bf16_f32 v117, v98, v99
    v_exp_f32 v102, v102
    v_exp_f32 v103, v103
    v_exp_f32 v72, v72
    v_exp_f32 v73, v73
    v_cvt_pk_bf16_f32 v118, v100, v101
    v_exp_f32 v74, v74
    v_exp_f32 v75, v75
    v_cvt_pk_bf16_f32 v119, v102, v103
    v_cvt_pk_bf16_f32 v104, v72, v73
    v_mfma_f32_32x32x16_bf16 v[88:103], v[20:23], v[12:15], v[56:71]
    buffer_load_dwordx4 v[204:207], v224, s[4:7], s33 offen offset:2048 sc1
    v_exp_f32 v76, v76
    v_exp_f32 v77, v77
    v_cvt_pk_bf16_f32 v105, v74, v75
    v_exp_f32 v78, v78
    v_exp_f32 v79, v79
    v_cvt_pk_bf16_f32 v106, v76, v77
    v_mfma_f32_32x32x16_bf16 v[136:151], v[24:27], v[112:115], v[136:151]
    buffer_load_dwordx4 v[208:211], v224, s[4:7], s32 offen offset:3072 sc1
    v_exp_f32 v80, v80
    v_exp_f32 v81, v81
    v_cvt_pk_bf16_f32 v107, v78, v79
    v_exp_f32 v82, v82
    v_exp_f32 v83, v83
    v_cvt_pk_bf16_f32 v108, v80, v81
    v_mfma_f32_32x32x16_bf16 v[136:151], v[28:31], v[116:119], v[136:151]
    s_waitcnt lgkmcnt(0)
    v_exp_f32 v84, v84
    v_exp_f32 v85, v85
    v_cvt_pk_bf16_f32 v109, v82, v83
    v_exp_f32 v86, v86
    v_exp_f32 v87, v87
    v_exp_f32 v88, v88
    v_exp_f32 v89, v89
    v_cvt_pk_bf16_f32 v110, v84, v85
    v_exp_f32 v90, v90
    v_exp_f32 v91, v91
    v_cvt_pk_bf16_f32 v111, v86, v87
    v_cvt_pk_bf16_f32 v112, v88, v89
    v_mfma_f32_32x32x16_bf16 v[72:87], v[16:19], v[8:11], v[40:55]
    ds_read_b128 v[24:27], v238 offset:16640
    v_exp_f32 v92, v92
    v_exp_f32 v93, v93
    v_cvt_pk_bf16_f32 v113, v90, v91
    v_exp_f32 v94, v94
    v_exp_f32 v95, v95
    v_cvt_pk_bf16_f32 v114, v92, v93
    v_mfma_f32_32x32x16_bf16 v[120:135], v[32:35], v[104:107], v[120:135]
    ds_read_b128 v[28:31], v238 offset:16656
    v_exp_f32 v96, v96
    v_exp_f32 v97, v97
    v_cvt_pk_bf16_f32 v115, v94, v95
    v_exp_f32 v98, v98
    v_exp_f32 v99, v99
    v_cvt_pk_bf16_f32 v116, v96, v97
    v_mfma_f32_32x32x16_bf16 v[120:135], v[36:39], v[108:111], v[120:135]
    ds_read_b128 v[20:23], v237 offset:18720
    buffer_load_dwordx4 a[68:71], v225, s[4:7], s35 offen offset:0 sc1
    v_exp_f32 v100, v100
    v_exp_f32 v101, v101
    v_cvt_pk_bf16_f32 v117, v98, v99
    v_exp_f32 v102, v102
    v_exp_f32 v103, v103
    v_exp_f32 v72, v72
    v_exp_f32 v73, v73
    v_cvt_pk_bf16_f32 v118, v100, v101
    v_exp_f32 v74, v74
    v_exp_f32 v75, v75
    v_cvt_pk_bf16_f32 v119, v102, v103
    v_cvt_pk_bf16_f32 v104, v72, v73
    v_mfma_f32_32x32x16_bf16 v[88:103], v[16:19], v[12:15], v[56:71]
    buffer_load_dwordx4 v[212:215], v224, s[4:7], s33 offen offset:3072 sc1
    v_exp_f32 v76, v76
    v_exp_f32 v77, v77
    v_cvt_pk_bf16_f32 v105, v74, v75
    v_exp_f32 v78, v78
    v_exp_f32 v79, v79
    v_cvt_pk_bf16_f32 v106, v76, v77
    v_mfma_f32_32x32x16_bf16 v[136:151], v[32:35], v[112:115], v[136:151]
    buffer_load_dwordx4 a[176:179], v1, s[4:7], s80 offen offset:0 sc1
    s_add_u32 m0, s45, 0
    s_add_u32 s51, s44, 0
    v_exp_f32 v80, v80
    v_exp_f32 v81, v81
    v_cvt_pk_bf16_f32 v107, v78, v79
    v_exp_f32 v82, v82
    v_exp_f32 v83, v83
    v_cvt_pk_bf16_f32 v108, v80, v81
    v_mfma_f32_32x32x16_bf16 v[136:151], v[36:39], v[116:119], v[136:151]
    s_waitcnt lgkmcnt(0)
    s_barrier
    v_exp_f32 v84, v84
    v_exp_f32 v85, v85
    v_cvt_pk_bf16_f32 v109, v82, v83
    v_exp_f32 v86, v86
    v_exp_f32 v87, v87
    v_exp_f32 v88, v88
    v_exp_f32 v89, v89
    v_cvt_pk_bf16_f32 v110, v84, v85
    v_exp_f32 v90, v90
    v_exp_f32 v91, v91
    v_cvt_pk_bf16_f32 v111, v86, v87
    v_cvt_pk_bf16_f32 v112, v88, v89
    v_mfma_f32_32x32x16_bf16 v[72:87], v[20:23], v[8:11], v[40:55]
    ds_read_b128 v[32:35], v238 offset:18720
    v_exp_f32 v92, v92
    v_exp_f32 v93, v93
    v_cvt_pk_bf16_f32 v113, v90, v91
    v_exp_f32 v94, v94
    v_exp_f32 v95, v95
    v_cvt_pk_bf16_f32 v114, v92, v93
    v_mfma_f32_32x32x16_bf16 v[120:135], v[24:27], v[104:107], v[120:135]
    ds_read_b128 v[36:39], v238 offset:18736
    v_exp_f32 v96, v96
    v_exp_f32 v97, v97
    v_cvt_pk_bf16_f32 v115, v94, v95
    v_exp_f32 v98, v98
    v_exp_f32 v99, v99
    v_cvt_pk_bf16_f32 v116, v96, v97
    v_mfma_f32_32x32x16_bf16 v[120:135], v[28:31], v[108:111], v[120:135]
    ds_read_b128 v[16:19], v237 offset:20800
    buffer_load_dwordx4 a[72:75], v225, s[4:7], s34 offen offset:1024 sc1
    v_exp_f32 v100, v100
    v_exp_f32 v101, v101
    v_cvt_pk_bf16_f32 v117, v98, v99
    v_exp_f32 v102, v102
    v_exp_f32 v103, v103
    v_exp_f32 v72, v72
    v_exp_f32 v73, v73
    v_cvt_pk_bf16_f32 v118, v100, v101
    v_exp_f32 v74, v74
    v_exp_f32 v75, v75
    v_cvt_pk_bf16_f32 v119, v102, v103
    v_cvt_pk_bf16_f32 v104, v72, v73
    v_mfma_f32_32x32x16_bf16 v[88:103], v[20:23], v[12:15], v[56:71]
    buffer_load_dwordx4 v1, s[4:7], s51 offen offset:0 sc1 lds
    v_exp_f32 v76, v76
    v_exp_f32 v77, v77
    v_cvt_pk_bf16_f32 v105, v74, v75
    v_exp_f32 v78, v78
    v_exp_f32 v79, v79
    v_cvt_pk_bf16_f32 v106, v76, v77
    v_mfma_f32_32x32x16_bf16 v[136:151], v[24:27], v[112:115], v[136:151]
    buffer_load_dwordx4 v239, s[4:7], s51 offen offset:1024 sc1 lds
    v_exp_f32 v80, v80
    v_exp_f32 v81, v81
    v_cvt_pk_bf16_f32 v107, v78, v79
    v_exp_f32 v82, v82
    v_exp_f32 v83, v83
    v_cvt_pk_bf16_f32 v108, v80, v81
    v_mfma_f32_32x32x16_bf16 v[136:151], v[28:31], v[116:119], v[136:151]
    s_waitcnt lgkmcnt(0)
    v_exp_f32 v84, v84
    v_exp_f32 v85, v85
    v_cvt_pk_bf16_f32 v109, v82, v83
    v_exp_f32 v86, v86
    v_exp_f32 v87, v87
    v_exp_f32 v88, v88
    v_exp_f32 v89, v89
    v_cvt_pk_bf16_f32 v110, v84, v85
    v_exp_f32 v90, v90
    v_exp_f32 v91, v91
    v_cvt_pk_bf16_f32 v111, v86, v87
    v_cvt_pk_bf16_f32 v112, v88, v89
    v_mfma_f32_32x32x16_bf16 v[72:87], v[16:19], v[8:11], v[40:55]
    ds_read_b128 v[24:27], v238 offset:20800
    v_exp_f32 v92, v92
    v_exp_f32 v93, v93
    v_cvt_pk_bf16_f32 v113, v90, v91
    v_exp_f32 v94, v94
    v_exp_f32 v95, v95
    v_cvt_pk_bf16_f32 v114, v92, v93
    v_mfma_f32_32x32x16_bf16 v[120:135], v[32:35], v[104:107], v[120:135]
    ds_read_b128 v[28:31], v238 offset:20816
    v_exp_f32 v96, v96
    v_exp_f32 v97, v97
    v_cvt_pk_bf16_f32 v115, v94, v95
    v_exp_f32 v98, v98
    v_exp_f32 v99, v99
    v_cvt_pk_bf16_f32 v116, v96, v97
    v_mfma_f32_32x32x16_bf16 v[120:135], v[36:39], v[108:111], v[120:135]
    ds_read_b128 v[20:23], v237 offset:22880
    buffer_load_dwordx4 a[76:79], v225, s[4:7], s35 offen offset:1024 sc1
    v_exp_f32 v100, v100
    v_exp_f32 v101, v101
    v_cvt_pk_bf16_f32 v117, v98, v99
    v_exp_f32 v102, v102
    v_exp_f32 v103, v103
    v_exp_f32 v72, v72
    v_exp_f32 v73, v73
    v_cvt_pk_bf16_f32 v118, v100, v101
    v_exp_f32 v74, v74
    v_exp_f32 v75, v75
    v_cvt_pk_bf16_f32 v119, v102, v103
    v_cvt_pk_bf16_f32 v104, v72, v73
    v_mfma_f32_32x32x16_bf16 v[88:103], v[16:19], v[12:15], v[56:71]
    buffer_load_dwordx4 v240, s[4:7], s51 offen offset:2048 sc1 lds
    v_exp_f32 v76, v76
    v_exp_f32 v77, v77
    v_cvt_pk_bf16_f32 v105, v74, v75
    v_exp_f32 v78, v78
    v_exp_f32 v79, v79
    v_cvt_pk_bf16_f32 v106, v76, v77
    v_mfma_f32_32x32x16_bf16 v[136:151], v[32:35], v[112:115], v[136:151]
    buffer_load_dwordx4 v241, s[4:7], s51 offen offset:3072 sc1 lds
    s_add_u32 m0, s45, 16384
    s_add_u32 s51, s44, 4096
    v_exp_f32 v80, v80
    v_exp_f32 v81, v81
    v_cvt_pk_bf16_f32 v107, v78, v79
    v_exp_f32 v82, v82
    v_exp_f32 v83, v83
    v_cvt_pk_bf16_f32 v108, v80, v81
    v_mfma_f32_32x32x16_bf16 v[136:151], v[36:39], v[116:119], v[136:151]
    s_waitcnt lgkmcnt(0)
    v_exp_f32 v84, v84
    v_exp_f32 v85, v85
    v_cvt_pk_bf16_f32 v109, v82, v83
    v_exp_f32 v86, v86
    v_exp_f32 v87, v87
    v_exp_f32 v88, v88
    v_exp_f32 v89, v89
    v_cvt_pk_bf16_f32 v110, v84, v85
    v_exp_f32 v90, v90
    v_exp_f32 v91, v91
    v_cvt_pk_bf16_f32 v111, v86, v87
    v_cvt_pk_bf16_f32 v112, v88, v89
    v_mfma_f32_32x32x16_bf16 v[72:87], v[20:23], v[8:11], v[40:55]
    ds_read_b128 v[32:35], v238 offset:22880
    v_exp_f32 v92, v92
    v_exp_f32 v93, v93
    v_cvt_pk_bf16_f32 v113, v90, v91
    v_exp_f32 v94, v94
    v_exp_f32 v95, v95
    v_cvt_pk_bf16_f32 v114, v92, v93
    v_mfma_f32_32x32x16_bf16 v[120:135], v[24:27], v[104:107], v[120:135]
    ds_read_b128 v[36:39], v238 offset:22896
    v_exp_f32 v96, v96
    v_exp_f32 v97, v97
    v_cvt_pk_bf16_f32 v115, v94, v95
    v_exp_f32 v98, v98
    v_exp_f32 v99, v99
    v_cvt_pk_bf16_f32 v116, v96, v97
    v_mfma_f32_32x32x16_bf16 v[120:135], v[28:31], v[108:111], v[120:135]
    ds_read_b128 v[16:19], v237 offset:24960
    buffer_load_dwordx4 a[80:83], v225, s[4:7], s34 offen offset:2048 sc1
    v_exp_f32 v100, v100
    v_exp_f32 v101, v101
    v_cvt_pk_bf16_f32 v117, v98, v99
    v_exp_f32 v102, v102
    v_exp_f32 v103, v103
    v_exp_f32 v72, v72
    v_exp_f32 v73, v73
    v_cvt_pk_bf16_f32 v118, v100, v101
    v_exp_f32 v74, v74
    v_exp_f32 v75, v75
    v_cvt_pk_bf16_f32 v119, v102, v103
    v_cvt_pk_bf16_f32 v104, v72, v73
    v_mfma_f32_32x32x16_bf16 v[88:103], v[20:23], v[12:15], v[56:71]
    buffer_load_dwordx4 v1, s[4:7], s51 offen offset:0 sc1 lds
    v_exp_f32 v76, v76
    v_exp_f32 v77, v77
    v_cvt_pk_bf16_f32 v105, v74, v75
    v_exp_f32 v78, v78
    v_exp_f32 v79, v79
    v_cvt_pk_bf16_f32 v106, v76, v77
    v_mfma_f32_32x32x16_bf16 v[136:151], v[24:27], v[112:115], v[136:151]
    buffer_load_dwordx4 v239, s[4:7], s51 offen offset:1024 sc1 lds
    v_exp_f32 v80, v80
    v_exp_f32 v81, v81
    v_cvt_pk_bf16_f32 v107, v78, v79
    v_exp_f32 v82, v82
    v_exp_f32 v83, v83
    v_cvt_pk_bf16_f32 v108, v80, v81
    v_mfma_f32_32x32x16_bf16 v[136:151], v[28:31], v[116:119], v[136:151]
    s_waitcnt lgkmcnt(0)
    v_exp_f32 v84, v84
    v_exp_f32 v85, v85
    v_cvt_pk_bf16_f32 v109, v82, v83
    v_exp_f32 v86, v86
    v_exp_f32 v87, v87
    v_exp_f32 v88, v88
    v_exp_f32 v89, v89
    v_cvt_pk_bf16_f32 v110, v84, v85
    v_exp_f32 v90, v90
    v_exp_f32 v91, v91
    v_cvt_pk_bf16_f32 v111, v86, v87
    v_cvt_pk_bf16_f32 v112, v88, v89
    v_mfma_f32_32x32x16_bf16 v[72:87], v[16:19], v[8:11], v[40:55]
    ds_read_b128 v[24:27], v238 offset:24960
    v_exp_f32 v92, v92
    v_exp_f32 v93, v93
    v_cvt_pk_bf16_f32 v113, v90, v91
    v_exp_f32 v94, v94
    v_exp_f32 v95, v95
    v_cvt_pk_bf16_f32 v114, v92, v93
    v_mfma_f32_32x32x16_bf16 v[120:135], v[32:35], v[104:107], v[120:135]
    ds_read_b128 v[28:31], v238 offset:24976
    v_exp_f32 v96, v96
    v_exp_f32 v97, v97
    v_cvt_pk_bf16_f32 v115, v94, v95
    v_exp_f32 v98, v98
    v_exp_f32 v99, v99
    v_cvt_pk_bf16_f32 v116, v96, v97
    v_mfma_f32_32x32x16_bf16 v[120:135], v[36:39], v[108:111], v[120:135]
    ds_read_b128 v[20:23], v237 offset:27040
    buffer_load_dwordx4 a[84:87], v225, s[4:7], s35 offen offset:2048 sc1
    v_exp_f32 v100, v100
    v_exp_f32 v101, v101
    v_cvt_pk_bf16_f32 v117, v98, v99
    v_exp_f32 v102, v102
    v_exp_f32 v103, v103
    v_exp_f32 v72, v72
    v_exp_f32 v73, v73
    v_cvt_pk_bf16_f32 v118, v100, v101
    v_exp_f32 v74, v74
    v_exp_f32 v75, v75
    v_cvt_pk_bf16_f32 v119, v102, v103
    v_cvt_pk_bf16_f32 v104, v72, v73
    v_mfma_f32_32x32x16_bf16 v[88:103], v[16:19], v[12:15], v[56:71]
    buffer_load_dwordx4 v240, s[4:7], s51 offen offset:2048 sc1 lds
    v_exp_f32 v76, v76
    v_exp_f32 v77, v77
    v_cvt_pk_bf16_f32 v105, v74, v75
    v_exp_f32 v78, v78
    v_exp_f32 v79, v79
    v_cvt_pk_bf16_f32 v106, v76, v77
    v_mfma_f32_32x32x16_bf16 v[136:151], v[32:35], v[112:115], v[136:151]
    buffer_load_dwordx4 v241, s[4:7], s51 offen offset:3072 sc1 lds
    s_add_u32 m0, s45, 32768
    s_add_u32 s51, s44, 8192
    v_exp_f32 v80, v80
    v_exp_f32 v81, v81
    v_cvt_pk_bf16_f32 v107, v78, v79
    v_exp_f32 v82, v82
    v_exp_f32 v83, v83
    v_cvt_pk_bf16_f32 v108, v80, v81
    v_mfma_f32_32x32x16_bf16 v[136:151], v[36:39], v[116:119], v[136:151]
    s_waitcnt lgkmcnt(0)
    v_exp_f32 v84, v84
    v_exp_f32 v85, v85
    v_cvt_pk_bf16_f32 v109, v82, v83
    v_exp_f32 v86, v86
    v_exp_f32 v87, v87
    v_exp_f32 v88, v88
    v_exp_f32 v89, v89
    v_cvt_pk_bf16_f32 v110, v84, v85
    v_exp_f32 v90, v90
    v_exp_f32 v91, v91
    v_cvt_pk_bf16_f32 v111, v86, v87
    v_cvt_pk_bf16_f32 v112, v88, v89
    v_mfma_f32_32x32x16_bf16 v[72:87], v[20:23], v[8:11], v[40:55]
    ds_read_b128 v[32:35], v238 offset:27040
    v_exp_f32 v92, v92
    v_exp_f32 v93, v93
    v_cvt_pk_bf16_f32 v113, v90, v91
    v_exp_f32 v94, v94
    v_exp_f32 v95, v95
    v_cvt_pk_bf16_f32 v114, v92, v93
    v_mfma_f32_32x32x16_bf16 v[120:135], v[24:27], v[104:107], v[120:135]
    ds_read_b128 v[36:39], v238 offset:27056
    v_exp_f32 v96, v96
    v_exp_f32 v97, v97
    v_cvt_pk_bf16_f32 v115, v94, v95
    v_exp_f32 v98, v98
    v_exp_f32 v99, v99
    v_cvt_pk_bf16_f32 v116, v96, v97
    v_mfma_f32_32x32x16_bf16 v[120:135], v[28:31], v[108:111], v[120:135]
    ds_read_b128 v[16:19], v237 offset:29120
    buffer_load_dwordx4 a[88:91], v225, s[4:7], s34 offen offset:3072 sc1
    v_exp_f32 v100, v100
    v_exp_f32 v101, v101
    v_cvt_pk_bf16_f32 v117, v98, v99
    v_exp_f32 v102, v102
    v_exp_f32 v103, v103
    v_exp_f32 v72, v72
    v_exp_f32 v73, v73
    v_cvt_pk_bf16_f32 v118, v100, v101
    v_exp_f32 v74, v74
    v_exp_f32 v75, v75
    v_cvt_pk_bf16_f32 v119, v102, v103
    v_cvt_pk_bf16_f32 v104, v72, v73
    v_mfma_f32_32x32x16_bf16 v[88:103], v[20:23], v[12:15], v[56:71]
    buffer_load_dwordx4 v1, s[4:7], s51 offen offset:0 sc1 lds
    v_exp_f32 v76, v76
    v_exp_f32 v77, v77
    v_cvt_pk_bf16_f32 v105, v74, v75
    v_exp_f32 v78, v78
    v_exp_f32 v79, v79
    v_cvt_pk_bf16_f32 v106, v76, v77
    v_mfma_f32_32x32x16_bf16 v[136:151], v[24:27], v[112:115], v[136:151]
    buffer_load_dwordx4 v239, s[4:7], s51 offen offset:1024 sc1 lds
    v_exp_f32 v80, v80
    v_exp_f32 v81, v81
    v_cvt_pk_bf16_f32 v107, v78, v79
    v_exp_f32 v82, v82
    v_exp_f32 v83, v83
    v_cvt_pk_bf16_f32 v108, v80, v81
    v_mfma_f32_32x32x16_bf16 v[136:151], v[28:31], v[116:119], v[136:151]
    s_waitcnt lgkmcnt(0)
    v_exp_f32 v84, v84
    v_exp_f32 v85, v85
    v_cvt_pk_bf16_f32 v109, v82, v83
    v_exp_f32 v86, v86
    v_exp_f32 v87, v87
    v_exp_f32 v88, v88
    v_exp_f32 v89, v89
    v_cvt_pk_bf16_f32 v110, v84, v85
    v_exp_f32 v90, v90
    v_exp_f32 v91, v91
    v_cvt_pk_bf16_f32 v111, v86, v87
    v_cvt_pk_bf16_f32 v112, v88, v89
    v_mfma_f32_32x32x16_bf16 v[72:87], v[16:19], v[8:11], v[40:55]
    ds_read_b128 v[24:27], v238 offset:29120
    v_exp_f32 v92, v92
    v_exp_f32 v93, v93
    v_cvt_pk_bf16_f32 v113, v90, v91
    v_exp_f32 v94, v94
    v_exp_f32 v95, v95
    v_cvt_pk_bf16_f32 v114, v92, v93
    v_mfma_f32_32x32x16_bf16 v[120:135], v[32:35], v[104:107], v[120:135]
    ds_read_b128 v[28:31], v238 offset:29136
    v_exp_f32 v96, v96
    v_exp_f32 v97, v97
    v_cvt_pk_bf16_f32 v115, v94, v95
    v_exp_f32 v98, v98
    v_exp_f32 v99, v99
    v_cvt_pk_bf16_f32 v116, v96, v97
    v_mfma_f32_32x32x16_bf16 v[120:135], v[36:39], v[108:111], v[120:135]
    ds_read_b128 v[20:23], v237 offset:31200
    buffer_load_dwordx4 a[92:95], v225, s[4:7], s35 offen offset:3072 sc1
    v_exp_f32 v100, v100
    v_exp_f32 v101, v101
    v_cvt_pk_bf16_f32 v117, v98, v99
    v_exp_f32 v102, v102
    v_exp_f32 v103, v103
    v_exp_f32 v72, v72
    v_exp_f32 v73, v73
    v_cvt_pk_bf16_f32 v118, v100, v101
    v_exp_f32 v74, v74
    v_exp_f32 v75, v75
    v_cvt_pk_bf16_f32 v119, v102, v103
    v_cvt_pk_bf16_f32 v104, v72, v73
    v_mfma_f32_32x32x16_bf16 v[88:103], v[16:19], v[12:15], v[56:71]
    buffer_load_dwordx4 v240, s[4:7], s51 offen offset:2048 sc1 lds
    v_exp_f32 v76, v76
    v_exp_f32 v77, v77
    v_cvt_pk_bf16_f32 v105, v74, v75
    v_exp_f32 v78, v78
    v_exp_f32 v79, v79
    v_cvt_pk_bf16_f32 v106, v76, v77
    v_mfma_f32_32x32x16_bf16 v[136:151], v[32:35], v[112:115], v[136:151]
    buffer_load_dwordx4 v241, s[4:7], s51 offen offset:3072 sc1 lds
    s_add_u32 m0, s45, 49152
    s_add_u32 s51, s44, 12288
    v_exp_f32 v80, v80
    v_exp_f32 v81, v81
    v_cvt_pk_bf16_f32 v107, v78, v79
    v_exp_f32 v82, v82
    v_exp_f32 v83, v83
    v_cvt_pk_bf16_f32 v108, v80, v81
    v_mfma_f32_32x32x16_bf16 v[136:151], v[36:39], v[116:119], v[136:151]
    s_waitcnt lgkmcnt(0)
    v_exp_f32 v84, v84
    v_exp_f32 v85, v85
    v_cvt_pk_bf16_f32 v109, v82, v83
    v_exp_f32 v86, v86
    v_exp_f32 v87, v87
    v_exp_f32 v88, v88
    v_exp_f32 v89, v89
    v_cvt_pk_bf16_f32 v110, v84, v85
    v_exp_f32 v90, v90
    v_exp_f32 v91, v91
    v_cvt_pk_bf16_f32 v111, v86, v87
    v_cvt_pk_bf16_f32 v112, v88, v89
    v_mfma_f32_32x32x16_bf16 v[72:87], v[20:23], v[8:11], v[40:55]
    ds_read_b128 v[32:35], v238 offset:31200
    v_exp_f32 v92, v92
    v_exp_f32 v93, v93
    v_cvt_pk_bf16_f32 v113, v90, v91
    v_exp_f32 v94, v94
    v_exp_f32 v95, v95
    v_cvt_pk_bf16_f32 v114, v92, v93
    v_mfma_f32_32x32x16_bf16 v[120:135], v[24:27], v[104:107], v[120:135]
    ds_read_b128 v[36:39], v238 offset:31216
    v_exp_f32 v96, v96
    v_exp_f32 v97, v97
    v_cvt_pk_bf16_f32 v115, v94, v95
    v_exp_f32 v98, v98
    v_exp_f32 v99, v99
    v_cvt_pk_bf16_f32 v116, v96, v97
    v_mfma_f32_32x32x16_bf16 v[120:135], v[28:31], v[108:111], v[120:135]
    ds_read_b128 v[16:19], v237 offset:33280
    buffer_load_dwordx4 a[96:99], v226, s[4:7], s34 offen offset:0 sc1
    v_exp_f32 v100, v100
    v_exp_f32 v101, v101
    v_cvt_pk_bf16_f32 v117, v98, v99
    v_exp_f32 v102, v102
    v_exp_f32 v103, v103
    v_exp_f32 v72, v72
    v_exp_f32 v73, v73
    v_cvt_pk_bf16_f32 v118, v100, v101
    v_exp_f32 v74, v74
    v_exp_f32 v75, v75
    v_cvt_pk_bf16_f32 v119, v102, v103
    v_cvt_pk_bf16_f32 v104, v72, v73
    v_mfma_f32_32x32x16_bf16 v[88:103], v[20:23], v[12:15], v[56:71]
    buffer_load_dwordx4 v1, s[4:7], s51 offen offset:0 sc1 lds
    v_exp_f32 v76, v76
    v_exp_f32 v77, v77
    v_cvt_pk_bf16_f32 v105, v74, v75
    v_exp_f32 v78, v78
    v_exp_f32 v79, v79
    v_cvt_pk_bf16_f32 v106, v76, v77
    v_mfma_f32_32x32x16_bf16 v[136:151], v[24:27], v[112:115], v[136:151]
    buffer_load_dwordx4 v239, s[4:7], s51 offen offset:1024 sc1 lds
    v_exp_f32 v80, v80
    v_exp_f32 v81, v81
    v_cvt_pk_bf16_f32 v107, v78, v79
    v_exp_f32 v82, v82
    v_exp_f32 v83, v83
    v_cvt_pk_bf16_f32 v108, v80, v81
    v_mfma_f32_32x32x16_bf16 v[136:151], v[28:31], v[116:119], v[136:151]
    s_waitcnt lgkmcnt(0)
    v_exp_f32 v84, v84
    v_exp_f32 v85, v85
    v_cvt_pk_bf16_f32 v109, v82, v83
    v_exp_f32 v86, v86
    v_exp_f32 v87, v87
    v_exp_f32 v88, v88
    v_exp_f32 v89, v89
    v_cvt_pk_bf16_f32 v110, v84, v85
    v_exp_f32 v90, v90
    v_exp_f32 v91, v91
    v_cvt_pk_bf16_f32 v111, v86, v87
    v_cvt_pk_bf16_f32 v112, v88, v89
    v_mfma_f32_32x32x16_bf16 v[72:87], v[16:19], v[8:11], v[40:55]
    ds_read_b128 v[24:27], v238 offset:33280
    v_exp_f32 v92, v92
    v_exp_f32 v93, v93
    v_cvt_pk_bf16_f32 v113, v90, v91
    v_exp_f32 v94, v94
    v_exp_f32 v95, v95
    v_cvt_pk_bf16_f32 v114, v92, v93
    v_mfma_f32_32x32x16_bf16 v[120:135], v[32:35], v[104:107], v[120:135]
    ds_read_b128 v[28:31], v238 offset:33296
    v_exp_f32 v96, v96
    v_exp_f32 v97, v97
    v_cvt_pk_bf16_f32 v115, v94, v95
    v_exp_f32 v98, v98
    v_exp_f32 v99, v99
    v_cvt_pk_bf16_f32 v116, v96, v97
    v_mfma_f32_32x32x16_bf16 v[120:135], v[36:39], v[108:111], v[120:135]
    ds_read_b128 v[20:23], v237 offset:35360
    buffer_load_dwordx4 a[100:103], v226, s[4:7], s35 offen offset:0 sc1
    v_exp_f32 v100, v100
    v_exp_f32 v101, v101
    v_cvt_pk_bf16_f32 v117, v98, v99
    v_exp_f32 v102, v102
    v_exp_f32 v103, v103
    v_exp_f32 v72, v72
    v_exp_f32 v73, v73
    v_cvt_pk_bf16_f32 v118, v100, v101
    v_exp_f32 v74, v74
    v_exp_f32 v75, v75
    v_cvt_pk_bf16_f32 v119, v102, v103
    v_cvt_pk_bf16_f32 v104, v72, v73
    v_mfma_f32_32x32x16_bf16 v[88:103], v[16:19], v[12:15], v[56:71]
    buffer_load_dwordx4 v240, s[4:7], s51 offen offset:2048 sc1 lds
    v_exp_f32 v76, v76
    v_exp_f32 v77, v77
    v_cvt_pk_bf16_f32 v105, v74, v75
    v_exp_f32 v78, v78
    v_exp_f32 v79, v79
    v_cvt_pk_bf16_f32 v106, v76, v77
    v_mfma_f32_32x32x16_bf16 v[136:151], v[32:35], v[112:115], v[136:151]
    buffer_load_dwordx4 v241, s[4:7], s51 offen offset:3072 sc1 lds
    s_add_u32 m0, s45, 65536
    s_add_u32 s51, s44, 16384
    v_exp_f32 v80, v80
    v_exp_f32 v81, v81
    v_cvt_pk_bf16_f32 v107, v78, v79
    v_exp_f32 v82, v82
    v_exp_f32 v83, v83
    v_cvt_pk_bf16_f32 v108, v80, v81
    v_mfma_f32_32x32x16_bf16 v[136:151], v[36:39], v[116:119], v[136:151]
    s_waitcnt lgkmcnt(0)
    v_exp_f32 v84, v84
    v_exp_f32 v85, v85
    v_cvt_pk_bf16_f32 v109, v82, v83
    v_exp_f32 v86, v86
    v_exp_f32 v87, v87
    v_exp_f32 v88, v88
    v_exp_f32 v89, v89
    v_cvt_pk_bf16_f32 v110, v84, v85
    v_exp_f32 v90, v90
    v_exp_f32 v91, v91
    v_cvt_pk_bf16_f32 v111, v86, v87
    v_cvt_pk_bf16_f32 v112, v88, v89
    v_mfma_f32_32x32x16_bf16 v[72:87], v[20:23], v[8:11], v[40:55]
    ds_read_b128 v[32:35], v238 offset:35360
    v_exp_f32 v92, v92
    v_exp_f32 v93, v93
    v_cvt_pk_bf16_f32 v113, v90, v91
    v_exp_f32 v94, v94
    v_exp_f32 v95, v95
    v_cvt_pk_bf16_f32 v114, v92, v93
    v_mfma_f32_32x32x16_bf16 v[120:135], v[24:27], v[104:107], v[120:135]
    ds_read_b128 v[36:39], v238 offset:35376
    v_exp_f32 v96, v96
    v_exp_f32 v97, v97
    v_cvt_pk_bf16_f32 v115, v94, v95
    v_exp_f32 v98, v98
    v_exp_f32 v99, v99
    v_cvt_pk_bf16_f32 v116, v96, v97
    v_mfma_f32_32x32x16_bf16 v[120:135], v[28:31], v[108:111], v[120:135]
    ds_read_b128 v[16:19], v237 offset:37440
    buffer_load_dwordx4 a[104:107], v226, s[4:7], s34 offen offset:1024 sc1
    v_exp_f32 v100, v100
    v_exp_f32 v101, v101
    v_cvt_pk_bf16_f32 v117, v98, v99
    v_exp_f32 v102, v102
    v_exp_f32 v103, v103
    v_exp_f32 v72, v72
    v_exp_f32 v73, v73
    v_cvt_pk_bf16_f32 v118, v100, v101
    v_exp_f32 v74, v74
    v_exp_f32 v75, v75
    v_cvt_pk_bf16_f32 v119, v102, v103
    v_cvt_pk_bf16_f32 v104, v72, v73
    v_mfma_f32_32x32x16_bf16 v[88:103], v[20:23], v[12:15], v[56:71]
    s_mov_b32 exec_lo, 0xffff0000
    s_mov_b32 exec_hi, 0x0
    buffer_load_dword v248, v247, s[4:7], 0 offen
    s_mov_b64 exec, -1
    v_exp_f32 v76, v76
    v_exp_f32 v77, v77
    v_cvt_pk_bf16_f32 v105, v74, v75
    v_exp_f32 v78, v78
    v_exp_f32 v79, v79
    v_cvt_pk_bf16_f32 v106, v76, v77
    v_mfma_f32_32x32x16_bf16 v[136:151], v[24:27], v[112:115], v[136:151]
    buffer_load_dwordx4 v1, s[4:7], s51 offen offset:0 sc1 lds
    v_exp_f32 v80, v80
    v_exp_f32 v81, v81
    v_cvt_pk_bf16_f32 v107, v78, v79
    v_exp_f32 v82, v82
    v_exp_f32 v83, v83
    v_cvt_pk_bf16_f32 v108, v80, v81
    v_mfma_f32_32x32x16_bf16 v[136:151], v[28:31], v[116:119], v[136:151]
    s_waitcnt lgkmcnt(0)
    v_exp_f32 v84, v84
    v_exp_f32 v85, v85
    v_cvt_pk_bf16_f32 v109, v82, v83
    v_exp_f32 v86, v86
    v_exp_f32 v87, v87
    v_exp_f32 v88, v88
    v_exp_f32 v89, v89
    v_cvt_pk_bf16_f32 v110, v84, v85
    v_exp_f32 v90, v90
    v_exp_f32 v91, v91
    v_cvt_pk_bf16_f32 v111, v86, v87
    v_cvt_pk_bf16_f32 v112, v88, v89
    v_mfma_f32_32x32x16_bf16 v[72:87], v[16:19], v[8:11], v[40:55]
    ds_read_b128 v[24:27], v238 offset:37440
    v_exp_f32 v92, v92
    v_exp_f32 v93, v93
    v_cvt_pk_bf16_f32 v113, v90, v91
    v_exp_f32 v94, v94
    v_exp_f32 v95, v95
    v_cvt_pk_bf16_f32 v114, v92, v93
    v_mfma_f32_32x32x16_bf16 v[120:135], v[32:35], v[104:107], v[120:135]
    ds_read_b128 v[28:31], v238 offset:37456
    v_exp_f32 v96, v96
    v_exp_f32 v97, v97
    v_cvt_pk_bf16_f32 v115, v94, v95
    v_exp_f32 v98, v98
    v_exp_f32 v99, v99
    v_cvt_pk_bf16_f32 v116, v96, v97
    v_mfma_f32_32x32x16_bf16 v[120:135], v[36:39], v[108:111], v[120:135]
    ds_read_b128 v[20:23], v237 offset:39520
    buffer_load_dwordx4 a[108:111], v226, s[4:7], s35 offen offset:1024 sc1
    v_exp_f32 v100, v100
    v_exp_f32 v101, v101
    v_cvt_pk_bf16_f32 v117, v98, v99
    v_exp_f32 v102, v102
    v_exp_f32 v103, v103
    v_exp_f32 v72, v72
    v_exp_f32 v73, v73
    v_cvt_pk_bf16_f32 v118, v100, v101
    v_exp_f32 v74, v74
    v_exp_f32 v75, v75
    v_cvt_pk_bf16_f32 v119, v102, v103
    v_cvt_pk_bf16_f32 v104, v72, v73
    v_mfma_f32_32x32x16_bf16 v[88:103], v[16:19], v[12:15], v[56:71]
    buffer_load_dwordx4 v239, s[4:7], s51 offen offset:1024 sc1 lds
    v_exp_f32 v76, v76
    v_exp_f32 v77, v77
    v_cvt_pk_bf16_f32 v105, v74, v75
    v_exp_f32 v78, v78
    v_exp_f32 v79, v79
    v_cvt_pk_bf16_f32 v106, v76, v77
    v_mfma_f32_32x32x16_bf16 v[136:151], v[32:35], v[112:115], v[136:151]
    buffer_load_dwordx4 v240, s[4:7], s51 offen offset:2048 sc1 lds
    v_exp_f32 v80, v80
    v_exp_f32 v81, v81
    v_cvt_pk_bf16_f32 v107, v78, v79
    v_exp_f32 v82, v82
    v_exp_f32 v83, v83
    v_cvt_pk_bf16_f32 v108, v80, v81
    v_mfma_f32_32x32x16_bf16 v[136:151], v[36:39], v[116:119], v[136:151]
    s_waitcnt lgkmcnt(0)
    v_exp_f32 v84, v84
    v_exp_f32 v85, v85
    v_cvt_pk_bf16_f32 v109, v82, v83
    v_exp_f32 v86, v86
    v_exp_f32 v87, v87
    v_exp_f32 v88, v88
    v_exp_f32 v89, v89
    v_cvt_pk_bf16_f32 v110, v84, v85
    v_exp_f32 v90, v90
    v_exp_f32 v91, v91
    v_cvt_pk_bf16_f32 v111, v86, v87
    v_cvt_pk_bf16_f32 v112, v88, v89
    v_mfma_f32_32x32x16_bf16 v[72:87], v[20:23], v[8:11], v[40:55]
    ds_read_b128 v[32:35], v238 offset:39520
    v_exp_f32 v92, v92
    v_exp_f32 v93, v93
    v_cvt_pk_bf16_f32 v113, v90, v91
    v_exp_f32 v94, v94
    v_exp_f32 v95, v95
    v_cvt_pk_bf16_f32 v114, v92, v93
    v_mfma_f32_32x32x16_bf16 v[120:135], v[24:27], v[104:107], v[120:135]
    ds_read_b128 v[36:39], v238 offset:39536
    v_exp_f32 v96, v96
    v_exp_f32 v97, v97
    v_cvt_pk_bf16_f32 v115, v94, v95
    v_exp_f32 v98, v98
    v_exp_f32 v99, v99
    v_cvt_pk_bf16_f32 v116, v96, v97
    v_mfma_f32_32x32x16_bf16 v[120:135], v[28:31], v[108:111], v[120:135]
    ds_read_b128 v[16:19], v237 offset:41600
    buffer_load_dwordx4 a[112:115], v226, s[4:7], s34 offen offset:2048 sc1
    v_exp_f32 v100, v100
    v_exp_f32 v101, v101
    v_cvt_pk_bf16_f32 v117, v98, v99
    v_exp_f32 v102, v102
    v_exp_f32 v103, v103
    v_exp_f32 v72, v72
    v_exp_f32 v73, v73
    v_cvt_pk_bf16_f32 v118, v100, v101
    v_exp_f32 v74, v74
    v_exp_f32 v75, v75
    v_cvt_pk_bf16_f32 v119, v102, v103
    v_cvt_pk_bf16_f32 v104, v72, v73
    v_mfma_f32_32x32x16_bf16 v[88:103], v[20:23], v[12:15], v[56:71]
    buffer_load_dwordx4 v241, s[4:7], s51 offen offset:3072 sc1 lds
    v_exp_f32 v76, v76
    v_exp_f32 v77, v77
    v_cvt_pk_bf16_f32 v105, v74, v75
    v_exp_f32 v78, v78
    v_exp_f32 v79, v79
    v_cvt_pk_bf16_f32 v106, v76, v77
    v_mfma_f32_32x32x16_bf16 v[136:151], v[24:27], v[112:115], v[136:151]
    buffer_load_dwordx4 a[180:183], v239, s[4:7], s80 offen offset:1024 sc1
    v_exp_f32 v80, v80
    v_exp_f32 v81, v81
    v_cvt_pk_bf16_f32 v107, v78, v79
    v_exp_f32 v82, v82
    v_exp_f32 v83, v83
    v_cvt_pk_bf16_f32 v108, v80, v81
    v_mfma_f32_32x32x16_bf16 v[136:151], v[28:31], v[116:119], v[136:151]
    s_waitcnt lgkmcnt(0)
    v_exp_f32 v84, v84
    v_exp_f32 v85, v85
    v_cvt_pk_bf16_f32 v109, v82, v83
    v_exp_f32 v86, v86
    v_exp_f32 v87, v87
    v_exp_f32 v88, v88
    v_exp_f32 v89, v89
    v_cvt_pk_bf16_f32 v110, v84, v85
    v_exp_f32 v90, v90
    v_exp_f32 v91, v91
    v_cvt_pk_bf16_f32 v111, v86, v87
    v_cvt_pk_bf16_f32 v112, v88, v89
    v_mfma_f32_32x32x16_bf16 v[72:87], v[16:19], v[8:11], v[40:55]
    ds_read_b128 v[24:27], v238 offset:41600
    v_exp_f32 v92, v92
    v_exp_f32 v93, v93
    v_cvt_pk_bf16_f32 v113, v90, v91
    v_exp_f32 v94, v94
    v_exp_f32 v95, v95
    v_cvt_pk_bf16_f32 v114, v92, v93
    v_mfma_f32_32x32x16_bf16 v[120:135], v[32:35], v[104:107], v[120:135]
    ds_read_b128 v[28:31], v238 offset:41616
    v_exp_f32 v96, v96
    v_exp_f32 v97, v97
    v_cvt_pk_bf16_f32 v115, v94, v95
    v_exp_f32 v98, v98
    v_exp_f32 v99, v99
    v_cvt_pk_bf16_f32 v116, v96, v97
    v_mfma_f32_32x32x16_bf16 v[120:135], v[36:39], v[108:111], v[120:135]
    ds_read_b128 v[20:23], v237 offset:43680
    buffer_load_dwordx4 a[116:119], v226, s[4:7], s35 offen offset:2048 sc1
    v_exp_f32 v100, v100
    v_exp_f32 v101, v101
    v_cvt_pk_bf16_f32 v117, v98, v99
    v_exp_f32 v102, v102
    v_exp_f32 v103, v103
    v_exp_f32 v72, v72
    v_exp_f32 v73, v73
    v_cvt_pk_bf16_f32 v118, v100, v101
    v_exp_f32 v74, v74
    v_exp_f32 v75, v75
    v_cvt_pk_bf16_f32 v119, v102, v103
    v_cvt_pk_bf16_f32 v104, v72, v73
    v_mfma_f32_32x32x16_bf16 v[88:103], v[16:19], v[12:15], v[56:71]
    buffer_load_dwordx4 a[184:187], v240, s[4:7], s80 offen offset:2048 sc1
    v_exp_f32 v76, v76
    v_exp_f32 v77, v77
    v_cvt_pk_bf16_f32 v105, v74, v75
    v_exp_f32 v78, v78
    v_exp_f32 v79, v79
    v_cvt_pk_bf16_f32 v106, v76, v77
    v_mfma_f32_32x32x16_bf16 v[136:151], v[32:35], v[112:115], v[136:151]
    buffer_load_dwordx4 a[188:191], v241, s[4:7], s80 offen offset:3072 sc1
    v_exp_f32 v80, v80
    v_exp_f32 v81, v81
    v_cvt_pk_bf16_f32 v107, v78, v79
    v_exp_f32 v82, v82
    v_exp_f32 v83, v83
    v_cvt_pk_bf16_f32 v108, v80, v81
    v_mfma_f32_32x32x16_bf16 v[136:151], v[36:39], v[116:119], v[136:151]
    s_waitcnt lgkmcnt(0)
    v_exp_f32 v84, v84
    v_exp_f32 v85, v85
    v_cvt_pk_bf16_f32 v109, v82, v83
    v_exp_f32 v86, v86
    v_exp_f32 v87, v87
    v_exp_f32 v88, v88
    v_exp_f32 v89, v89
    v_cvt_pk_bf16_f32 v110, v84, v85
    v_exp_f32 v90, v90
    v_exp_f32 v91, v91
    v_cvt_pk_bf16_f32 v111, v86, v87
    v_cvt_pk_bf16_f32 v112, v88, v89
    v_mfma_f32_32x32x16_bf16 v[72:87], v[20:23], v[8:11], v[40:55]
    ds_read_b128 v[32:35], v238 offset:43680
    v_exp_f32 v92, v92
    v_exp_f32 v93, v93
    v_cvt_pk_bf16_f32 v113, v90, v91
    v_exp_f32 v94, v94
    v_exp_f32 v95, v95
    v_cvt_pk_bf16_f32 v114, v92, v93
    v_mfma_f32_32x32x16_bf16 v[120:135], v[24:27], v[104:107], v[120:135]
    ds_read_b128 v[36:39], v238 offset:43696
    v_exp_f32 v96, v96
    v_exp_f32 v97, v97
    v_cvt_pk_bf16_f32 v115, v94, v95
    v_exp_f32 v98, v98
    v_exp_f32 v99, v99
    v_cvt_pk_bf16_f32 v116, v96, v97
    v_mfma_f32_32x32x16_bf16 v[120:135], v[28:31], v[108:111], v[120:135]
    ds_read_b128 v[16:19], v237 offset:45760
    buffer_load_dwordx4 a[120:123], v226, s[4:7], s34 offen offset:3072 sc1
    v_exp_f32 v100, v100
    v_exp_f32 v101, v101
    v_cvt_pk_bf16_f32 v117, v98, v99
    v_exp_f32 v102, v102
    v_exp_f32 v103, v103
    v_exp_f32 v72, v72
    v_exp_f32 v73, v73
    v_cvt_pk_bf16_f32 v118, v100, v101
    v_exp_f32 v74, v74
    v_exp_f32 v75, v75
    v_cvt_pk_bf16_f32 v119, v102, v103
    v_cvt_pk_bf16_f32 v104, v72, v73
    v_mfma_f32_32x32x16_bf16 v[88:103], v[20:23], v[12:15], v[56:71]
    buffer_load_dwordx4 a[192:195], v1, s[4:7], s81 offen offset:0 sc1
    v_exp_f32 v76, v76
    v_exp_f32 v77, v77
    v_cvt_pk_bf16_f32 v105, v74, v75
    v_exp_f32 v78, v78
    v_exp_f32 v79, v79
    v_cvt_pk_bf16_f32 v106, v76, v77
    v_mfma_f32_32x32x16_bf16 v[136:151], v[24:27], v[112:115], v[136:151]
    buffer_load_dwordx4 a[196:199], v1, s[4:7], s81 offen offset:1024 sc1
    v_exp_f32 v80, v80
    v_exp_f32 v81, v81
    v_cvt_pk_bf16_f32 v107, v78, v79
    v_exp_f32 v82, v82
    v_exp_f32 v83, v83
    v_cvt_pk_bf16_f32 v108, v80, v81
    v_mfma_f32_32x32x16_bf16 v[136:151], v[28:31], v[116:119], v[136:151]
    s_waitcnt lgkmcnt(0)
    v_exp_f32 v84, v84
    v_exp_f32 v85, v85
    v_cvt_pk_bf16_f32 v109, v82, v83
    v_exp_f32 v86, v86
    v_exp_f32 v87, v87
    v_exp_f32 v88, v88
    v_exp_f32 v89, v89
    v_cvt_pk_bf16_f32 v110, v84, v85
    v_exp_f32 v90, v90
    v_exp_f32 v91, v91
    v_cvt_pk_bf16_f32 v111, v86, v87
    v_cvt_pk_bf16_f32 v112, v88, v89
    v_mfma_f32_32x32x16_bf16 v[72:87], v[16:19], v[8:11], v[40:55]
    ds_read_b128 v[24:27], v238 offset:45760
    v_exp_f32 v92, v92
    v_exp_f32 v93, v93
    v_cvt_pk_bf16_f32 v113, v90, v91
    v_exp_f32 v94, v94
    v_exp_f32 v95, v95
    v_cvt_pk_bf16_f32 v114, v92, v93
    v_mfma_f32_32x32x16_bf16 v[120:135], v[32:35], v[104:107], v[120:135]
    ds_read_b128 v[28:31], v238 offset:45776
    v_exp_f32 v96, v96
    v_exp_f32 v97, v97
    v_cvt_pk_bf16_f32 v115, v94, v95
    v_exp_f32 v98, v98
    v_exp_f32 v99, v99
    v_cvt_pk_bf16_f32 v116, v96, v97
    v_mfma_f32_32x32x16_bf16 v[120:135], v[36:39], v[108:111], v[120:135]
    ds_read_b128 v[20:23], v237 offset:47840
    buffer_load_dwordx4 a[124:127], v226, s[4:7], s35 offen offset:3072 sc1
    v_exp_f32 v100, v100
    v_exp_f32 v101, v101
    v_cvt_pk_bf16_f32 v117, v98, v99
    v_exp_f32 v102, v102
    v_exp_f32 v103, v103
    v_exp_f32 v72, v72
    v_exp_f32 v73, v73
    v_cvt_pk_bf16_f32 v118, v100, v101
    v_exp_f32 v74, v74
    v_exp_f32 v75, v75
    v_cvt_pk_bf16_f32 v119, v102, v103
    v_cvt_pk_bf16_f32 v104, v72, v73
    v_mfma_f32_32x32x16_bf16 v[88:103], v[16:19], v[12:15], v[56:71]
    buffer_load_dwordx4 a[200:203], v1, s[4:7], s81 offen offset:2048 sc1
    v_exp_f32 v76, v76
    v_exp_f32 v77, v77
    v_cvt_pk_bf16_f32 v105, v74, v75
    v_exp_f32 v78, v78
    v_exp_f32 v79, v79
    v_cvt_pk_bf16_f32 v106, v76, v77
    v_mfma_f32_32x32x16_bf16 v[136:151], v[32:35], v[112:115], v[136:151]
    buffer_load_dwordx4 a[204:207], v1, s[4:7], s81 offen offset:3072 sc1
    v_exp_f32 v80, v80
    v_exp_f32 v81, v81
    v_cvt_pk_bf16_f32 v107, v78, v79
    v_exp_f32 v82, v82
    v_exp_f32 v83, v83
    v_cvt_pk_bf16_f32 v108, v80, v81
    v_mfma_f32_32x32x16_bf16 v[136:151], v[36:39], v[116:119], v[136:151]
    s_waitcnt lgkmcnt(0)
    v_exp_f32 v84, v84
    v_exp_f32 v85, v85
    v_cvt_pk_bf16_f32 v109, v82, v83
    v_exp_f32 v86, v86
    v_exp_f32 v87, v87
    v_exp_f32 v88, v88
    v_exp_f32 v89, v89
    v_cvt_pk_bf16_f32 v110, v84, v85
    v_exp_f32 v90, v90
    v_exp_f32 v91, v91
    v_cvt_pk_bf16_f32 v111, v86, v87
    v_cvt_pk_bf16_f32 v112, v88, v89
    v_mfma_f32_32x32x16_bf16 v[72:87], v[20:23], v[8:11], v[40:55]
    ds_read_b128 v[32:35], v238 offset:47840
    v_exp_f32 v92, v92
    v_exp_f32 v93, v93
    v_cvt_pk_bf16_f32 v113, v90, v91
    v_exp_f32 v94, v94
    v_exp_f32 v95, v95
    v_cvt_pk_bf16_f32 v114, v92, v93
    v_mfma_f32_32x32x16_bf16 v[120:135], v[24:27], v[104:107], v[120:135]
    ds_read_b128 v[36:39], v238 offset:47856
    v_exp_f32 v96, v96
    v_exp_f32 v97, v97
    v_cvt_pk_bf16_f32 v115, v94, v95
    v_exp_f32 v98, v98
    v_exp_f32 v99, v99
    v_cvt_pk_bf16_f32 v116, v96, v97
    v_mfma_f32_32x32x16_bf16 v[120:135], v[28:31], v[108:111], v[120:135]
    ds_read_b128 v[16:19], v237 offset:49920
    buffer_load_dwordx4 a[128:131], v227, s[4:7], s34 offen offset:0 sc1
    v_exp_f32 v100, v100
    v_exp_f32 v101, v101
    v_cvt_pk_bf16_f32 v117, v98, v99
    v_exp_f32 v102, v102
    v_exp_f32 v103, v103
    v_exp_f32 v72, v72
    v_exp_f32 v73, v73
    v_cvt_pk_bf16_f32 v118, v100, v101
    v_exp_f32 v74, v74
    v_exp_f32 v75, v75
    v_cvt_pk_bf16_f32 v119, v102, v103
    v_cvt_pk_bf16_f32 v104, v72, v73
    v_mfma_f32_32x32x16_bf16 v[88:103], v[20:23], v[12:15], v[56:71]
    buffer_load_dwordx4 a[208:211], v1, s[4:7], s82 offen offset:0 sc1
    v_exp_f32 v76, v76
    v_exp_f32 v77, v77
    v_cvt_pk_bf16_f32 v105, v74, v75
    v_exp_f32 v78, v78
    v_exp_f32 v79, v79
    v_cvt_pk_bf16_f32 v106, v76, v77
    v_mfma_f32_32x32x16_bf16 v[136:151], v[24:27], v[112:115], v[136:151]
    buffer_load_dwordx4 a[212:215], v1, s[4:7], s82 offen offset:1024 sc1
    v_exp_f32 v80, v80
    v_exp_f32 v81, v81
    v_cvt_pk_bf16_f32 v107, v78, v79
    v_exp_f32 v82, v82
    v_exp_f32 v83, v83
    v_cvt_pk_bf16_f32 v108, v80, v81
    v_mfma_f32_32x32x16_bf16 v[136:151], v[28:31], v[116:119], v[136:151]
    s_waitcnt lgkmcnt(0)
    v_exp_f32 v84, v84
    v_exp_f32 v85, v85
    v_cvt_pk_bf16_f32 v109, v82, v83
    v_exp_f32 v86, v86
    v_exp_f32 v87, v87
    v_exp_f32 v88, v88
    v_exp_f32 v89, v89
    v_cvt_pk_bf16_f32 v110, v84, v85
    v_exp_f32 v90, v90
    v_exp_f32 v91, v91
    v_cvt_pk_bf16_f32 v111, v86, v87
    v_cvt_pk_bf16_f32 v112, v88, v89
    v_mfma_f32_32x32x16_bf16 v[72:87], v[16:19], v[8:11], v[40:55]
    ds_read_b128 v[24:27], v238 offset:49920
    v_exp_f32 v92, v92
    v_exp_f32 v93, v93
    v_cvt_pk_bf16_f32 v113, v90, v91
    v_exp_f32 v94, v94
    v_exp_f32 v95, v95
    v_cvt_pk_bf16_f32 v114, v92, v93
    v_mfma_f32_32x32x16_bf16 v[120:135], v[32:35], v[104:107], v[120:135]
    ds_read_b128 v[28:31], v238 offset:49936
    v_exp_f32 v96, v96
    v_exp_f32 v97, v97
    v_cvt_pk_bf16_f32 v115, v94, v95
    v_exp_f32 v98, v98
    v_exp_f32 v99, v99
    v_cvt_pk_bf16_f32 v116, v96, v97
    v_mfma_f32_32x32x16_bf16 v[120:135], v[36:39], v[108:111], v[120:135]
    ds_read_b128 v[20:23], v237 offset:52000
    buffer_load_dwordx4 a[132:135], v227, s[4:7], s35 offen offset:0 sc1
    v_exp_f32 v100, v100
    v_exp_f32 v101, v101
    v_cvt_pk_bf16_f32 v117, v98, v99
    v_exp_f32 v102, v102
    v_exp_f32 v103, v103
    v_exp_f32 v72, v72
    v_exp_f32 v73, v73
    v_cvt_pk_bf16_f32 v118, v100, v101
    v_exp_f32 v74, v74
    v_exp_f32 v75, v75
    v_cvt_pk_bf16_f32 v119, v102, v103
    v_cvt_pk_bf16_f32 v104, v72, v73
    v_mfma_f32_32x32x16_bf16 v[88:103], v[16:19], v[12:15], v[56:71]
    buffer_load_dwordx4 a[216:219], v1, s[4:7], s82 offen offset:2048 sc1
    v_exp_f32 v76, v76
    v_exp_f32 v77, v77
    v_cvt_pk_bf16_f32 v105, v74, v75
    v_exp_f32 v78, v78
    v_exp_f32 v79, v79
    v_cvt_pk_bf16_f32 v106, v76, v77
    v_mfma_f32_32x32x16_bf16 v[136:151], v[32:35], v[112:115], v[136:151]
    buffer_load_dwordx4 a[220:223], v1, s[4:7], s82 offen offset:3072 sc1
    v_exp_f32 v80, v80
    v_exp_f32 v81, v81
    v_cvt_pk_bf16_f32 v107, v78, v79
    v_exp_f32 v82, v82
    v_exp_f32 v83, v83
    v_cvt_pk_bf16_f32 v108, v80, v81
    v_mfma_f32_32x32x16_bf16 v[136:151], v[36:39], v[116:119], v[136:151]
    s_waitcnt lgkmcnt(0)
    s_barrier
    v_exp_f32 v84, v84
    v_exp_f32 v85, v85
    v_cvt_pk_bf16_f32 v109, v82, v83
    v_exp_f32 v86, v86
    v_exp_f32 v87, v87
    v_exp_f32 v88, v88
    v_exp_f32 v89, v89
    v_cvt_pk_bf16_f32 v110, v84, v85
    v_exp_f32 v90, v90
    v_exp_f32 v91, v91
    v_cvt_pk_bf16_f32 v111, v86, v87
    v_cvt_pk_bf16_f32 v112, v88, v89
    v_mfma_f32_32x32x16_bf16 v[72:87], v[20:23], v[8:11], v[40:55]
    ds_read_b128 v[32:35], v238 offset:52000
    v_exp_f32 v92, v92
    v_exp_f32 v93, v93
    v_cvt_pk_bf16_f32 v113, v90, v91
    v_exp_f32 v94, v94
    v_exp_f32 v95, v95
    v_cvt_pk_bf16_f32 v114, v92, v93
    v_mfma_f32_32x32x16_bf16 v[120:135], v[24:27], v[104:107], v[120:135]
    ds_read_b128 v[36:39], v238 offset:52016
    v_exp_f32 v96, v96
    v_exp_f32 v97, v97
    v_cvt_pk_bf16_f32 v115, v94, v95
    v_exp_f32 v98, v98
    v_exp_f32 v99, v99
    v_cvt_pk_bf16_f32 v116, v96, v97
    v_mfma_f32_32x32x16_bf16 v[120:135], v[28:31], v[108:111], v[120:135]
    ds_read_b128 v[16:19], v237 offset:54080
    buffer_load_dwordx4 a[136:139], v227, s[4:7], s34 offen offset:1024 sc1
    v_exp_f32 v100, v100
    v_exp_f32 v101, v101
    v_cvt_pk_bf16_f32 v117, v98, v99
    v_exp_f32 v102, v102
    v_exp_f32 v103, v103
    v_exp_f32 v72, v72
    v_exp_f32 v73, v73
    v_cvt_pk_bf16_f32 v118, v100, v101
    v_exp_f32 v74, v74
    v_exp_f32 v75, v75
    v_cvt_pk_bf16_f32 v119, v102, v103
    v_cvt_pk_bf16_f32 v104, v72, v73
    v_mfma_f32_32x32x16_bf16 v[88:103], v[20:23], v[12:15], v[56:71]
    s_mov_b32 exec_lo, 0xffff
    s_mov_b32 exec_hi, 0xf
    buffer_load_dword v248, v247, s[4:7], 0 offen
    s_mov_b64 exec, 15
    global_load_dword v248, v254, s[94:95]
    s_mov_b64 exec, -1
    s_add_u32 m0, s45, 81920
    s_add_u32 s51, s44, 20480
    v_exp_f32 v76, v76
    v_exp_f32 v77, v77
    v_cvt_pk_bf16_f32 v105, v74, v75
    v_exp_f32 v78, v78
    v_exp_f32 v79, v79
    v_cvt_pk_bf16_f32 v106, v76, v77
    v_mfma_f32_32x32x16_bf16 v[136:151], v[24:27], v[112:115], v[136:151]
    buffer_load_dwordx4 v1, s[4:7], s51 offen offset:0 sc1 lds
    v_exp_f32 v80, v80
    v_exp_f32 v81, v81
    v_cvt_pk_bf16_f32 v107, v78, v79
    v_exp_f32 v82, v82
    v_exp_f32 v83, v83
    v_cvt_pk_bf16_f32 v108, v80, v81
    v_mfma_f32_32x32x16_bf16 v[136:151], v[28:31], v[116:119], v[136:151]
    s_waitcnt lgkmcnt(0)
    v_exp_f32 v84, v84
    v_exp_f32 v85, v85
    v_cvt_pk_bf16_f32 v109, v82, v83
    v_exp_f32 v86, v86
    v_exp_f32 v87, v87
    v_exp_f32 v88, v88
    v_exp_f32 v89, v89
    v_cvt_pk_bf16_f32 v110, v84, v85
    v_exp_f32 v90, v90
    v_exp_f32 v91, v91
    v_cvt_pk_bf16_f32 v111, v86, v87
    v_cvt_pk_bf16_f32 v112, v88, v89
    v_mfma_f32_32x32x16_bf16 v[72:87], v[16:19], v[8:11], v[40:55]
    ds_read_b128 v[24:27], v238 offset:54080
    v_exp_f32 v92, v92
    v_exp_f32 v93, v93
    v_cvt_pk_bf16_f32 v113, v90, v91
    v_exp_f32 v94, v94
    v_exp_f32 v95, v95
    v_cvt_pk_bf16_f32 v114, v92, v93
    v_mfma_f32_32x32x16_bf16 v[120:135], v[32:35], v[104:107], v[120:135]
    ds_read_b128 v[28:31], v238 offset:54096
    v_exp_f32 v96, v96
    v_exp_f32 v97, v97
    v_cvt_pk_bf16_f32 v115, v94, v95
    v_exp_f32 v98, v98
    v_exp_f32 v99, v99
    v_cvt_pk_bf16_f32 v116, v96, v97
    v_mfma_f32_32x32x16_bf16 v[120:135], v[36:39], v[108:111], v[120:135]
    ds_read_b128 v[20:23], v237 offset:56160
    buffer_load_dwordx4 a[140:143], v227, s[4:7], s35 offen offset:1024 sc1
    v_exp_f32 v100, v100
    v_exp_f32 v101, v101
    v_cvt_pk_bf16_f32 v117, v98, v99
    v_exp_f32 v102, v102
    v_exp_f32 v103, v103
    v_exp_f32 v72, v72
    v_exp_f32 v73, v73
    v_cvt_pk_bf16_f32 v118, v100, v101
    v_exp_f32 v74, v74
    v_exp_f32 v75, v75
    v_cvt_pk_bf16_f32 v119, v102, v103
    v_cvt_pk_bf16_f32 v104, v72, v73
    v_mfma_f32_32x32x16_bf16 v[88:103], v[16:19], v[12:15], v[56:71]
    buffer_load_dwordx4 v239, s[4:7], s51 offen offset:1024 sc1 lds
    v_exp_f32 v76, v76
    v_exp_f32 v77, v77
    v_cvt_pk_bf16_f32 v105, v74, v75
    v_exp_f32 v78, v78
    v_exp_f32 v79, v79
    v_cvt_pk_bf16_f32 v106, v76, v77
    v_mfma_f32_32x32x16_bf16 v[136:151], v[32:35], v[112:115], v[136:151]
    buffer_load_dwordx4 v240, s[4:7], s51 offen offset:2048 sc1 lds
    v_exp_f32 v80, v80
    v_exp_f32 v81, v81
    v_cvt_pk_bf16_f32 v107, v78, v79
    v_exp_f32 v82, v82
    v_exp_f32 v83, v83
    v_cvt_pk_bf16_f32 v108, v80, v81
    v_mfma_f32_32x32x16_bf16 v[136:151], v[36:39], v[116:119], v[136:151]
    s_waitcnt lgkmcnt(0)
    v_exp_f32 v84, v84
    v_exp_f32 v85, v85
    v_cvt_pk_bf16_f32 v109, v82, v83
    v_exp_f32 v86, v86
    v_exp_f32 v87, v87
    v_exp_f32 v88, v88
    v_exp_f32 v89, v89
    v_cvt_pk_bf16_f32 v110, v84, v85
    v_exp_f32 v90, v90
    v_exp_f32 v91, v91
    v_cvt_pk_bf16_f32 v111, v86, v87
    v_cvt_pk_bf16_f32 v112, v88, v89
    v_mfma_f32_32x32x16_bf16 v[72:87], v[20:23], v[8:11], v[40:55]
    ds_read_b128 v[32:35], v238 offset:56160
    v_exp_f32 v92, v92
    v_exp_f32 v93, v93
    v_cvt_pk_bf16_f32 v113, v90, v91
    v_exp_f32 v94, v94
    v_exp_f32 v95, v95
    v_cvt_pk_bf16_f32 v114, v92, v93
    v_mfma_f32_32x32x16_bf16 v[120:135], v[24:27], v[104:107], v[120:135]
    ds_read_b128 v[36:39], v238 offset:56176
    v_exp_f32 v96, v96
    v_exp_f32 v97, v97
    v_cvt_pk_bf16_f32 v115, v94, v95
    v_exp_f32 v98, v98
    v_exp_f32 v99, v99
    v_cvt_pk_bf16_f32 v116, v96, v97
    v_mfma_f32_32x32x16_bf16 v[120:135], v[28:31], v[108:111], v[120:135]
    ds_read_b128 v[16:19], v237 offset:58240
    buffer_load_dwordx4 a[144:147], v227, s[4:7], s34 offen offset:2048 sc1
    v_exp_f32 v100, v100
    v_exp_f32 v101, v101
    v_cvt_pk_bf16_f32 v117, v98, v99
    v_exp_f32 v102, v102
    v_exp_f32 v103, v103
    v_exp_f32 v72, v72
    v_exp_f32 v73, v73
    v_cvt_pk_bf16_f32 v118, v100, v101
    v_exp_f32 v74, v74
    v_exp_f32 v75, v75
    v_cvt_pk_bf16_f32 v119, v102, v103
    v_cvt_pk_bf16_f32 v104, v72, v73
    v_mfma_f32_32x32x16_bf16 v[88:103], v[20:23], v[12:15], v[56:71]
    buffer_load_dwordx4 v241, s[4:7], s51 offen offset:3072 sc1 lds
    s_add_u32 m0, s45, 98304
    s_add_u32 s51, s44, 24576
    v_exp_f32 v76, v76
    v_exp_f32 v77, v77
    v_cvt_pk_bf16_f32 v105, v74, v75
    v_exp_f32 v78, v78
    v_exp_f32 v79, v79
    v_cvt_pk_bf16_f32 v106, v76, v77
    v_mfma_f32_32x32x16_bf16 v[136:151], v[24:27], v[112:115], v[136:151]
    buffer_load_dwordx4 v1, s[4:7], s51 offen offset:0 sc1 lds
    v_exp_f32 v80, v80
    v_exp_f32 v81, v81
    v_cvt_pk_bf16_f32 v107, v78, v79
    v_exp_f32 v82, v82
    v_exp_f32 v83, v83
    v_cvt_pk_bf16_f32 v108, v80, v81
    v_mfma_f32_32x32x16_bf16 v[136:151], v[28:31], v[116:119], v[136:151]
    s_waitcnt lgkmcnt(0)
    v_exp_f32 v84, v84
    v_exp_f32 v85, v85
    v_cvt_pk_bf16_f32 v109, v82, v83
    v_exp_f32 v86, v86
    v_exp_f32 v87, v87
    v_exp_f32 v88, v88
    v_exp_f32 v89, v89
    v_cvt_pk_bf16_f32 v110, v84, v85
    v_exp_f32 v90, v90
    v_exp_f32 v91, v91
    v_cvt_pk_bf16_f32 v111, v86, v87
    v_cvt_pk_bf16_f32 v112, v88, v89
    v_mfma_f32_32x32x16_bf16 v[72:87], v[16:19], v[8:11], v[40:55]
    ds_read_b128 v[24:27], v238 offset:58240
    v_exp_f32 v92, v92
    v_exp_f32 v93, v93
    v_cvt_pk_bf16_f32 v113, v90, v91
    v_exp_f32 v94, v94
    v_exp_f32 v95, v95
    v_cvt_pk_bf16_f32 v114, v92, v93
    v_mfma_f32_32x32x16_bf16 v[120:135], v[32:35], v[104:107], v[120:135]
    ds_read_b128 v[28:31], v238 offset:58256
    v_exp_f32 v96, v96
    v_exp_f32 v97, v97
    v_cvt_pk_bf16_f32 v115, v94, v95
    v_exp_f32 v98, v98
    v_exp_f32 v99, v99
    v_cvt_pk_bf16_f32 v116, v96, v97
    v_mfma_f32_32x32x16_bf16 v[120:135], v[36:39], v[108:111], v[120:135]
    ds_read_b128 v[20:23], v237 offset:60320
    buffer_load_dwordx4 a[148:151], v227, s[4:7], s35 offen offset:2048 sc1
    v_exp_f32 v100, v100
    v_exp_f32 v101, v101
    v_cvt_pk_bf16_f32 v117, v98, v99
    v_exp_f32 v102, v102
    v_exp_f32 v103, v103
    v_exp_f32 v72, v72
    v_exp_f32 v73, v73
    v_cvt_pk_bf16_f32 v118, v100, v101
    v_exp_f32 v74, v74
    v_exp_f32 v75, v75
    v_cvt_pk_bf16_f32 v119, v102, v103
    v_cvt_pk_bf16_f32 v104, v72, v73
    v_mfma_f32_32x32x16_bf16 v[88:103], v[16:19], v[12:15], v[56:71]
    buffer_load_dwordx4 v239, s[4:7], s51 offen offset:1024 sc1 lds
    v_exp_f32 v76, v76
    v_exp_f32 v77, v77
    v_cvt_pk_bf16_f32 v105, v74, v75
    v_exp_f32 v78, v78
    v_exp_f32 v79, v79
    v_cvt_pk_bf16_f32 v106, v76, v77
    v_mfma_f32_32x32x16_bf16 v[136:151], v[32:35], v[112:115], v[136:151]
    buffer_load_dwordx4 v240, s[4:7], s51 offen offset:2048 sc1 lds
    v_exp_f32 v80, v80
    v_exp_f32 v81, v81
    v_cvt_pk_bf16_f32 v107, v78, v79
    v_exp_f32 v82, v82
    v_exp_f32 v83, v83
    v_cvt_pk_bf16_f32 v108, v80, v81
    v_mfma_f32_32x32x16_bf16 v[136:151], v[36:39], v[116:119], v[136:151]
    s_waitcnt lgkmcnt(0)
    v_exp_f32 v84, v84
    v_exp_f32 v85, v85
    v_cvt_pk_bf16_f32 v109, v82, v83
    v_exp_f32 v86, v86
    v_exp_f32 v87, v87
    v_exp_f32 v88, v88
    v_exp_f32 v89, v89
    v_cvt_pk_bf16_f32 v110, v84, v85
    v_exp_f32 v90, v90
    v_exp_f32 v91, v91
    v_cvt_pk_bf16_f32 v111, v86, v87
    v_cvt_pk_bf16_f32 v112, v88, v89
    v_mfma_f32_32x32x16_bf16 v[72:87], v[20:23], v[8:11], v[40:55]
    ds_read_b128 v[32:35], v238 offset:60320
    v_exp_f32 v92, v92
    v_exp_f32 v93, v93
    v_cvt_pk_bf16_f32 v113, v90, v91
    v_exp_f32 v94, v94
    v_exp_f32 v95, v95
    v_cvt_pk_bf16_f32 v114, v92, v93
    v_mfma_f32_32x32x16_bf16 v[120:135], v[24:27], v[104:107], v[120:135]
    ds_read_b128 v[36:39], v238 offset:60336
    v_exp_f32 v96, v96
    v_exp_f32 v97, v97
    v_cvt_pk_bf16_f32 v115, v94, v95
    v_exp_f32 v98, v98
    v_exp_f32 v99, v99
    v_cvt_pk_bf16_f32 v116, v96, v97
    v_mfma_f32_32x32x16_bf16 v[120:135], v[28:31], v[108:111], v[120:135]
    ds_read_b128 v[16:19], v237 offset:62400
    buffer_load_dwordx4 a[152:155], v227, s[4:7], s34 offen offset:3072 sc1
    v_exp_f32 v100, v100
    v_exp_f32 v101, v101
    v_cvt_pk_bf16_f32 v117, v98, v99
    v_exp_f32 v102, v102
    v_exp_f32 v103, v103
    v_exp_f32 v72, v72
    v_exp_f32 v73, v73
    v_cvt_pk_bf16_f32 v118, v100, v101
    v_exp_f32 v74, v74
    v_exp_f32 v75, v75
    v_cvt_pk_bf16_f32 v119, v102, v103
    v_cvt_pk_bf16_f32 v104, v72, v73
    v_mfma_f32_32x32x16_bf16 v[88:103], v[20:23], v[12:15], v[56:71]
    buffer_load_dwordx4 v241, s[4:7], s51 offen offset:3072 sc1 lds
    v_exp_f32 v76, v76
    v_exp_f32 v77, v77
    v_cvt_pk_bf16_f32 v105, v74, v75
    v_exp_f32 v78, v78
    v_exp_f32 v79, v79
    v_cvt_pk_bf16_f32 v106, v76, v77
    v_mfma_f32_32x32x16_bf16 v[136:151], v[24:27], v[112:115], v[136:151]
    buffer_load_dwordx4 a[0:3], v1, s[4:7], s34 offen offset:0 sc1
    v_exp_f32 v80, v80
    v_exp_f32 v81, v81
    v_cvt_pk_bf16_f32 v107, v78, v79
    v_exp_f32 v82, v82
    v_exp_f32 v83, v83
    v_cvt_pk_bf16_f32 v108, v80, v81
    v_mfma_f32_32x32x16_bf16 v[136:151], v[28:31], v[116:119], v[136:151]
    s_waitcnt lgkmcnt(0)
    v_exp_f32 v84, v84
    v_exp_f32 v85, v85
    v_cvt_pk_bf16_f32 v109, v82, v83
    v_exp_f32 v86, v86
    v_exp_f32 v87, v87
    v_exp_f32 v88, v88
    v_exp_f32 v89, v89
    v_cvt_pk_bf16_f32 v110, v84, v85
    v_exp_f32 v90, v90
    v_exp_f32 v91, v91
    v_cvt_pk_bf16_f32 v111, v86, v87
    v_cvt_pk_bf16_f32 v112, v88, v89
    v_mfma_f32_32x32x16_bf16 v[72:87], v[16:19], v[8:11], v[40:55]
    ds_read_b128 v[24:27], v238 offset:62400
    v_exp_f32 v92, v92
    v_exp_f32 v93, v93
    v_cvt_pk_bf16_f32 v113, v90, v91
    v_exp_f32 v94, v94
    v_exp_f32 v95, v95
    v_cvt_pk_bf16_f32 v114, v92, v93
    v_mfma_f32_32x32x16_bf16 v[120:135], v[32:35], v[104:107], v[120:135]
    ds_read_b128 v[28:31], v238 offset:62416
    v_exp_f32 v96, v96
    v_exp_f32 v97, v97
    v_cvt_pk_bf16_f32 v115, v94, v95
    v_exp_f32 v98, v98
    v_exp_f32 v99, v99
    v_cvt_pk_bf16_f32 v116, v96, v97
    v_mfma_f32_32x32x16_bf16 v[120:135], v[36:39], v[108:111], v[120:135]
    ds_read_b128 v[20:23], v237 offset:64480
    buffer_load_dwordx4 a[156:159], v227, s[4:7], s35 offen offset:3072 sc1
    v_exp_f32 v100, v100
    v_exp_f32 v101, v101
    v_cvt_pk_bf16_f32 v117, v98, v99
    v_exp_f32 v102, v102
    v_exp_f32 v103, v103
    v_exp_f32 v72, v72
    v_exp_f32 v73, v73
    v_cvt_pk_bf16_f32 v118, v100, v101
    v_exp_f32 v74, v74
    v_exp_f32 v75, v75
    v_cvt_pk_bf16_f32 v119, v102, v103
    v_cvt_pk_bf16_f32 v104, v72, v73
    v_mfma_f32_32x32x16_bf16 v[88:103], v[16:19], v[12:15], v[56:71]
    buffer_load_dwordx4 a[4:7], v1, s[4:7], s35 offen offset:0 sc1
    v_exp_f32 v76, v76
    v_exp_f32 v77, v77
    v_cvt_pk_bf16_f32 v105, v74, v75
    v_exp_f32 v78, v78
    v_exp_f32 v79, v79
    v_cvt_pk_bf16_f32 v106, v76, v77
    v_mfma_f32_32x32x16_bf16 v[136:151], v[32:35], v[112:115], v[136:151]
    buffer_load_dwordx4 a[8:11], v1, s[4:7], s34 offen offset:1024 sc1
    v_exp_f32 v80, v80
    v_exp_f32 v81, v81
    v_cvt_pk_bf16_f32 v107, v78, v79
    v_exp_f32 v82, v82
    v_exp_f32 v83, v83
    v_cvt_pk_bf16_f32 v108, v80, v81
    v_mfma_f32_32x32x16_bf16 v[136:151], v[36:39], v[116:119], v[136:151]
    s_waitcnt lgkmcnt(0)
    v_exp_f32 v84, v84
    v_exp_f32 v85, v85
    v_cvt_pk_bf16_f32 v109, v82, v83
    v_exp_f32 v86, v86
    v_exp_f32 v87, v87
    v_exp_f32 v88, v88
    v_exp_f32 v89, v89
    v_cvt_pk_bf16_f32 v110, v84, v85
    v_exp_f32 v90, v90
    v_exp_f32 v91, v91
    v_cvt_pk_bf16_f32 v111, v86, v87
    v_cvt_pk_bf16_f32 v112, v88, v89
    v_mfma_f32_32x32x16_bf16 v[72:87], v[20:23], v[8:11], v[40:55]
    ds_read_b128 v[32:35], v238 offset:64480
    v_exp_f32 v92, v92
    v_exp_f32 v93, v93
    v_cvt_pk_bf16_f32 v113, v90, v91
    v_exp_f32 v94, v94
    v_exp_f32 v95, v95
    v_cvt_pk_bf16_f32 v114, v92, v93
    v_mfma_f32_32x32x16_bf16 v[120:135], v[24:27], v[104:107], v[120:135]
    ds_read_b128 v[36:39], v238 offset:64496
    v_exp_f32 v96, v96
    v_exp_f32 v97, v97
    v_cvt_pk_bf16_f32 v115, v94, v95
    v_exp_f32 v98, v98
    v_exp_f32 v99, v99
    v_cvt_pk_bf16_f32 v116, v96, v97
    v_mfma_f32_32x32x16_bf16 v[120:135], v[28:31], v[108:111], v[120:135]
    buffer_load_dwordx4 a[160:163], v228, s[4:7], s34 offen offset:0 sc1
    v_exp_f32 v100, v100
    v_exp_f32 v101, v101
    v_cvt_pk_bf16_f32 v117, v98, v99
    v_exp_f32 v102, v102
    v_exp_f32 v103, v103
    v_exp_f32 v72, v72
    v_exp_f32 v73, v73
    v_cvt_pk_bf16_f32 v118, v100, v101
    v_exp_f32 v74, v74
    v_exp_f32 v75, v75
    v_cvt_pk_bf16_f32 v119, v102, v103
    v_cvt_pk_bf16_f32 v104, v72, v73
    v_mfma_f32_32x32x16_bf16 v[88:103], v[20:23], v[12:15], v[56:71]
    buffer_load_dwordx4 a[12:15], v1, s[4:7], s35 offen offset:1024 sc1
    v_exp_f32 v76, v76
    v_exp_f32 v77, v77
    v_cvt_pk_bf16_f32 v105, v74, v75
    v_exp_f32 v78, v78
    v_exp_f32 v79, v79
    v_cvt_pk_bf16_f32 v106, v76, v77
    v_mfma_f32_32x32x16_bf16 v[136:151], v[24:27], v[112:115], v[136:151]
    buffer_load_dwordx4 a[16:19], v1, s[4:7], s34 offen offset:2048 sc1
    v_exp_f32 v80, v80
    v_exp_f32 v81, v81
    v_cvt_pk_bf16_f32 v107, v78, v79
    v_exp_f32 v82, v82
    v_exp_f32 v83, v83
    v_cvt_pk_bf16_f32 v108, v80, v81
    v_mfma_f32_32x32x16_bf16 v[136:151], v[28:31], v[116:119], v[136:151]
    s_waitcnt lgkmcnt(0)
    v_exp_f32 v84, v84
    v_exp_f32 v85, v85
    v_cvt_pk_bf16_f32 v109, v82, v83
    v_exp_f32 v86, v86
    v_exp_f32 v87, v87
    v_exp_f32 v88, v88
    v_exp_f32 v89, v89
    v_cvt_pk_bf16_f32 v110, v84, v85
    v_exp_f32 v90, v90
    v_exp_f32 v91, v91
    v_cvt_pk_bf16_f32 v111, v86, v87
    v_cvt_pk_bf16_f32 v112, v88, v89
    v_exp_f32 v92, v92
    v_exp_f32 v93, v93
    v_cvt_pk_bf16_f32 v113, v90, v91
    v_exp_f32 v94, v94
    v_exp_f32 v95, v95
    v_cvt_pk_bf16_f32 v114, v92, v93
    v_mfma_f32_32x32x16_bf16 v[120:135], v[32:35], v[104:107], v[120:135]
    v_exp_f32 v96, v96
    v_exp_f32 v97, v97
    v_cvt_pk_bf16_f32 v115, v94, v95
    v_exp_f32 v98, v98
    v_exp_f32 v99, v99
    v_cvt_pk_bf16_f32 v116, v96, v97
    v_mfma_f32_32x32x16_bf16 v[120:135], v[36:39], v[108:111], v[120:135]
    buffer_load_dwordx4 a[164:167], v228, s[4:7], s35 offen offset:0 sc1
    v_exp_f32 v100, v100
    v_exp_f32 v101, v101
    v_cvt_pk_bf16_f32 v117, v98, v99
    v_exp_f32 v102, v102
    v_exp_f32 v103, v103
    v_cvt_pk_bf16_f32 v118, v100, v101
    v_cvt_pk_bf16_f32 v119, v102, v103
    v_mfma_f32_32x32x16_bf16 v[136:151], v[32:35], v[112:115], v[136:151]
    s_nop 0
    v_mfma_f32_32x32x16_bf16 v[136:151], v[36:39], v[116:119], v[136:151]
    s_mov_b32 s38, 0x7e800000
    v_max3_f32 v6, |v120|, |v121|, |v122|
    v_max3_f32 v6, v6, |v123|, |v124|
    v_max3_f32 v6, v6, |v125|, |v126|
    v_max_f32 v6, v6, |v127|
    s_nop 6
    v_max3_f32 v6, v6, |v136|, |v137|
    v_max3_f32 v6, v6, |v138|, |v139|
    v_max3_f32 v6, v6, |v140|, |v141|
    v_max3_f32 v6, v6, |v142|, |v143|
    v_max_f32 v7, v128, v144
    v_add_f32 v104, v128, v144
    v_cmp_gt_f32 vcc, 0x53800000, v7
    v_cmp_o_f32 s[50:51], v104, v104
    v_cmp_gt_f32 s[48:49], s38, v6
    s_and_b64 s[50:51], s[50:51], vcc
    s_and_b64 s[50:51], s[50:51], s[48:49]
    s_cmp_eq_u64 s[50:51], -1
    s_cbranch_scc0 F_fallback
F_attn_done:
    s_lshl_b32 s38, s56, 5
    s_add_u32 s38, s38, s54
    s_lshl_b32 s38, s38, 10
    s_add_u32 s38, s38, 6291456
    s_add_u32 s41, s38, 32768
    v_rcp_f32 v6, v128
    v_rcp_f32 v7, v144
    v_mul_f32 v120, v6, v120
    v_mul_f32 v121, v6, v121
    v_mul_f32 v122, v6, v122
    v_mul_f32 v123, v6, v123
    v_mul_f32 v124, v6, v124
    v_mul_f32 v125, v6, v125
    v_mul_f32 v126, v6, v126
    v_mul_f32 v127, v6, v127
    v_cvt_pk_bf16_f32 v120, v120, v121
    v_cvt_pk_bf16_f32 v121, v122, v123
    v_cvt_pk_bf16_f32 v122, v124, v125
    v_cvt_pk_bf16_f32 v123, v126, v127
    buffer_store_dwordx4 v[120:123], v1, s[4:7], s38 offen sc1
    v_mul_f32 v136, v7, v136
    v_mul_f32 v137, v7, v137
    v_mul_f32 v138, v7, v138
    v_mul_f32 v139, v7, v139
    v_mul_f32 v140, v7, v140
    v_mul_f32 v141, v7, v141
    v_mul_f32 v142, v7, v142
    v_mul_f32 v143, v7, v143
    v_cvt_pk_bf16_f32 v136, v136, v137
    v_cvt_pk_bf16_f32 v137, v138, v139
    v_cvt_pk_bf16_f32 v138, v140, v141
    v_cvt_pk_bf16_f32 v139, v142, v143
    buffer_store_dwordx4 v[136:139], v1, s[4:7], s41 offen sc1
    s_mul_i32 s47, s55, 512
    s_lshl_b32 s31, s54, 4
    s_add_u32 s47, s47, s31
    s_add_u32 s47, s47, 25694208
    s_lshr_b32 s48, s60, 2
    s_mul_i32 s48, s48, 512
    s_lshl_b32 s31, s3, 7
    s_add_u32 s48, s48, s31
    s_add_u32 s48, s48, 25694208
    v_and_b32 v3, 7, v2
    v_lshlrev_b32 v3, 4, v3
    s_lshl_b32 s49, s3, 13
    s_add_u32 s49, s49, 6291456
    s_xor_b32 s50, s40, 1
    s_lshl_b32 s50, s50, 15
    s_add_u32 s50, s50, s49
    s_lshl_b32 s31, s40, 15
    s_add_u32 s49, s49, s31
    s_cmp_eq_u32 s73, 0
    s_cbranch_scc1 F_tailG
    s_waitcnt vmcnt(0)
    s_barrier
    s_cmp_lg_u32 s3, 0
    s_cbranch_scc1 F_f2
    v_mov_b32 v6, 0
    v_mov_b32 v7, 1
    s_mov_b64 exec, 1
    buffer_store_dword v7, v6, s[4:7], s47 offen sc1
    s_mov_b64 exec, -1
F_f2:
F_p2:
    buffer_load_dword v6, v3, s[4:7], s48 offen sc1
    s_waitcnt vmcnt(0)
    v_cmp_ne_u32 vcc, 0, v6
    s_cmp_eq_u64 vcc, -1
    s_cbranch_scc1 F_p2_ok
    s_cmp_eq_u32 s30, 0
    s_cbranch_scc1 F_p2_ok
    s_sub_u32 s30, s30, 1
    s_sleep 1
    s_branch F_p2
F_p2_ok:
    buffer_load_dwordx4 v[8:11], v1, s[4:7], s49 offen offset:0 sc1
    buffer_load_dwordx4 v[12:15], v1, s[4:7], s50 offen offset:0 sc1
    buffer_load_dwordx4 v[16:19], v1, s[4:7], s49 offen offset:1024 sc1
    buffer_load_dwordx4 v[20:23], v1, s[4:7], s50 offen offset:1024 sc1
    buffer_load_dwordx4 v[24:27], v1, s[4:7], s49 offen offset:2048 sc1
    buffer_load_dwordx4 v[28:31], v1, s[4:7], s50 offen offset:2048 sc1
    buffer_load_dwordx4 v[32:35], v1, s[4:7], s49 offen offset:3072 sc1
    buffer_load_dwordx4 v[36:39], v1, s[4:7], s50 offen offset:3072 sc1
    buffer_load_dwordx4 v[40:43], v224, s[4:7], s49 offen offset:0 sc1
    buffer_load_dwordx4 v[44:47], v224, s[4:7], s50 offen offset:0 sc1
    buffer_load_dwordx4 v[48:51], v224, s[4:7], s49 offen offset:1024 sc1
    buffer_load_dwordx4 v[52:55], v224, s[4:7], s50 offen offset:1024 sc1
    buffer_load_dwordx4 v[56:59], v224, s[4:7], s49 offen offset:2048 sc1
    buffer_load_dwordx4 v[60:63], v224, s[4:7], s50 offen offset:2048 sc1
    buffer_load_dwordx4 v[64:67], v224, s[4:7], s49 offen offset:3072 sc1
    buffer_load_dwordx4 v[68:71], v224, s[4:7], s50 offen offset:3072 sc1
    s_xor_b32 s31, s3, 1
    s_mul_i32 s31, s31, 12288
    s_add_u32 s31, s31, 114688
    v_add_u32 v137, s31, v1
    s_xor_b32 s31, s3, 2
    s_mul_i32 s31, s31, 12288
    s_add_u32 s31, s31, 114688
    v_add_u32 v138, s31, v1
    s_xor_b32 s31, s3, 3
    s_mul_i32 s31, s31, 12288
    s_add_u32 s31, s31, 114688
    v_add_u32 v139, s31, v1
    s_mul_i32 s31, s3, 12288
    s_add_u32 s31, s31, 114688
    v_add_u32 v136, s31, v1
    s_lshl_b32 s42, s40, 5
    s_lshl_b32 s43, s39, 1
    s_add_u32 s42, s42, s43
    s_lshl_b32 s42, s42, 10
    s_add_u32 s42, s42, 8388608
    v_permlane32_swap_b32 v216, v218
    v_permlane32_swap_b32 v217, v219
    v_permlane32_swap_b32 v220, v222
    v_permlane32_swap_b32 v221, v223
    s_waitcnt vmcnt(14)
    v_mfma_f32_32x32x16_bf16 v[72:87], v[152:155], v[8:11], 0
    buffer_load_dwordx4 a[168:171], v228, s[4:7], s34 offen offset:1024 sc1
    v_mfma_f32_32x32x16_bf16 v[88:103], v[156:159], v[8:11], 0
    buffer_load_dwordx4 a[172:175], v228, s[4:7], s35 offen offset:1024 sc1
    v_mfma_f32_32x32x16_bf16 v[104:119], v[152:155], v[12:15], 0
    v_mfma_f32_32x32x16_bf16 v[120:135], v[156:159], v[12:15], 0
    s_waitcnt vmcnt(14)
    v_mfma_f32_32x32x16_bf16 v[72:87], v[160:163], v[16:19], v[72:87]
    v_mfma_f32_32x32x16_bf16 v[88:103], v[164:167], v[16:19], v[88:103]
    v_mfma_f32_32x32x16_bf16 v[104:119], v[160:163], v[20:23], v[104:119]
    v_mfma_f32_32x32x16_bf16 v[120:135], v[164:167], v[20:23], v[120:135]
    s_waitcnt vmcnt(12)
    v_mfma_f32_32x32x16_bf16 v[72:87], v[168:171], v[24:27], v[72:87]
    v_mfma_f32_32x32x16_bf16 v[88:103], v[172:175], v[24:27], v[88:103]
    v_mfma_f32_32x32x16_bf16 v[104:119], v[168:171], v[28:31], v[104:119]
    v_mfma_f32_32x32x16_bf16 v[120:135], v[172:175], v[28:31], v[120:135]
    s_waitcnt vmcnt(10)
    v_mfma_f32_32x32x16_bf16 v[72:87], v[176:179], v[32:35], v[72:87]
    v_mfma_f32_32x32x16_bf16 v[88:103], v[180:183], v[32:35], v[88:103]
    v_mfma_f32_32x32x16_bf16 v[104:119], v[176:179], v[36:39], v[104:119]
    v_mfma_f32_32x32x16_bf16 v[120:135], v[180:183], v[36:39], v[120:135]
    s_waitcnt vmcnt(8)
    v_mfma_f32_32x32x16_bf16 v[72:87], v[184:187], v[40:43], v[72:87]
    v_mfma_f32_32x32x16_bf16 v[88:103], v[188:191], v[40:43], v[88:103]
    v_mfma_f32_32x32x16_bf16 v[104:119], v[184:187], v[44:47], v[104:119]
    v_mfma_f32_32x32x16_bf16 v[120:135], v[188:191], v[44:47], v[120:135]
    s_waitcnt vmcnt(6)
    v_mfma_f32_32x32x16_bf16 v[72:87], v[192:195], v[48:51], v[72:87]
    v_mfma_f32_32x32x16_bf16 v[88:103], v[196:199], v[48:51], v[88:103]
    v_mfma_f32_32x32x16_bf16 v[104:119], v[192:195], v[52:55], v[104:119]
    v_mfma_f32_32x32x16_bf16 v[120:135], v[196:199], v[52:55], v[120:135]
    s_waitcnt vmcnt(4)
    v_mfma_f32_32x32x16_bf16 v[72:87], v[200:203], v[56:59], v[72:87]
    v_mfma_f32_32x32x16_bf16 v[88:103], v[204:207], v[56:59], v[88:103]
    v_mfma_f32_32x32x16_bf16 v[104:119], v[200:203], v[60:63], v[104:119]
    v_mfma_f32_32x32x16_bf16 v[120:135], v[204:207], v[60:63], v[120:135]
    s_waitcnt vmcnt(2)
    v_mfma_f32_32x32x16_bf16 v[88:103], v[212:215], v[64:67], v[88:103]
    v_mfma_f32_32x32x16_bf16 v[104:119], v[208:211], v[68:71], v[104:119]
    v_mfma_f32_32x32x16_bf16 v[120:135], v[212:215], v[68:71], v[120:135]
    v_mfma_f32_32x32x16_bf16 v[72:87], v[208:211], v[64:67], v[72:87]
    s_nop 8
    ds_write_b128 v137, v[88:91] offset:0
    ds_write_b128 v137, v[92:95] offset:1024
    ds_write_b128 v137, v[96:99] offset:2048
    ds_write_b128 v137, v[100:103] offset:3072
    ds_write_b128 v138, v[104:107] offset:4096
    ds_write_b128 v138, v[108:111] offset:5120
    ds_write_b128 v138, v[112:115] offset:6144
    ds_write_b128 v138, v[116:119] offset:7168
    ds_write_b128 v139, v[120:123] offset:8192
    ds_write_b128 v139, v[124:127] offset:9216
    ds_write_b128 v139, v[128:131] offset:10240
    ds_write_b128 v139, v[132:135] offset:11264
    v_lshlrev_b32 v8, 16, v216
    v_and_b32 v9, 0xffff0000, v216
    v_lshlrev_b32 v10, 16, v217
    v_and_b32 v11, 0xffff0000, v217
    v_lshlrev_b32 v12, 16, v218
    v_and_b32 v13, 0xffff0000, v218
    v_lshlrev_b32 v14, 16, v219
    v_and_b32 v15, 0xffff0000, v219
    v_lshlrev_b32 v16, 16, v220
    v_and_b32 v17, 0xffff0000, v220
    v_lshlrev_b32 v18, 16, v221
    v_and_b32 v19, 0xffff0000, v221
    v_lshlrev_b32 v20, 16, v222
    v_and_b32 v21, 0xffff0000, v222
    v_lshlrev_b32 v22, 16, v223
    v_and_b32 v23, 0xffff0000, v223
    v_add_f32 v72, v72, v8
    v_add_f32 v73, v73, v9
    v_add_f32 v74, v74, v10
    v_add_f32 v75, v75, v11
    v_add_f32 v76, v76, v12
    v_add_f32 v77, v77, v13
    v_add_f32 v78, v78, v14
    v_add_f32 v79, v79, v15
    v_add_f32 v80, v80, v16
    v_add_f32 v81, v81, v17
    v_add_f32 v82, v82, v18
    v_add_f32 v83, v83, v19
    v_add_f32 v84, v84, v20
    v_add_f32 v85, v85, v21
    v_add_f32 v86, v86, v22
    v_add_f32 v87, v87, v23
    s_waitcnt lgkmcnt(0)
    s_barrier
    ds_read_b128 v[88:91], v136 offset:0
    ds_read_b128 v[92:95], v136 offset:1024
    ds_read_b128 v[96:99], v136 offset:2048
    ds_read_b128 v[100:103], v136 offset:3072
    ds_read_b128 v[104:107], v136 offset:4096
    ds_read_b128 v[108:111], v136 offset:5120
    ds_read_b128 v[112:115], v136 offset:6144
    ds_read_b128 v[116:119], v136 offset:7168
    ds_read_b128 v[120:123], v136 offset:8192
    ds_read_b128 v[124:127], v136 offset:9216
    ds_read_b128 v[128:131], v136 offset:10240
    ds_read_b128 v[132:135], v136 offset:11264
    s_waitcnt lgkmcnt(11)
    v_add_f32 v72, v72, v88
    v_add_f32 v73, v73, v89
    v_add_f32 v74, v74, v90
    v_add_f32 v75, v75, v91
    s_waitcnt lgkmcnt(10)
    v_add_f32 v76, v76, v92
    v_add_f32 v77, v77, v93
    v_add_f32 v78, v78, v94
    v_add_f32 v79, v79, v95
    s_waitcnt lgkmcnt(9)
    v_add_f32 v80, v80, v96
    v_add_f32 v81, v81, v97
    v_add_f32 v82, v82, v98
    v_add_f32 v83, v83, v99
    s_waitcnt lgkmcnt(8)
    v_add_f32 v84, v84, v100
    v_add_f32 v85, v85, v101
    v_add_f32 v86, v86, v102
    v_add_f32 v87, v87, v103
    s_waitcnt lgkmcnt(7)
    v_add_f32 v72, v72, v104
    v_add_f32 v73, v73, v105
    v_add_f32 v74, v74, v106
    v_add_f32 v75, v75, v107
    s_waitcnt lgkmcnt(6)
    v_add_f32 v76, v76, v108
    v_add_f32 v77, v77, v109
    v_add_f32 v78, v78, v110
    v_add_f32 v79, v79, v111
    s_waitcnt lgkmcnt(5)
    v_add_f32 v80, v80, v112
    v_add_f32 v81, v81, v113
    v_add_f32 v82, v82, v114
    v_add_f32 v83, v83, v115
    s_waitcnt lgkmcnt(4)
    v_add_f32 v84, v84, v116
    v_add_f32 v85, v85, v117
    v_add_f32 v86, v86, v118
    v_add_f32 v87, v87, v119
    s_waitcnt lgkmcnt(3)
    v_add_f32 v72, v72, v120
    v_add_f32 v73, v73, v121
    v_add_f32 v74, v74, v122
    v_add_f32 v75, v75, v123
    s_waitcnt lgkmcnt(2)
    v_add_f32 v76, v76, v124
    v_add_f32 v77, v77, v125
    v_add_f32 v78, v78, v126
    v_add_f32 v79, v79, v127
    s_waitcnt lgkmcnt(1)
    v_add_f32 v80, v80, v128
    v_add_f32 v81, v81, v129
    v_add_f32 v82, v82, v130
    v_add_f32 v83, v83, v131
    s_waitcnt lgkmcnt(0)
    v_add_f32 v84, v84, v132
    v_add_f32 v85, v85, v133
    v_add_f32 v86, v86, v134
    v_add_f32 v87, v87, v135
    v_cvt_pk_bf16_f32 v88, v72, v73
    v_cvt_pk_bf16_f32 v89, v74, v75
    v_cvt_pk_bf16_f32 v90, v76, v77
    v_cvt_pk_bf16_f32 v91, v78, v79
    v_cvt_pk_bf16_f32 v92, v80, v81
    v_cvt_pk_bf16_f32 v93, v82, v83
    v_cvt_pk_bf16_f32 v94, v84, v85
    v_cvt_pk_bf16_f32 v95, v86, v87
    buffer_store_dwordx4 v[88:91], v1, s[4:7], s42 offen
    buffer_store_dwordx4 v[92:95], v1, s[4:7], s42 offen offset:1024
    v_add_f32 v8, v72, v73
    v_mul_f32 v9, v72, v72
    v_add_f32 v10, v74, v75
    v_mul_f32 v11, v73, v73
    v_fma_f32 v9, v74, v74, v9
    v_fma_f32 v11, v75, v75, v11
    v_fma_f32 v9, v76, v76, v9
    v_add_f32 v8, v8, v76
    v_fma_f32 v11, v77, v77, v11
    v_add_f32 v10, v10, v77
    v_fma_f32 v9, v78, v78, v9
    v_add_f32 v8, v8, v78
    v_fma_f32 v11, v79, v79, v11
    v_add_f32 v10, v10, v79
    v_fma_f32 v9, v80, v80, v9
    v_add_f32 v8, v8, v80
    v_fma_f32 v11, v81, v81, v11
    v_add_f32 v10, v10, v81
    v_fma_f32 v9, v82, v82, v9
    v_add_f32 v8, v8, v82
    v_fma_f32 v11, v83, v83, v11
    v_add_f32 v10, v10, v83
    v_fma_f32 v9, v84, v84, v9
    v_add_f32 v8, v8, v84
    v_fma_f32 v11, v85, v85, v11
    v_add_f32 v10, v10, v85
    v_fma_f32 v9, v86, v86, v9
    v_add_f32 v8, v8, v86
    v_fma_f32 v11, v87, v87, v11
    v_add_f32 v10, v10, v87
    v_add_f32 v8, v8, v10
    v_add_f32 v9, v9, v11
    v_and_b32 v5, 31, v2
    v_lshrrev_b32 v6, 5, v2
    v_lshlrev_b32 v12, 4, v5
    v_lshl_add_u32 v12, v6, 2, v12
    v_permlane32_swap_b32 v8, v9
    s_lshl_b32 s47, s40, 12
    s_and_b32 s48, s3, 1
    s_lshl3_add_u32 s47, s48, s47
    s_and_b32 s48, s61, 3
    s_lshl_b32 s48, s48, 10
    s_add_u32 s47, s47, s48
    s_lshr_b32 s48, s61, 2
    s_lshl_b32 s48, s48, 9
    s_add_u32 s47, s47, s48
    s_add_u32 s47, s47, 25165824
    v_add_f32 v8, v8, v9
    buffer_store_dword v8, v12, s[4:7], s47 offen
    s_lshr_b32 s31, s60, 1
    s_mul_i32 s31, s31, 256
    s_and_b32 s43, s60, 1
    s_lshl_b32 s43, s43, 3
    s_add_u32 s43, s43, s61
    s_lshl_b32 s43, s43, 4
    s_add_u32 s31, s31, s43
    s_add_u32 s31, s31, 25698304
    s_lshl_b32 s47, s62, 2
    s_add_u32 s47, s47, s3
    s_lshl_b32 s48, s47, 15
    s_add_u32 s48, s48, 8388608
    s_lshl_b32 s49, s47, 12
    s_add_u32 s49, s49, 25165824
    s_mul_i32 s50, s47, 114688
    s_mul_i32 s43, s63, 7168
    s_add_u32 s50, s50, s43
    s_add_u32 s50, s50, 10485760
    s_mul_i32 s43, s62, 256
    s_lshr_b32 s51, s3, 1
    s_lshl_b32 s51, s51, 7
    s_add_u32 s43, s43, s51
    s_add_u32 s43, s43, 25698304
    v_add_u32 v10, 4096, v1
    v_add_u32 v11, 65536, v1
    v_add_u32 v14, 131072, v1
    v_mov_b32 v7, v239
    v_mov_b32 v8, v240
    v_mov_b32 v9, v241
    s_add_u32 s51, s45, 114688
    v_add_u32 v15, s51, v1
    s_waitcnt vmcnt(0)
    s_barrier
    s_cmp_lg_u32 s3, 0
    s_cbranch_scc1 F_f3
    v_mov_b32 v4, 0
    v_mov_b32 v5, 1
    s_mov_b64 exec, 1
    buffer_store_dword v5, v4, s[4:7], s31 offen
    s_mov_b64 exec, -1
F_f3:
    ds_write_b128 v15, a[176:179] offset:0
    ds_write_b128 v15, a[180:183] offset:1024
    ds_write_b128 v15, a[184:187] offset:2048
    ds_write_b128 v15, a[188:191] offset:3072
    ds_write_b128 v15, a[192:195] offset:16384
    ds_write_b128 v15, a[196:199] offset:17408
    ds_write_b128 v15, a[200:203] offset:18432
    ds_write_b128 v15, a[204:207] offset:19456
    ds_write_b128 v15, a[208:211] offset:32768
    ds_write_b128 v15, a[212:215] offset:33792
    ds_write_b128 v15, a[216:219] offset:34816
    ds_write_b128 v15, a[220:223] offset:35840
F_p3:
    buffer_load_dword v4, v3, s[4:7], s43 offen sc1
    s_waitcnt vmcnt(0)
    v_cmp_ne_u32 vcc, 0, v4
    s_cmp_eq_u64 vcc, -1
    s_cbranch_scc1 F_p3_ok
    s_cmp_eq_u32 s30, 0
    s_cbranch_scc1 F_p3_ok
    s_sub_u32 s30, s30, 1
    s_sleep 1
    s_branch F_p3
F_p3_ok:
    buffer_load_dwordx4 v[128:131], v1, s[4:7], s48 offen offset:0 sc1
    buffer_load_dwordx4 v[132:135], v1, s[4:7], s48 offen offset:1024 sc1
    buffer_load_dwordx4 v[136:139], v1, s[4:7], s48 offen offset:2048 sc1
    buffer_load_dwordx4 v[140:143], v1, s[4:7], s48 offen offset:3072 sc1
    buffer_load_dwordx4 v[144:147], v10, s[4:7], s48 offen offset:0 sc1
    s_mul_i32 s31, s62, 256
    s_lshl_b32 s43, s63, 4
    s_add_u32 s31, s31, s43
    s_lshl2_add_u32 s31, s3, s31
    s_add_u32 s74, s31, 25702400
    s_lshr_b32 s43, s60, 1
    s_mul_i32 s43, s43, 256
    s_lshl_b32 s31, s3, 6
    s_add_u32 s43, s43, s31
    s_and_b32 s31, s60, 1
    s_lshl3_add_u32 s43, s31, s43
    s_add_u32 s75, s43, 25702400
    s_mul_i32 s31, s3, 28672
    s_add_u32 s31, s31, 10485760
    s_mul_i32 s76, s40, 114688
    s_add_u32 s76, s76, s31
    s_xor_b32 s43, s40, 1
    s_mul_i32 s80, s43, 114688
    s_add_u32 s80, s80, s31
    v_and_b32 v3, 3, v2
    v_lshlrev_b32 v3, 4, v3
    v_bfe_u32 v4, v2, 2, 1
    v_lshl_add_u32 v3, v4, 2, v3
    v_and_b32 v5, 31, v2
    v_lshlrev_b32 v7, 10, v5
    v_lshl_add_u32 v7, v6, 4, v7
    s_add_u32 s77, s76, 8192
    s_add_u32 s78, s76, 16384
    s_add_u32 s79, s76, 24576
    s_add_u32 s81, s80, 8192
    s_add_u32 s82, s80, 16384
    s_add_u32 s83, s80, 24576
    ds_read_b128 v[96:99], v1 offset:0
    ds_read_b128 v[100:103], v1 offset:1024
    ds_read_b128 v[104:107], v1 offset:2048
    ds_read_b128 v[108:111], v1 offset:3072
    ds_read_b128 v[112:115], v1 offset:4096
    s_waitcnt vmcnt(4)
    s_waitcnt lgkmcnt(3)
    v_mfma_f32_32x32x16_bf16 v[16:31], v[96:99], v[128:131], 0
    ds_read_b128 v[116:119], v1 offset:5120
    buffer_load_dwordx4 v[148:151], v10, s[4:7], s48 offen offset:1024 sc1
    v_mfma_f32_32x32x16_bf16 v[32:47], v[100:103], v[128:131], 0
    ds_read_b128 v[96:99], v1 offset:6144
    s_waitcnt lgkmcnt(3)
    v_mfma_f32_32x32x16_bf16 v[48:63], v[104:107], v[128:131], 0
    ds_read_b128 v[100:103], v1 offset:7168
    v_mfma_f32_32x32x16_bf16 v[64:79], v[108:111], v[128:131], 0
    ds_read_b128 v[104:107], v1 offset:8192
    buffer_load_dwordx4 v[152:155], v10, s[4:7], s48 offen offset:2048 sc1
    s_waitcnt vmcnt(5)
    s_waitcnt lgkmcnt(3)
    v_mfma_f32_32x32x16_bf16 v[16:31], v[112:115], v[132:135], v[16:31]
    ds_read_b128 v[108:111], v1 offset:9216
    v_mfma_f32_32x32x16_bf16 v[32:47], v[116:119], v[132:135], v[32:47]
    ds_read_b128 v[112:115], v1 offset:10240
    s_waitcnt lgkmcnt(3)
    v_mfma_f32_32x32x16_bf16 v[48:63], v[96:99], v[132:135], v[48:63]
    ds_read_b128 v[116:119], v1 offset:11264
    buffer_load_dwordx4 v[156:159], v10, s[4:7], s48 offen offset:3072 sc1
    s_add_u32 s48, s48, 8192
    v_mfma_f32_32x32x16_bf16 v[64:79], v[100:103], v[132:135], v[64:79]
    ds_read_b128 v[96:99], v1 offset:12288
    s_waitcnt vmcnt(5)
    s_waitcnt lgkmcnt(3)
    v_mfma_f32_32x32x16_bf16 v[16:31], v[104:107], v[136:139], v[16:31]
    ds_read_b128 v[100:103], v1 offset:13312
    v_mfma_f32_32x32x16_bf16 v[32:47], v[108:111], v[136:139], v[32:47]
    ds_read_b128 v[104:107], v1 offset:14336
    buffer_load_dwordx4 v[160:163], v1, s[4:7], s48 offen offset:0 sc1
    s_waitcnt lgkmcnt(3)
    v_mfma_f32_32x32x16_bf16 v[48:63], v[112:115], v[136:139], v[48:63]
    ds_read_b128 v[108:111], v1 offset:15360
    v_mfma_f32_32x32x16_bf16 v[64:79], v[116:119], v[136:139], v[64:79]
    ds_read_b128 v[112:115], v1 offset:16384
    s_waitcnt vmcnt(5)
    s_waitcnt lgkmcnt(3)
    v_mfma_f32_32x32x16_bf16 v[16:31], v[96:99], v[140:143], v[16:31]
    ds_read_b128 v[116:119], v1 offset:17408
    buffer_load_dwordx4 v[164:167], v1, s[4:7], s48 offen offset:1024 sc1
    v_mfma_f32_32x32x16_bf16 v[32:47], v[100:103], v[140:143], v[32:47]
    ds_read_b128 v[96:99], v1 offset:18432
    s_waitcnt lgkmcnt(3)
    v_mfma_f32_32x32x16_bf16 v[48:63], v[104:107], v[140:143], v[48:63]
    ds_read_b128 v[100:103], v1 offset:19456
    v_mfma_f32_32x32x16_bf16 v[64:79], v[108:111], v[140:143], v[64:79]
    ds_read_b128 v[104:107], v1 offset:20480
    buffer_load_dwordx4 v[168:171], v1, s[4:7], s48 offen offset:2048 sc1
    s_waitcnt vmcnt(6)
    s_waitcnt lgkmcnt(3)
    v_mfma_f32_32x32x16_bf16 v[16:31], v[112:115], v[144:147], v[16:31]
    ds_read_b128 v[108:111], v1 offset:21504
    v_mfma_f32_32x32x16_bf16 v[32:47], v[116:119], v[144:147], v[32:47]
    ds_read_b128 v[112:115], v1 offset:22528
    s_waitcnt lgkmcnt(3)
    v_mfma_f32_32x32x16_bf16 v[48:63], v[96:99], v[144:147], v[48:63]
    ds_read_b128 v[116:119], v1 offset:23552
    buffer_load_dwordx4 v[172:175], v1, s[4:7], s48 offen offset:3072 sc1
    v_mfma_f32_32x32x16_bf16 v[64:79], v[100:103], v[144:147], v[64:79]
    ds_read_b128 v[96:99], v1 offset:24576
    s_waitcnt vmcnt(6)
    s_waitcnt lgkmcnt(3)
    v_mfma_f32_32x32x16_bf16 v[16:31], v[104:107], v[148:151], v[16:31]
    ds_read_b128 v[100:103], v1 offset:25600
    v_mfma_f32_32x32x16_bf16 v[32:47], v[108:111], v[148:151], v[32:47]
    ds_read_b128 v[104:107], v1 offset:26624
    buffer_load_dwordx4 v[176:179], v10, s[4:7], s48 offen offset:0 sc1
    s_waitcnt lgkmcnt(3)
    v_mfma_f32_32x32x16_bf16 v[48:63], v[112:115], v[148:151], v[48:63]
    ds_read_b128 v[108:111], v1 offset:27648
    v_mfma_f32_32x32x16_bf16 v[64:79], v[116:119], v[148:151], v[64:79]
    ds_read_b128 v[112:115], v1 offset:28672
    s_waitcnt vmcnt(6)
    s_waitcnt lgkmcnt(3)
    v_mfma_f32_32x32x16_bf16 v[16:31], v[96:99], v[152:155], v[16:31]
    ds_read_b128 v[116:119], v1 offset:29696
    buffer_load_dwordx4 v[180:183], v10, s[4:7], s48 offen offset:1024 sc1
    v_mfma_f32_32x32x16_bf16 v[32:47], v[100:103], v[152:155], v[32:47]
    ds_read_b128 v[96:99], v1 offset:30720
    s_waitcnt lgkmcnt(3)
    v_mfma_f32_32x32x16_bf16 v[48:63], v[104:107], v[152:155], v[48:63]
    ds_read_b128 v[100:103], v1 offset:31744
    v_mfma_f32_32x32x16_bf16 v[64:79], v[108:111], v[152:155], v[64:79]
    ds_read_b128 v[104:107], v1 offset:32768
    buffer_load_dwordx4 v[184:187], v10, s[4:7], s48 offen offset:2048 sc1
    s_waitcnt vmcnt(7)
    s_waitcnt lgkmcnt(3)
    v_mfma_f32_32x32x16_bf16 v[16:31], v[112:115], v[156:159], v[16:31]
    ds_read_b128 v[108:111], v1 offset:33792
    v_mfma_f32_32x32x16_bf16 v[32:47], v[116:119], v[156:159], v[32:47]
    ds_read_b128 v[112:115], v1 offset:34816
    s_waitcnt lgkmcnt(3)
    v_mfma_f32_32x32x16_bf16 v[48:63], v[96:99], v[156:159], v[48:63]
    ds_read_b128 v[116:119], v1 offset:35840
    buffer_load_dwordx4 v[188:191], v10, s[4:7], s48 offen offset:3072 sc1
    v_mfma_f32_32x32x16_bf16 v[64:79], v[100:103], v[156:159], v[64:79]
    ds_read_b128 v[96:99], v1 offset:36864
    s_waitcnt vmcnt(7)
    s_waitcnt lgkmcnt(3)
    v_mfma_f32_32x32x16_bf16 v[16:31], v[104:107], v[160:163], v[16:31]
    ds_read_b128 v[100:103], v1 offset:37888
    v_mfma_f32_32x32x16_bf16 v[32:47], v[108:111], v[160:163], v[32:47]
    ds_read_b128 v[104:107], v1 offset:38912
    buffer_load_dwordx4 v[80:83], v1, s[4:7], s49 offen offset:0 sc1
    s_waitcnt lgkmcnt(3)
    v_mfma_f32_32x32x16_bf16 v[48:63], v[112:115], v[160:163], v[48:63]
    ds_read_b128 v[108:111], v1 offset:39936
    v_mfma_f32_32x32x16_bf16 v[64:79], v[116:119], v[160:163], v[64:79]
    ds_read_b128 v[112:115], v1 offset:40960
    s_waitcnt vmcnt(7)
    s_waitcnt lgkmcnt(3)
    v_mfma_f32_32x32x16_bf16 v[16:31], v[96:99], v[164:167], v[16:31]
    ds_read_b128 v[116:119], v1 offset:41984
    buffer_load_dwordx4 v[84:87], v1, s[4:7], s49 offen offset:1024 sc1
    v_mfma_f32_32x32x16_bf16 v[32:47], v[100:103], v[164:167], v[32:47]
    ds_read_b128 v[96:99], v1 offset:43008
    s_waitcnt lgkmcnt(3)
    v_mfma_f32_32x32x16_bf16 v[48:63], v[104:107], v[164:167], v[48:63]
    ds_read_b128 v[100:103], v1 offset:44032
    v_mfma_f32_32x32x16_bf16 v[64:79], v[108:111], v[164:167], v[64:79]
    ds_read_b128 v[104:107], v1 offset:45056
    buffer_load_dwordx4 v[88:91], v1, s[4:7], s49 offen offset:2048 sc1
    s_waitcnt vmcnt(8)
    s_waitcnt lgkmcnt(3)
    v_mfma_f32_32x32x16_bf16 v[16:31], v[112:115], v[168:171], v[16:31]
    ds_read_b128 v[108:111], v1 offset:46080
    v_mfma_f32_32x32x16_bf16 v[32:47], v[116:119], v[168:171], v[32:47]
    ds_read_b128 v[112:115], v1 offset:47104
    s_waitcnt lgkmcnt(3)
    v_mfma_f32_32x32x16_bf16 v[48:63], v[96:99], v[168:171], v[48:63]
    ds_read_b128 v[116:119], v1 offset:48128
    buffer_load_dwordx4 v[92:95], v1, s[4:7], s49 offen offset:3072 sc1
    s_add_u32 s48, s48, 8192
    v_mfma_f32_32x32x16_bf16 v[64:79], v[100:103], v[168:171], v[64:79]
    ds_read_b128 v[96:99], v1 offset:49152
    s_waitcnt vmcnt(8)
    s_waitcnt lgkmcnt(3)
    v_mfma_f32_32x32x16_bf16 v[16:31], v[104:107], v[172:175], v[16:31]
    ds_read_b128 v[100:103], v1 offset:50176
    v_mfma_f32_32x32x16_bf16 v[32:47], v[108:111], v[172:175], v[32:47]
    ds_read_b128 v[104:107], v1 offset:51200
    buffer_load_dwordx4 v[192:195], v1, s[4:7], s48 offen offset:0 sc1
    s_waitcnt lgkmcnt(3)
    v_mfma_f32_32x32x16_bf16 v[48:63], v[112:115], v[172:175], v[48:63]
    ds_read_b128 v[108:111], v1 offset:52224
    v_mfma_f32_32x32x16_bf16 v[64:79], v[116:119], v[172:175], v[64:79]
    ds_read_b128 v[112:115], v1 offset:53248
    s_waitcnt vmcnt(8)
    s_waitcnt lgkmcnt(3)
    v_mfma_f32_32x32x16_bf16 v[16:31], v[96:99], v[176:179], v[16:31]
    ds_read_b128 v[116:119], v1 offset:54272
    buffer_load_dwordx4 v[196:199], v1, s[4:7], s48 offen offset:1024 sc1
    v_mfma_f32_32x32x16_bf16 v[32:47], v[100:103], v[176:179], v[32:47]
    ds_read_b128 v[96:99], v1 offset:55296
    s_waitcnt lgkmcnt(3)
    v_mfma_f32_32x32x16_bf16 v[48:63], v[104:107], v[176:179], v[48:63]
    ds_read_b128 v[100:103], v1 offset:56320
    v_mfma_f32_32x32x16_bf16 v[64:79], v[108:111], v[176:179], v[64:79]
    ds_read_b128 v[104:107], v1 offset:57344
    buffer_load_dwordx4 v[200:203], v1, s[4:7], s48 offen offset:2048 sc1
    s_waitcnt vmcnt(9)
    s_waitcnt lgkmcnt(3)
    v_mfma_f32_32x32x16_bf16 v[16:31], v[112:115], v[180:183], v[16:31]
    ds_read_b128 v[108:111], v1 offset:58368
    v_mfma_f32_32x32x16_bf16 v[32:47], v[116:119], v[180:183], v[32:47]
    ds_read_b128 v[112:115], v1 offset:59392
    s_waitcnt lgkmcnt(3)
    v_mfma_f32_32x32x16_bf16 v[48:63], v[96:99], v[180:183], v[48:63]
    ds_read_b128 v[116:119], v1 offset:60416
    buffer_load_dwordx4 v[204:207], v1, s[4:7], s48 offen offset:3072 sc1
    v_mfma_f32_32x32x16_bf16 v[64:79], v[100:103], v[180:183], v[64:79]
    ds_read_b128 v[96:99], v1 offset:61440
    s_waitcnt vmcnt(9)
    s_waitcnt lgkmcnt(3)
    v_mfma_f32_32x32x16_bf16 v[16:31], v[104:107], v[184:187], v[16:31]
    ds_read_b128 v[100:103], v1 offset:62464
    v_mfma_f32_32x32x16_bf16 v[32:47], v[108:111], v[184:187], v[32:47]
    ds_read_b128 v[104:107], v1 offset:63488
    buffer_load_dwordx4 v[208:211], v10, s[4:7], s48 offen offset:0 sc1
    s_waitcnt lgkmcnt(3)
    v_mfma_f32_32x32x16_bf16 v[48:63], v[112:115], v[184:187], v[48:63]
    ds_read_b128 v[108:111], v1 offset:64512
    v_mfma_f32_32x32x16_bf16 v[64:79], v[116:119], v[184:187], v[64:79]
    ds_read_b128 v[112:115], v11 offset:0
    s_waitcnt vmcnt(9)
    s_waitcnt lgkmcnt(3)
    v_mfma_f32_32x32x16_bf16 v[16:31], v[96:99], v[188:191], v[16:31]
    ds_read_b128 v[116:119], v11 offset:1024
    buffer_load_dwordx4 v[212:215], v10, s[4:7], s48 offen offset:1024 sc1
    v_mfma_f32_32x32x16_bf16 v[32:47], v[100:103], v[188:191], v[32:47]
    ds_read_b128 v[96:99], v11 offset:2048
    s_waitcnt lgkmcnt(3)
    v_mfma_f32_32x32x16_bf16 v[48:63], v[104:107], v[188:191], v[48:63]
    ds_read_b128 v[100:103], v11 offset:4096
    v_mfma_f32_32x32x16_bf16 v[64:79], v[108:111], v[188:191], v[64:79]
    ds_read_b128 v[104:107], v11 offset:5120
    buffer_load_dwordx4 v[216:219], v10, s[4:7], s48 offen offset:2048 sc1
    s_waitcnt vmcnt(6)
    s_waitcnt lgkmcnt(3)
    v_mfma_f32_32x32x16_bf16 v[16:31], v[112:115], v[192:195], v[16:31]
    ds_read_b128 v[108:111], v11 offset:6144
    v_mfma_f32_32x32x16_bf16 v[32:47], v[116:119], v[192:195], v[32:47]
    ds_read_b128 v[112:115], v11 offset:8192
    s_waitcnt lgkmcnt(3)
    v_mfma_f32_32x32x16_bf16 v[48:63], v[96:99], v[192:195], v[48:63]
    ds_read_b128 v[116:119], v11 offset:9216
    buffer_load_dwordx4 v[220:223], v10, s[4:7], s48 offen offset:3072 sc1
    s_add_u32 s48, s48, 8192
    s_waitcnt vmcnt(6)
    v_mfma_f32_32x32x16_bf16 v[16:31], v[100:103], v[196:199], v[16:31]
    ds_read_b128 v[96:99], v11 offset:10240
    s_waitcnt lgkmcnt(3)
    v_mfma_f32_32x32x16_bf16 v[32:47], v[104:107], v[196:199], v[32:47]
    ds_read_b128 v[100:103], v11 offset:12288
    v_mfma_f32_32x32x16_bf16 v[48:63], v[108:111], v[196:199], v[48:63]
    ds_read_b128 v[104:107], v11 offset:13312
    buffer_load_dwordx4 v[224:227], v1, s[4:7], s48 offen offset:0 sc1
    s_waitcnt vmcnt(6)
    s_waitcnt lgkmcnt(3)
    v_mfma_f32_32x32x16_bf16 v[16:31], v[112:115], v[200:203], v[16:31]
    ds_read_b128 v[108:111], v11 offset:14336
    v_mfma_f32_32x32x16_bf16 v[32:47], v[116:119], v[200:203], v[32:47]
    ds_read_b128 v[112:115], v11 offset:16384
    s_waitcnt lgkmcnt(3)
    v_mfma_f32_32x32x16_bf16 v[48:63], v[96:99], v[200:203], v[48:63]
    ds_read_b128 v[116:119], v11 offset:17408
    buffer_load_dwordx4 v[228:231], v1, s[4:7], s48 offen offset:1024 sc1
    v_add_f32 v80, v80, v88
    v_add_f32 v82, v82, v90
    v_add_f32 v84, v84, v92
    v_add_f32 v86, v86, v94
    v_add_f32 v81, v81, v89
    s_waitcnt vmcnt(6)
    v_mfma_f32_32x32x16_bf16 v[16:31], v[100:103], v[204:207], v[16:31]
    ds_read_b128 v[96:99], v11 offset:18432
    v_add_f32 v83, v83, v91
    v_add_f32 v85, v85, v93
    v_add_f32 v87, v87, v95
    v_add_f32 v80, v80, v84
    v_add_f32 v81, v81, v85
    s_waitcnt lgkmcnt(3)
    v_mfma_f32_32x32x16_bf16 v[32:47], v[104:107], v[204:207], v[32:47]
    ds_read_b128 v[100:103], v11 offset:20480
    v_add_f32 v82, v82, v86
    v_add_f32 v83, v83, v87
    v_add_f32 v80, v80, v82
    v_add_f32 v81, v81, v83
    v_mov_b32 v82, v80
    v_mfma_f32_32x32x16_bf16 v[48:63], v[108:111], v[204:207], v[48:63]
    ds_read_b128 v[104:107], v11 offset:21504
    buffer_load_dwordx4 v[232:235], v1, s[4:7], s48 offen offset:2048 sc1
    v_mov_b32 v83, v81
    v_permlane32_swap_b32 v82, v80
    s_nop 0
    v_permlane32_swap_b32 v83, v81
    s_waitcnt vmcnt(6)
    s_waitcnt lgkmcnt(3)
    v_mfma_f32_32x32x16_bf16 v[16:31], v[112:115], v[208:211], v[16:31]
    ds_read_b128 v[108:111], v11 offset:22528
    v_add_f32 v80, v80, v82
    v_add_f32 v81, v81, v83
    v_mul_f32 v80, 0.001953125, v80
    v_mul_f32 v81, 0.001953125, v81
    v_fma_f32 v81, -v80, v80, v81
    v_mfma_f32_32x32x16_bf16 v[32:47], v[116:119], v[208:211], v[32:47]
    ds_read_b128 v[112:115], v11 offset:24576
    v_max_f32 v81, 0, v81
    v_add_f32 v125, 0x3727c5ac, v81
    v_rsq_f32 v124, v125
    v_sub_f32 v80, 0, v80
    s_waitcnt lgkmcnt(3)
    v_mfma_f32_32x32x16_bf16 v[48:63], v[96:99], v[208:211], v[48:63]
    ds_read_b128 v[116:119], v11 offset:25600
    buffer_load_dwordx4 v[236:239], v1, s[4:7], s48 offen offset:3072 sc1
    v_mul_f32 v124, -1.4426950408889634, v124
    v_cvt_pk_bf16_f32 v84, v80, v80
    v_and_b32 v84, 0xffff0000, v84
    v_sub_f32 v85, v80, v84
    v_cvt_pk_bf16_f32 v120, v84, v85
    s_waitcnt vmcnt(6)
    v_mfma_f32_32x32x16_bf16 v[16:31], v[100:103], v[212:215], v[16:31]
    ds_read_b128 v[96:99], v11 offset:26624
    v_mov_b32 v121, v120
    v_mov_b32 v122, v120
    v_mov_b32 v123, v120
    s_waitcnt lgkmcnt(3)
    v_mfma_f32_32x32x16_bf16 v[32:47], v[104:107], v[212:215], v[32:47]
    ds_read_b128 v[100:103], v11 offset:28672
    v_mfma_f32_32x32x16_bf16 v[48:63], v[108:111], v[212:215], v[48:63]
    ds_read_b128 v[104:107], v11 offset:29696
    buffer_load_dwordx4 v[240:243], v10, s[4:7], s48 offen offset:0 sc1
    s_waitcnt vmcnt(6)
    s_waitcnt lgkmcnt(3)
    v_mfma_f32_32x32x16_bf16 v[16:31], v[112:115], v[216:219], v[16:31]
    ds_read_b128 v[108:111], v11 offset:30720
    v_mfma_f32_32x32x16_bf16 v[32:47], v[116:119], v[216:219], v[32:47]
    ds_read_b128 v[112:115], v11 offset:32768
    s_waitcnt lgkmcnt(3)
    v_mfma_f32_32x32x16_bf16 v[48:63], v[96:99], v[216:219], v[48:63]
    ds_read_b128 v[116:119], v11 offset:33792
    buffer_load_dwordx4 v[244:247], v10, s[4:7], s48 offen offset:1024 sc1
    s_waitcnt vmcnt(6)
    v_mfma_f32_32x32x16_bf16 v[16:31], v[100:103], v[220:223], v[16:31]
    ds_read_b128 v[96:99], v11 offset:34816
    s_waitcnt lgkmcnt(3)
    v_mfma_f32_32x32x16_bf16 v[32:47], v[104:107], v[220:223], v[32:47]
    ds_read_b128 v[100:103], v11 offset:36864
    v_mfma_f32_32x32x16_bf16 v[48:63], v[108:111], v[220:223], v[48:63]
    ds_read_b128 v[104:107], v11 offset:37888
    buffer_load_dwordx4 v[248:251], v10, s[4:7], s48 offen offset:2048 sc1
    s_waitcnt vmcnt(6)
    s_waitcnt lgkmcnt(3)
    v_mfma_f32_32x32x16_bf16 v[16:31], v[112:115], v[224:227], v[16:31]
    ds_read_b128 v[108:111], v11 offset:38912
    v_mfma_f32_32x32x16_bf16 v[32:47], v[116:119], v[224:227], v[32:47]
    ds_read_b128 v[112:115], v11 offset:40960
    s_waitcnt lgkmcnt(3)
    v_mfma_f32_32x32x16_bf16 v[48:63], v[96:99], v[224:227], v[48:63]
    ds_read_b128 v[116:119], v11 offset:41984
    buffer_load_dwordx4 v[252:255], v10, s[4:7], s48 offen offset:3072 sc1
    s_waitcnt vmcnt(6)
    v_mfma_f32_32x32x16_bf16 v[16:31], v[100:103], v[228:231], v[16:31]
    ds_read_b128 v[96:99], v11 offset:43008
    s_waitcnt lgkmcnt(3)
    v_mfma_f32_32x32x16_bf16 v[32:47], v[104:107], v[228:231], v[32:47]
    ds_read_b128 v[100:103], v11 offset:45056
    s_barrier
    v_mfma_f32_32x32x16_bf16 v[48:63], v[108:111], v[228:231], v[48:63]
    ds_read_b128 v[104:107], v11 offset:46080
    s_add_u32 m0, s45, 0
    s_add_u32 s51, s46, 163840
    buffer_load_dwordx4 v1, s[4:7], s51 offen offset:0 sc1 lds
    s_waitcnt vmcnt(6)
    s_waitcnt lgkmcnt(3)
    v_mfma_f32_32x32x16_bf16 v[16:31], v[112:115], v[232:235], v[16:31]
    ds_read_b128 v[108:111], v11 offset:47104
    v_mfma_f32_32x32x16_bf16 v[32:47], v[116:119], v[232:235], v[32:47]
    ds_read_b128 v[112:115], v11 offset:49152
    s_waitcnt lgkmcnt(3)
    v_mfma_f32_32x32x16_bf16 v[48:63], v[96:99], v[232:235], v[48:63]
    ds_read_b128 v[116:119], v11 offset:50176
    buffer_load_dwordx4 v1, s[4:7], s51 offen offset:1024 sc1 lds
    s_waitcnt vmcnt(6)
    v_mfma_f32_32x32x16_bf16 v[16:31], v[100:103], v[236:239], v[16:31]
    ds_read_b128 v[96:99], v11 offset:51200
    s_waitcnt lgkmcnt(3)
    v_mfma_f32_32x32x16_bf16 v[32:47], v[104:107], v[236:239], v[32:47]
    ds_read_b128 v[100:103], v11 offset:53248
    v_mfma_f32_32x32x16_bf16 v[48:63], v[108:111], v[236:239], v[48:63]
    ds_read_b128 v[104:107], v11 offset:54272
    buffer_load_dwordx4 v1, s[4:7], s51 offen offset:2048 sc1 lds
    s_waitcnt vmcnt(6)
    s_waitcnt lgkmcnt(3)
    v_mfma_f32_32x32x16_bf16 v[16:31], v[112:115], v[240:243], v[16:31]
    ds_read_b128 v[108:111], v11 offset:55296
    v_mfma_f32_32x32x16_bf16 v[32:47], v[116:119], v[240:243], v[32:47]
    ds_read_b128 v[112:115], v11 offset:57344
    s_waitcnt lgkmcnt(3)
    v_mfma_f32_32x32x16_bf16 v[48:63], v[96:99], v[240:243], v[48:63]
    ds_read_b128 v[116:119], v11 offset:58368
    buffer_load_dwordx4 v1, s[4:7], s51 offen offset:3072 sc1 lds
    s_add_u32 m0, s45, 16384
    s_add_u32 s51, s46, 180224
    s_waitcnt vmcnt(6)
    v_mfma_f32_32x32x16_bf16 v[16:31], v[100:103], v[244:247], v[16:31]
    ds_read_b128 v[96:99], v11 offset:59392
    s_waitcnt lgkmcnt(3)
    v_mfma_f32_32x32x16_bf16 v[32:47], v[104:107], v[244:247], v[32:47]
    ds_read_b128 v[100:103], v11 offset:61440
    v_mfma_f32_32x32x16_bf16 v[48:63], v[108:111], v[244:247], v[48:63]
    ds_read_b128 v[104:107], v11 offset:62464
    buffer_load_dwordx4 v1, s[4:7], s51 offen offset:0 sc1 lds
    s_waitcnt vmcnt(6)
    s_waitcnt lgkmcnt(3)
    v_mfma_f32_32x32x16_bf16 v[16:31], v[112:115], v[248:251], v[16:31]
    ds_read_b128 v[108:111], v11 offset:63488
    v_mfma_f32_32x32x16_bf16 v[32:47], v[116:119], v[248:251], v[32:47]
    ds_read_b128 v[112:115], v11 offset:3072
    s_waitcnt lgkmcnt(3)
    v_mfma_f32_32x32x16_bf16 v[48:63], v[96:99], v[248:251], v[48:63]
    ds_read_b128 v[116:119], v14 offset:0
    buffer_load_dwordx4 v1, s[4:7], s51 offen offset:1024 sc1 lds
    s_waitcnt vmcnt(6)
    v_mfma_f32_32x32x16_bf16 v[16:31], v[100:103], v[252:255], v[16:31]
    ds_read_b128 v[96:99], v11 offset:7168
    s_waitcnt lgkmcnt(3)
    v_mfma_f32_32x32x16_bf16 v[32:47], v[104:107], v[252:255], v[32:47]
    ds_read_b128 v[100:103], v14 offset:1024
    v_mfma_f32_32x32x16_bf16 v[16:31], a[224:227], v[120:123], v[16:31]
    v_mfma_f32_32x32x16_bf16 v[48:63], v[108:111], v[252:255], v[48:63]
    ds_read_b128 v[104:107], v11 offset:11264
    buffer_load_dwordx4 v1, s[4:7], s51 offen offset:2048 sc1 lds
    v_mfma_f32_32x32x16_bf16 v[32:47], a[228:231], v[120:123], v[32:47]
    s_nop 7
    v_mul_f32 v126, v124, v16
    v_mul_f32 v127, v124, v17
    v_mul_f32 v12, v124, v18
    v_mul_f32 v13, v124, v19
    s_waitcnt lgkmcnt(3)
    v_mfma_f32_32x32x16_bf16 v[64:79], v[112:115], v[192:195], v[64:79]
    ds_read_b128 v[108:111], v14 offset:2048
    v_exp_f32 v126, v126
    v_mul_f32 v16, v16, v24
    v_exp_f32 v127, v127
    v_mfma_f32_32x32x16_bf16 v[48:63], a[232:235], v[120:123], v[48:63]
    v_mul_f32 v17, v17, v25
    v_exp_f32 v12, v12
    v_mul_f32 v18, v18, v26
    v_mfma_f32_32x32x16_bf16 v[80:95], v[116:119], v[128:131], 0
    ds_read_b128 v[112:115], v11 offset:15360
    v_exp_f32 v13, v13
    v_mul_f32 v19, v19, v27
    v_fma_f32 v126, v126, v125, v125
    v_fma_f32 v127, v127, v125, v125
    s_waitcnt lgkmcnt(3)
    v_mfma_f32_32x32x16_bf16 v[64:79], v[96:99], v[196:199], v[64:79]
    ds_read_b128 v[116:119], v14 offset:3072
    buffer_load_dwordx4 v1, s[4:7], s51 offen offset:3072 sc1 lds
    s_add_u32 m0, s45, 32768
    s_add_u32 s51, s46, 196608
    v_fma_f32 v12, v12, v125, v125
    v_fma_f32 v13, v13, v125, v125
    v_rcp_f32 v126, v126
    v_mfma_f32_32x32x16_bf16 v[80:95], v[100:103], v[132:135], v[80:95]
    ds_read_b128 v[96:99], v11 offset:19456
    v_rcp_f32 v127, v127
    v_rcp_f32 v12, v12
    s_waitcnt lgkmcnt(3)
    v_mfma_f32_32x32x16_bf16 v[64:79], v[104:107], v[200:203], v[64:79]
    ds_read_b128 v[100:103], v14 offset:4096
    v_rcp_f32 v13, v13
    v_mul_f32 v16, v16, v126
    v_mul_f32 v17, v17, v127
    v_mul_f32 v18, v18, v12
    v_mfma_f32_32x32x16_bf16 v[80:95], v[108:111], v[136:139], v[80:95]
    ds_read_b128 v[104:107], v11 offset:23552
    buffer_load_dwordx4 v1, s[4:7], s51 offen offset:0 sc1 lds
    v_mul_f32 v19, v19, v13
    v_cvt_pk_bf16_f32 v24, v16, v17
    v_cvt_pk_bf16_f32 v25, v18, v19
    v_mul_f32 v126, v124, v20
    v_mul_f32 v127, v124, v21
    s_waitcnt lgkmcnt(3)
    v_mfma_f32_32x32x16_bf16 v[64:79], v[112:115], v[204:207], v[64:79]
    ds_read_b128 v[108:111], v14 offset:5120
    v_mul_f32 v12, v124, v22
    v_mul_f32 v13, v124, v23
    v_exp_f32 v126, v126
    v_mul_f32 v20, v20, v28
    v_mfma_f32_32x32x16_bf16 v[80:95], v[116:119], v[140:143], v[80:95]
    ds_read_b128 v[112:115], v11 offset:27648
    v_exp_f32 v127, v127
    v_mul_f32 v21, v21, v29
    v_exp_f32 v12, v12
    s_waitcnt lgkmcnt(3)
    v_mfma_f32_32x32x16_bf16 v[64:79], v[96:99], v[208:211], v[64:79]
    ds_read_b128 v[116:119], v14 offset:6144
    buffer_load_dwordx4 v1, s[4:7], s51 offen offset:1024 sc1 lds
    v_mul_f32 v22, v22, v30
    v_exp_f32 v13, v13
    v_mul_f32 v23, v23, v31
    v_fma_f32 v126, v126, v125, v125
    v_mfma_f32_32x32x16_bf16 v[80:95], v[100:103], v[144:147], v[80:95]
    ds_read_b128 v[96:99], v11 offset:31744
    v_fma_f32 v127, v127, v125, v125
    v_fma_f32 v12, v12, v125, v125
    v_fma_f32 v13, v13, v125, v125
    v_rcp_f32 v126, v126
    s_waitcnt lgkmcnt(3)
    v_mfma_f32_32x32x16_bf16 v[64:79], v[104:107], v[212:215], v[64:79]
    ds_read_b128 v[100:103], v14 offset:7168
    v_rcp_f32 v127, v127
    v_rcp_f32 v12, v12
    v_mfma_f32_32x32x16_bf16 v[80:95], v[108:111], v[148:151], v[80:95]
    ds_read_b128 v[104:107], v11 offset:35840
    buffer_load_dwordx4 v1, s[4:7], s51 offen offset:2048 sc1 lds
    v_rcp_f32 v13, v13
    v_mul_f32 v20, v20, v126
    v_mul_f32 v21, v21, v127
    v_mul_f32 v22, v22, v12
    s_waitcnt lgkmcnt(3)
    v_mfma_f32_32x32x16_bf16 v[64:79], v[112:115], v[216:219], v[64:79]
    ds_read_b128 v[108:111], v14 offset:8192
    v_mul_f32 v23, v23, v13
    v_cvt_pk_bf16_f32 v26, v20, v21
    v_cvt_pk_bf16_f32 v27, v22, v23
    v_mfma_f32_32x32x16_bf16 v[80:95], v[116:119], v[152:155], v[80:95]
    ds_read_b128 v[112:115], v11 offset:39936
    buffer_store_dwordx4 v[24:27], v1, s[4:7], s50 offen offset:0 sc1
    v_mul_f32 v126, v124, v32
    v_mul_f32 v127, v124, v33
    s_waitcnt lgkmcnt(3)
    v_mfma_f32_32x32x16_bf16 v[64:79], v[96:99], v[220:223], v[64:79]
    ds_read_b128 v[116:119], v14 offset:9216
    buffer_load_dwordx4 v1, s[4:7], s51 offen offset:3072 sc1 lds
    s_add_u32 m0, s45, 49152
    s_add_u32 s51, s46, 212992
    v_mul_f32 v12, v124, v34
    v_mul_f32 v13, v124, v35
    v_exp_f32 v126, v126
    v_mul_f32 v32, v32, v40
    v_mfma_f32_32x32x16_bf16 v[80:95], v[100:103], v[156:159], v[80:95]
    ds_read_b128 v[96:99], v11 offset:44032
    v_exp_f32 v127, v127
    v_mul_f32 v33, v33, v41
    v_exp_f32 v12, v12
    s_waitcnt lgkmcnt(3)
    v_mfma_f32_32x32x16_bf16 v[64:79], v[104:107], v[224:227], v[64:79]
    ds_read_b128 v[100:103], v14 offset:10240
    v_mul_f32 v34, v34, v42
    v_exp_f32 v13, v13
    v_mul_f32 v35, v35, v43
    v_fma_f32 v126, v126, v125, v125
    v_mfma_f32_32x32x16_bf16 v[80:95], v[108:111], v[160:163], v[80:95]
    ds_read_b128 v[104:107], v11 offset:48128
    buffer_load_dwordx4 v1, s[4:7], s51 offen offset:0 sc1 lds
    v_fma_f32 v127, v127, v125, v125
    v_fma_f32 v12, v12, v125, v125
    v_fma_f32 v13, v13, v125, v125
    v_rcp_f32 v126, v126
    s_waitcnt lgkmcnt(3)
    v_mfma_f32_32x32x16_bf16 v[64:79], v[112:115], v[228:231], v[64:79]
    ds_read_b128 v[108:111], v14 offset:11264
    v_rcp_f32 v127, v127
    v_rcp_f32 v12, v12
    v_mfma_f32_32x32x16_bf16 v[80:95], v[116:119], v[164:167], v[80:95]
    ds_read_b128 v[112:115], v11 offset:52224
    v_rcp_f32 v13, v13
    v_mul_f32 v32, v32, v126
    v_mul_f32 v33, v33, v127
    v_mul_f32 v34, v34, v12
    s_waitcnt lgkmcnt(3)
    v_mfma_f32_32x32x16_bf16 v[64:79], v[96:99], v[232:235], v[64:79]
    ds_read_b128 v[116:119], v14 offset:12288
    buffer_load_dwordx4 v1, s[4:7], s51 offen offset:1024 sc1 lds
    v_mul_f32 v35, v35, v13
    v_cvt_pk_bf16_f32 v40, v32, v33
    v_cvt_pk_bf16_f32 v41, v34, v35
    v_mul_f32 v126, v124, v36
    v_mul_f32 v127, v124, v37
    v_mfma_f32_32x32x16_bf16 v[80:95], v[100:103], v[168:171], v[80:95]
    ds_read_b128 v[96:99], v11 offset:56320
    v_mul_f32 v12, v124, v38
    v_mul_f32 v13, v124, v39
    v_exp_f32 v126, v126
    v_mul_f32 v36, v36, v44
    s_waitcnt lgkmcnt(3)
    v_mfma_f32_32x32x16_bf16 v[64:79], v[104:107], v[236:239], v[64:79]
    ds_read_b128 v[100:103], v14 offset:13312
    v_exp_f32 v127, v127
    v_mul_f32 v37, v37, v45
    v_exp_f32 v12, v12
    v_mfma_f32_32x32x16_bf16 v[80:95], v[108:111], v[172:175], v[80:95]
    ds_read_b128 v[104:107], v11 offset:60416
    buffer_load_dwordx4 v1, s[4:7], s51 offen offset:2048 sc1 lds
    v_mul_f32 v38, v38, v46
    v_exp_f32 v13, v13
    v_mul_f32 v39, v39, v47
    v_fma_f32 v126, v126, v125, v125
    s_waitcnt lgkmcnt(3)
    v_mfma_f32_32x32x16_bf16 v[64:79], v[112:115], v[240:243], v[64:79]
    ds_read_b128 v[108:111], v14 offset:14336
    v_fma_f32 v127, v127, v125, v125
    v_fma_f32 v12, v12, v125, v125
    v_fma_f32 v13, v13, v125, v125
    v_rcp_f32 v126, v126
    v_mfma_f32_32x32x16_bf16 v[80:95], v[116:119], v[176:179], v[80:95]
    ds_read_b128 v[112:115], v11 offset:64512
    v_rcp_f32 v127, v127
    v_rcp_f32 v12, v12
    s_waitcnt lgkmcnt(3)
    v_mfma_f32_32x32x16_bf16 v[64:79], v[96:99], v[244:247], v[64:79]
    ds_read_b128 v[116:119], v14 offset:15360
    buffer_load_dwordx4 v1, s[4:7], s51 offen offset:3072 sc1 lds
    s_add_u32 s34, s34, 16384
    v_rcp_f32 v13, v13
    v_mul_f32 v36, v36, v126
    v_mul_f32 v37, v37, v127
    v_mul_f32 v38, v38, v12
    v_mfma_f32_32x32x16_bf16 v[80:95], v[100:103], v[180:183], v[80:95]
    ds_read_b128 v[96:99], v14 offset:16384
    v_mul_f32 v39, v39, v13
    v_cvt_pk_bf16_f32 v42, v36, v37
    v_cvt_pk_bf16_f32 v43, v38, v39
    s_waitcnt vmcnt(13)
    s_barrier
    s_waitcnt lgkmcnt(3)
    v_mfma_f32_32x32x16_bf16 v[64:79], v[104:107], v[248:251], v[64:79]
    ds_read_b128 v[100:103], v1 offset:0
    buffer_store_dwordx4 v[40:43], v1, s[4:7], s50 offen offset:1024 sc1
    v_mul_f32 v126, v124, v48
    v_mul_f32 v127, v124, v49
    v_mfma_f32_32x32x16_bf16 v[80:95], v[108:111], v[184:187], v[80:95]
    ds_read_b128 v[104:107], v14 offset:17408
    buffer_load_dwordx4 a[176:179], v10, s[4:7], s34 offen offset:2048 sc1
    s_add_u32 s35, s35, 16384
    v_mul_f32 v12, v124, v50
    v_mul_f32 v13, v124, v51
    v_exp_f32 v126, v126
    v_mul_f32 v48, v48, v56
    s_waitcnt lgkmcnt(3)
    v_mfma_f32_32x32x16_bf16 v[64:79], v[112:115], v[252:255], v[64:79]
    ds_read_b128 v[108:111], v1 offset:1024
    v_exp_f32 v127, v127
    v_mul_f32 v49, v49, v57
    v_exp_f32 v12, v12
    v_mfma_f32_32x32x16_bf16 v[80:95], v[116:119], v[188:191], v[80:95]
    ds_read_b128 v[112:115], v14 offset:18432
    v_mul_f32 v50, v50, v58
    v_exp_f32 v13, v13
    v_mul_f32 v51, v51, v59
    v_fma_f32 v126, v126, v125, v125
    v_mfma_f32_32x32x16_bf16 v[64:79], a[236:239], v[120:123], v[64:79]
    v_fma_f32 v127, v127, v125, v125
    v_fma_f32 v12, v12, v125, v125
    v_fma_f32 v13, v13, v125, v125
    v_rcp_f32 v126, v126
    s_waitcnt lgkmcnt(3)
    v_mfma_f32_32x32x16_bf16 v[80:95], v[96:99], v[192:195], v[80:95]
    ds_read_b128 v[116:119], v1 offset:2048
    buffer_load_dwordx4 a[180:183], v10, s[4:7], s35 offen offset:2048 sc1
    v_rcp_f32 v127, v127
    v_rcp_f32 v12, v12
    v_mfma_f32_32x32x16_bf16 v[16:31], v[100:103], v[128:131], 0
    ds_read_b128 v[96:99], v14 offset:19456
    v_rcp_f32 v13, v13
    v_mul_f32 v48, v48, v126
    v_mul_f32 v49, v49, v127
    v_mul_f32 v50, v50, v12
    s_waitcnt lgkmcnt(3)
    v_mfma_f32_32x32x16_bf16 v[80:95], v[104:107], v[196:199], v[80:95]
    ds_read_b128 v[100:103], v1 offset:3072
    v_mul_f32 v51, v51, v13
    v_cvt_pk_bf16_f32 v56, v48, v49
    v_cvt_pk_bf16_f32 v57, v50, v51
    v_mul_f32 v126, v124, v52
    v_mul_f32 v127, v124, v53
    v_mfma_f32_32x32x16_bf16 v[16:31], v[108:111], v[132:135], v[16:31]
    ds_read_b128 v[104:107], v14 offset:20480
    buffer_load_dwordx4 a[184:187], v10, s[4:7], s34 offen offset:3072 sc1
    v_mul_f32 v12, v124, v54
    v_mul_f32 v13, v124, v55
    v_exp_f32 v126, v126
    v_mul_f32 v52, v52, v60
    s_waitcnt lgkmcnt(3)
    v_mfma_f32_32x32x16_bf16 v[80:95], v[112:115], v[200:203], v[80:95]
    ds_read_b128 v[108:111], v1 offset:4096
    v_exp_f32 v127, v127
    v_mul_f32 v53, v53, v61
    v_exp_f32 v12, v12
    v_mfma_f32_32x32x16_bf16 v[16:31], v[116:119], v[136:139], v[16:31]
    ds_read_b128 v[112:115], v14 offset:21504
    v_mul_f32 v54, v54, v62
    v_exp_f32 v13, v13
    v_mul_f32 v55, v55, v63
    v_fma_f32 v126, v126, v125, v125
    s_waitcnt lgkmcnt(3)
    v_mfma_f32_32x32x16_bf16 v[80:95], v[96:99], v[204:207], v[80:95]
    ds_read_b128 v[116:119], v1 offset:5120
    buffer_load_dwordx4 a[188:191], v10, s[4:7], s35 offen offset:3072 sc1
    s_add_u32 s34, s34, 8192
    v_fma_f32 v127, v127, v125, v125
    v_fma_f32 v12, v12, v125, v125
    v_fma_f32 v13, v13, v125, v125
    v_rcp_f32 v126, v126
    v_mfma_f32_32x32x16_bf16 v[16:31], v[100:103], v[140:143], v[16:31]
    ds_read_b128 v[96:99], v14 offset:22528
    v_rcp_f32 v127, v127
    v_rcp_f32 v12, v12
    s_waitcnt lgkmcnt(3)
    v_mfma_f32_32x32x16_bf16 v[80:95], v[104:107], v[208:211], v[80:95]
    ds_read_b128 v[100:103], v1 offset:6144
    v_rcp_f32 v13, v13
    v_mul_f32 v52, v52, v126
    v_mul_f32 v53, v53, v127
    v_mul_f32 v54, v54, v12
    v_mfma_f32_32x32x16_bf16 v[16:31], v[108:111], v[144:147], v[16:31]
    ds_read_b128 v[104:107], v14 offset:23552
    buffer_load_dwordx4 a[192:195], v1, s[4:7], s34 offen offset:0 sc1
    s_add_u32 s35, s35, 8192
    s_waitcnt vmcnt(11)
    v_mov_b32 v4, 1
    s_mov_b64 exec, 1
    buffer_store_dword v4, v3, s[4:7], s74 offen
    s_mov_b64 exec, -1
    v_mul_f32 v55, v55, v13
    v_cvt_pk_bf16_f32 v58, v52, v53
    v_cvt_pk_bf16_f32 v59, v54, v55
    s_waitcnt lgkmcnt(3)
    v_mfma_f32_32x32x16_bf16 v[80:95], v[112:115], v[212:215], v[80:95]
    ds_read_b128 v[108:111], v1 offset:7168
    buffer_store_dwordx4 v[56:59], v1, s[4:7], s50 offen offset:2048 sc1
    v_mul_f32 v126, v124, v64
    v_mul_f32 v127, v124, v65
    v_mfma_f32_32x32x16_bf16 v[16:31], v[116:119], v[148:151], v[16:31]
    ds_read_b128 v[112:115], v14 offset:24576
    v_mul_f32 v12, v124, v66
    v_mul_f32 v13, v124, v67
    v_exp_f32 v126, v126
    v_mul_f32 v64, v64, v72
    s_waitcnt lgkmcnt(3)
    v_mfma_f32_32x32x16_bf16 v[80:95], v[96:99], v[216:219], v[80:95]
    ds_read_b128 v[116:119], v1 offset:8192
    buffer_load_dwordx4 a[196:199], v1, s[4:7], s35 offen offset:0 sc1
    v_exp_f32 v127, v127
    v_mul_f32 v65, v65, v73
    v_exp_f32 v12, v12
    v_mfma_f32_32x32x16_bf16 v[16:31], v[100:103], v[152:155], v[16:31]
    ds_read_b128 v[96:99], v14 offset:25600
    v_mul_f32 v66, v66, v74
    v_exp_f32 v13, v13
    v_mul_f32 v67, v67, v75
    v_fma_f32 v126, v126, v125, v125
    s_waitcnt lgkmcnt(3)
    v_mfma_f32_32x32x16_bf16 v[80:95], v[104:107], v[220:223], v[80:95]
    ds_read_b128 v[100:103], v1 offset:9216
    v_fma_f32 v127, v127, v125, v125
    v_fma_f32 v12, v12, v125, v125
    v_fma_f32 v13, v13, v125, v125
    v_rcp_f32 v126, v126
    v_mfma_f32_32x32x16_bf16 v[16:31], v[108:111], v[156:159], v[16:31]
    ds_read_b128 v[104:107], v14 offset:26624
    buffer_load_dwordx4 a[200:203], v1, s[4:7], s34 offen offset:1024 sc1
    v_rcp_f32 v127, v127
    v_rcp_f32 v12, v12
    s_waitcnt lgkmcnt(3)
    v_mfma_f32_32x32x16_bf16 v[80:95], v[112:115], v[224:227], v[80:95]
    ds_read_b128 v[108:111], v1 offset:10240
    v_rcp_f32 v13, v13
    v_mul_f32 v64, v64, v126
    v_mul_f32 v65, v65, v127
    v_mul_f32 v66, v66, v12
    v_mfma_f32_32x32x16_bf16 v[16:31], v[116:119], v[160:163], v[16:31]
    ds_read_b128 v[112:115], v14 offset:27648
    buffer_load_dword v5, v3, s[4:7], s75 offen sc1
    v_mul_f32 v67, v67, v13
    v_cvt_pk_bf16_f32 v72, v64, v65
    v_cvt_pk_bf16_f32 v73, v66, v67
    v_mul_f32 v126, v124, v68
    v_mul_f32 v127, v124, v69
    s_waitcnt lgkmcnt(3)
    v_mfma_f32_32x32x16_bf16 v[80:95], v[96:99], v[228:231], v[80:95]
    ds_read_b128 v[116:119], v1 offset:11264
    buffer_load_dwordx4 a[204:207], v1, s[4:7], s35 offen offset:1024 sc1
    v_mul_f32 v12, v124, v70
    v_mul_f32 v13, v124, v71
    v_exp_f32 v126, v126
    v_mul_f32 v68, v68, v76
    v_mfma_f32_32x32x16_bf16 v[16:31], v[100:103], v[164:167], v[16:31]
    ds_read_b128 v[96:99], v14 offset:28672
    v_exp_f32 v127, v127
    v_mul_f32 v69, v69, v77
    v_exp_f32 v12, v12
    s_waitcnt lgkmcnt(3)
    v_mfma_f32_32x32x16_bf16 v[80:95], v[104:107], v[232:235], v[80:95]
    ds_read_b128 v[100:103], v1 offset:12288
    v_mul_f32 v70, v70, v78
    v_exp_f32 v13, v13
    v_mul_f32 v71, v71, v79
    v_fma_f32 v126, v126, v125, v125
    v_mfma_f32_32x32x16_bf16 v[16:31], v[108:111], v[168:171], v[16:31]
    ds_read_b128 v[104:107], v14 offset:29696
    buffer_load_dwordx4 a[208:211], v1, s[4:7], s34 offen offset:2048 sc1
    v_fma_f32 v127, v127, v125, v125
    v_fma_f32 v12, v12, v125, v125
    v_fma_f32 v13, v13, v125, v125
    v_rcp_f32 v126, v126
    s_waitcnt lgkmcnt(3)
    v_mfma_f32_32x32x16_bf16 v[80:95], v[112:115], v[236:239], v[80:95]
    ds_read_b128 v[108:111], v1 offset:13312
    v_rcp_f32 v127, v127
    v_rcp_f32 v12, v12
    v_mfma_f32_32x32x16_bf16 v[16:31], v[116:119], v[172:175], v[16:31]
    ds_read_b128 v[112:115], v14 offset:30720
    v_rcp_f32 v13, v13
    v_mul_f32 v68, v68, v126
    v_mul_f32 v69, v69, v127
    v_mul_f32 v70, v70, v12
    s_waitcnt lgkmcnt(3)
    v_mfma_f32_32x32x16_bf16 v[80:95], v[96:99], v[240:243], v[80:95]
    ds_read_b128 v[116:119], v1 offset:14336
    buffer_load_dwordx4 a[212:215], v1, s[4:7], s35 offen offset:2048 sc1
    v_mul_f32 v71, v71, v13
    v_cvt_pk_bf16_f32 v74, v68, v69
    v_cvt_pk_bf16_f32 v75, v70, v71
    v_mfma_f32_32x32x16_bf16 v[16:31], v[100:103], v[176:179], v[16:31]
    ds_read_b128 v[96:99], v14 offset:31744
    buffer_store_dwordx4 v[72:75], v1, s[4:7], s50 offen offset:3072 sc1
    s_waitcnt lgkmcnt(3)
    v_mfma_f32_32x32x16_bf16 v[80:95], v[104:107], v[244:247], v[80:95]
    ds_read_b128 v[100:103], v1 offset:15360
    s_waitcnt vmcnt(19)
    s_barrier
    v_mfma_f32_32x32x16_bf16 v[16:31], v[108:111], v[180:183], v[16:31]
    ds_read_b128 v[104:107], v1 offset:16384
    buffer_load_dwordx4 a[216:219], v1, s[4:7], s34 offen offset:3072 sc1
    s_waitcnt lgkmcnt(3)
    v_mfma_f32_32x32x16_bf16 v[80:95], v[112:115], v[248:251], v[80:95]
    ds_read_b128 v[108:111], v1 offset:32768
    v_mfma_f32_32x32x16_bf16 v[16:31], v[116:119], v[184:187], v[16:31]
    ds_read_b128 v[112:115], v1 offset:17408
    s_waitcnt lgkmcnt(3)
    v_mfma_f32_32x32x16_bf16 v[80:95], v[96:99], v[252:255], v[80:95]
    ds_read_b128 v[116:119], v1 offset:33792
    buffer_load_dwordx4 a[220:223], v1, s[4:7], s35 offen offset:3072 sc1
    v_mfma_f32_32x32x16_bf16 v[16:31], v[100:103], v[188:191], v[16:31]
    ds_read_b128 v[96:99], v1 offset:18432
    v_mfma_f32_32x32x16_bf16 v[80:95], a[240:243], v[120:123], v[80:95]
    s_waitcnt lgkmcnt(3)
    v_mfma_f32_32x32x16_bf16 v[16:31], v[104:107], v[192:195], v[16:31]
    ds_read_b128 v[100:103], v1 offset:34816
    s_waitcnt vmcnt(6)
    v_cmp_le_u32 vcc, 1, v5
    s_cmp_eq_u64 vcc, -1
    s_cbranch_scc0 F_e5s0
F_e5b0:
    v_mfma_f32_32x32x16_bf16 v[32:47], v[108:111], v[128:131], 0
    ds_read_b128 v[104:107], v1 offset:19456
    buffer_load_dwordx4 v[128:131], v1, s[4:7], s76 offen offset:0 sc1
    s_nop 1
    v_mul_f32 v126, v124, v80
    v_mul_f32 v127, v124, v81
    v_mul_f32 v12, v124, v82
    v_mul_f32 v13, v124, v83
    s_waitcnt lgkmcnt(3)
    v_mfma_f32_32x32x16_bf16 v[16:31], v[112:115], v[196:199], v[16:31]
    ds_read_b128 v[108:111], v1 offset:35840
    v_exp_f32 v126, v126
    v_mul_f32 v80, v80, v88
    v_exp_f32 v127, v127
    v_mfma_f32_32x32x16_bf16 v[32:47], v[116:119], v[132:135], v[32:47]
    ds_read_b128 v[112:115], v1 offset:20480
    buffer_load_dwordx4 v[132:135], v1, s[4:7], s80 offen offset:0 sc1
    v_mul_f32 v81, v81, v89
    v_exp_f32 v12, v12
    v_mul_f32 v82, v82, v90
    s_waitcnt lgkmcnt(3)
    v_mfma_f32_32x32x16_bf16 v[16:31], v[96:99], v[200:203], v[16:31]
    ds_read_b128 v[116:119], v1 offset:36864
    v_exp_f32 v13, v13
    v_mul_f32 v83, v83, v91
    v_fma_f32 v126, v126, v125, v125
    v_fma_f32 v127, v127, v125, v125
    v_mfma_f32_32x32x16_bf16 v[32:47], v[100:103], v[136:139], v[32:47]
    ds_read_b128 v[96:99], v1 offset:21504
    buffer_load_dwordx4 v[136:139], v10, s[4:7], s76 offen offset:3072 sc1
    v_fma_f32 v12, v12, v125, v125
    v_fma_f32 v13, v13, v125, v125
    v_rcp_f32 v126, v126
    s_waitcnt lgkmcnt(3)
    v_mfma_f32_32x32x16_bf16 v[16:31], v[104:107], v[204:207], v[16:31]
    ds_read_b128 v[100:103], v1 offset:37888
    v_mov_b32 v4, 2
    s_mov_b64 exec, 1
    buffer_store_dword v4, v3, s[4:7], s74 offen
    s_mov_b64 exec, -1
    v_rcp_f32 v127, v127
    v_rcp_f32 v12, v12
    v_mfma_f32_32x32x16_bf16 v[32:47], v[108:111], v[140:143], v[32:47]
    ds_read_b128 v[104:107], v1 offset:22528
    buffer_load_dwordx4 v[140:143], v10, s[4:7], s80 offen offset:3072 sc1
    v_rcp_f32 v13, v13
    v_mul_f32 v80, v80, v126
    v_mul_f32 v81, v81, v127
    v_mul_f32 v82, v82, v12
    s_waitcnt lgkmcnt(3)
    v_mfma_f32_32x32x16_bf16 v[16:31], v[112:115], v[208:211], v[16:31]
    ds_read_b128 v[108:111], v1 offset:38912
    v_mul_f32 v83, v83, v13
    v_cvt_pk_bf16_f32 v88, v80, v81
    v_cvt_pk_bf16_f32 v89, v82, v83
    v_mul_f32 v126, v124, v84
    v_mul_f32 v127, v124, v85
    v_mfma_f32_32x32x16_bf16 v[32:47], v[116:119], v[144:147], v[32:47]
    ds_read_b128 v[112:115], v1 offset:23552
    buffer_load_dwordx4 v[144:147], v10, s[4:7], s77 offen offset:2048 sc1
    v_mul_f32 v12, v124, v86
    v_mul_f32 v13, v124, v87
    v_exp_f32 v126, v126
    v_mul_f32 v84, v84, v92
    s_waitcnt lgkmcnt(3)
    v_mfma_f32_32x32x16_bf16 v[16:31], v[96:99], v[212:215], v[16:31]
    ds_read_b128 v[116:119], v1 offset:39936
    v_exp_f32 v127, v127
    v_mul_f32 v85, v85, v93
    v_exp_f32 v12, v12
    v_mfma_f32_32x32x16_bf16 v[32:47], v[100:103], v[148:151], v[32:47]
    ds_read_b128 v[96:99], v1 offset:24576
    buffer_load_dwordx4 v[148:151], v10, s[4:7], s81 offen offset:2048 sc1
    v_mul_f32 v86, v86, v94
    v_exp_f32 v13, v13
    v_mul_f32 v87, v87, v95
    v_fma_f32 v126, v126, v125, v125
    s_waitcnt lgkmcnt(3)
    v_mfma_f32_32x32x16_bf16 v[16:31], v[104:107], v[216:219], v[16:31]
    ds_read_b128 v[100:103], v1 offset:40960
    v_fma_f32 v127, v127, v125, v125
    v_fma_f32 v12, v12, v125, v125
    v_fma_f32 v13, v13, v125, v125
    v_rcp_f32 v126, v126
    v_mfma_f32_32x32x16_bf16 v[32:47], v[108:111], v[152:155], v[32:47]
    ds_read_b128 v[104:107], v1 offset:25600
    buffer_load_dwordx4 v[152:155], v10, s[4:7], s78 offen offset:1024 sc1
    v_rcp_f32 v127, v127
    v_rcp_f32 v12, v12
    s_waitcnt lgkmcnt(3)
    v_mfma_f32_32x32x16_bf16 v[16:31], v[112:115], v[220:223], v[16:31]
    ds_read_b128 v[108:111], v1 offset:41984
    buffer_load_dword v5, v3, s[4:7], s75 offen sc1
    v_rcp_f32 v13, v13
    v_mul_f32 v84, v84, v126
    v_mul_f32 v85, v85, v127
    v_mul_f32 v86, v86, v12
    v_mfma_f32_32x32x16_bf16 v[32:47], v[116:119], v[156:159], v[32:47]
    ds_read_b128 v[112:115], v1 offset:26624
    buffer_load_dwordx4 v[156:159], v10, s[4:7], s82 offen offset:1024 sc1
    v_mul_f32 v87, v87, v13
    v_cvt_pk_bf16_f32 v90, v84, v85
    v_cvt_pk_bf16_f32 v91, v86, v87
    s_waitcnt lgkmcnt(3)
    v_mfma_f32_32x32x16_bf16 v[16:31], v[96:99], v[224:227], v[16:31]
    ds_read_b128 v[116:119], v1 offset:43008
    buffer_store_dwordx4 v[88:91], v10, s[4:7], s50 offen offset:0 sc1
    v_mfma_f32_32x32x16_bf16 v[32:47], v[100:103], v[160:163], v[32:47]
    ds_read_b128 v[96:99], v1 offset:27648
    s_waitcnt lgkmcnt(3)
    v_mfma_f32_32x32x16_bf16 v[16:31], v[104:107], v[228:231], v[16:31]
    ds_read_b128 v[100:103], v1 offset:44032
    v_mfma_f32_32x32x16_bf16 v[32:47], v[108:111], v[164:167], v[32:47]
    ds_read_b128 v[104:107], v1 offset:28672
    s_waitcnt lgkmcnt(3)
    v_mfma_f32_32x32x16_bf16 v[16:31], v[112:115], v[232:235], v[16:31]
    ds_read_b128 v[108:111], v1 offset:45056
    v_mfma_f32_32x32x16_bf16 v[32:47], v[116:119], v[168:171], v[32:47]
    ds_read_b128 v[112:115], v1 offset:29696
    s_waitcnt lgkmcnt(3)
    v_mfma_f32_32x32x16_bf16 v[16:31], v[96:99], v[236:239], v[16:31]
    ds_read_b128 v[116:119], v1 offset:46080
    v_mfma_f32_32x32x16_bf16 v[32:47], v[100:103], v[172:175], v[32:47]
    ds_read_b128 v[96:99], v1 offset:30720
    s_waitcnt lgkmcnt(3)
    v_mfma_f32_32x32x16_bf16 v[16:31], v[104:107], v[240:243], v[16:31]
    ds_read_b128 v[100:103], v1 offset:47104
    v_mfma_f32_32x32x16_bf16 v[32:47], v[108:111], v[176:179], v[32:47]
    ds_read_b128 v[104:107], v1 offset:31744
    s_waitcnt lgkmcnt(3)
    v_mfma_f32_32x32x16_bf16 v[16:31], v[112:115], v[244:247], v[16:31]
    ds_read_b128 v[108:111], v1 offset:48128
    s_barrier
    v_mfma_f32_32x32x16_bf16 v[32:47], v[116:119], v[180:183], v[32:47]
    ds_read_b128 v[112:115], v1 offset:49152
    s_waitcnt lgkmcnt(3)
    v_mfma_f32_32x32x16_bf16 v[16:31], v[96:99], v[248:251], v[16:31]
    ds_read_b128 v[116:119], v1 offset:50176
    v_mfma_f32_32x32x16_bf16 v[32:47], v[100:103], v[184:187], v[32:47]
    ds_read_b128 v[96:99], v1 offset:51200
    s_waitcnt lgkmcnt(3)
    v_mfma_f32_32x32x16_bf16 v[16:31], v[104:107], v[252:255], v[16:31]
    ds_read_b128 v[100:103], v1 offset:52224
    v_mfma_f32_32x32x16_bf16 v[32:47], v[108:111], v[188:191], v[32:47]
    ds_read_b128 v[104:107], v1 offset:53248
    v_mfma_f32_32x32x16_bf16 v[16:31], a[244:247], v[120:123], v[16:31]
    s_waitcnt lgkmcnt(3)
    v_mfma_f32_32x32x16_bf16 v[32:47], v[112:115], v[192:195], v[32:47]
    ds_read_b128 v[108:111], v1 offset:54272
    s_waitcnt vmcnt(2)
    v_cmp_le_u32 vcc, 2, v5
    s_cmp_eq_u64 vcc, -1
    s_cbranch_scc0 F_e5s1
F_e5b1:
    buffer_load_dwordx4 v[160:163], v1, s[4:7], s76 offen offset:1024 sc1
    v_mfma_f32_32x32x16_bf16 v[32:47], v[116:119], v[196:199], v[32:47]
    ds_read_b128 v[112:115], v1 offset:55296
    s_nop 1
    v_mul_f32 v126, v124, v16
    v_mul_f32 v127, v124, v17
    v_mul_f32 v12, v124, v18
    v_mul_f32 v13, v124, v19
    s_waitcnt lgkmcnt(3)
    v_mfma_f32_32x32x16_bf16 v[32:47], v[96:99], v[200:203], v[32:47]
    ds_read_b128 v[116:119], v1 offset:56320
    buffer_load_dwordx4 v[164:167], v1, s[4:7], s80 offen offset:1024 sc1
    v_exp_f32 v126, v126
    v_mul_f32 v16, v16, v24
    v_exp_f32 v127, v127
    v_mfma_f32_32x32x16_bf16 v[32:47], v[100:103], v[204:207], v[32:47]
    ds_read_b128 v[96:99], v1 offset:57344
    v_mul_f32 v17, v17, v25
    v_exp_f32 v12, v12
    v_mul_f32 v18, v18, v26
    s_waitcnt lgkmcnt(3)
    v_mfma_f32_32x32x16_bf16 v[32:47], v[104:107], v[208:211], v[32:47]
    ds_read_b128 v[100:103], v1 offset:58368
    buffer_load_dwordx4 v[168:171], v1, s[4:7], s76 offen offset:2048 sc1
    v_exp_f32 v13, v13
    v_mul_f32 v19, v19, v27
    v_fma_f32 v126, v126, v125, v125
    v_fma_f32 v127, v127, v125, v125
    v_mfma_f32_32x32x16_bf16 v[32:47], v[108:111], v[212:215], v[32:47]
    ds_read_b128 v[104:107], v1 offset:59392
    v_fma_f32 v12, v12, v125, v125
    v_fma_f32 v13, v13, v125, v125
    v_rcp_f32 v126, v126
    s_waitcnt lgkmcnt(3)
    v_mfma_f32_32x32x16_bf16 v[32:47], v[112:115], v[216:219], v[32:47]
    ds_read_b128 v[108:111], v1 offset:60416
    buffer_load_dwordx4 v[172:175], v1, s[4:7], s80 offen offset:2048 sc1
    v_rcp_f32 v127, v127
    v_rcp_f32 v12, v12
    v_mfma_f32_32x32x16_bf16 v[32:47], v[116:119], v[220:223], v[32:47]
    ds_read_b128 v[112:115], v1 offset:61440
    v_rcp_f32 v13, v13
    v_mul_f32 v16, v16, v126
    v_mul_f32 v17, v17, v127
    v_mul_f32 v18, v18, v12
    s_waitcnt lgkmcnt(3)
    v_mfma_f32_32x32x16_bf16 v[32:47], v[96:99], v[224:227], v[32:47]
    ds_read_b128 v[116:119], v1 offset:62464
    buffer_load_dwordx4 v[176:179], v1, s[4:7], s77 offen offset:0 sc1
    v_mul_f32 v19, v19, v13
    v_cvt_pk_bf16_f32 v24, v16, v17
    v_cvt_pk_bf16_f32 v25, v18, v19
    v_mul_f32 v126, v124, v20
    v_mul_f32 v127, v124, v21
    v_mfma_f32_32x32x16_bf16 v[32:47], v[100:103], v[228:231], v[32:47]
    ds_read_b128 v[96:99], v1 offset:63488
    v_mul_f32 v12, v124, v22
    v_mul_f32 v13, v124, v23
    v_exp_f32 v126, v126
    v_mul_f32 v20, v20, v28
    s_waitcnt lgkmcnt(3)
    v_mfma_f32_32x32x16_bf16 v[32:47], v[104:107], v[232:235], v[32:47]
    ds_read_b128 v[100:103], v1 offset:64512
    buffer_load_dwordx4 v[180:183], v1, s[4:7], s81 offen offset:0 sc1
    v_exp_f32 v127, v127
    v_mul_f32 v21, v21, v29
    v_exp_f32 v12, v12
    v_mfma_f32_32x32x16_bf16 v[32:47], v[108:111], v[236:239], v[32:47]
    v_mul_f32 v22, v22, v30
    v_exp_f32 v13, v13
    v_mul_f32 v23, v23, v31
    v_fma_f32 v126, v126, v125, v125
    s_waitcnt lgkmcnt(2)
    v_mfma_f32_32x32x16_bf16 v[32:47], v[112:115], v[240:243], v[32:47]
    buffer_load_dwordx4 v[184:187], v1, s[4:7], s77 offen offset:1024 sc1
    v_fma_f32 v127, v127, v125, v125
    v_fma_f32 v12, v12, v125, v125
    v_fma_f32 v13, v13, v125, v125
    v_rcp_f32 v126, v126
    v_mfma_f32_32x32x16_bf16 v[32:47], v[116:119], v[244:247], v[32:47]
    v_rcp_f32 v127, v127
    v_rcp_f32 v12, v12
    s_waitcnt lgkmcnt(0)
    v_mfma_f32_32x32x16_bf16 v[32:47], v[96:99], v[248:251], v[32:47]
    s_waitcnt vmcnt(7)
    v_mov_b32 v4, 3
    s_mov_b64 exec, 1
    buffer_store_dword v4, v3, s[4:7], s74 offen
    s_mov_b64 exec, -1
    buffer_load_dwordx4 v[188:191], v1, s[4:7], s81 offen offset:1024 sc1
    v_rcp_f32 v13, v13
    v_mul_f32 v20, v20, v126
    v_mul_f32 v21, v21, v127
    v_mul_f32 v22, v22, v12
    v_mfma_f32_32x32x16_bf16 v[32:47], v[100:103], v[252:255], v[32:47]
    v_mul_f32 v23, v23, v13
    v_cvt_pk_bf16_f32 v26, v20, v21
    v_cvt_pk_bf16_f32 v27, v22, v23
    v_mfma_f32_32x32x16_bf16 v[32:47], a[248:251], v[120:123], v[32:47]
    buffer_store_dwordx4 v[24:27], v10, s[4:7], s50 offen offset:1024
    v_mfma_f32_32x32x16_bf16 v[48:63], a[0:3], v[128:131], 0
    buffer_load_dwordx4 v[192:195], v10, s[4:7], s77 offen offset:3072 sc1
    v_mfma_f32_32x32x16_bf16 v[64:79], a[4:7], v[128:131], 0
    buffer_load_dwordx4 v[196:199], v10, s[4:7], s81 offen offset:3072 sc1
    s_nop 6
    v_mul_f32 v126, v124, v32
    v_mul_f32 v127, v124, v33
    v_mul_f32 v12, v124, v34
    v_mul_f32 v13, v124, v35
    v_exp_f32 v126, v126
    v_mul_f32 v32, v32, v40
    v_mfma_f32_32x32x16_bf16 v[80:95], a[0:3], v[132:135], 0
    v_exp_f32 v127, v127
    v_mul_f32 v33, v33, v41
    v_exp_f32 v12, v12
    v_mul_f32 v34, v34, v42
    v_mfma_f32_32x32x16_bf16 v[96:111], a[4:7], v[132:135], 0
    buffer_load_dwordx4 v[200:203], v1, s[4:7], s78 offen offset:0 sc1
    v_exp_f32 v13, v13
    v_mul_f32 v35, v35, v43
    v_fma_f32 v126, v126, v125, v125
    v_fma_f32 v127, v127, v125, v125
    v_fma_f32 v12, v12, v125, v125
    v_fma_f32 v13, v13, v125, v125
    v_mfma_f32_32x32x16_bf16 v[48:63], a[56:59], v[136:139], v[48:63]
    buffer_load_dwordx4 v[204:207], v1, s[4:7], s82 offen offset:0 sc1
    v_rcp_f32 v126, v126
    v_rcp_f32 v127, v127
    v_rcp_f32 v12, v12
    v_mfma_f32_32x32x16_bf16 v[64:79], a[60:63], v[136:139], v[64:79]
    buffer_load_dword v5, v3, s[4:7], s75 offen sc1
    v_rcp_f32 v13, v13
    v_mul_f32 v32, v32, v126
    v_mul_f32 v33, v33, v127
    v_mul_f32 v34, v34, v12
    v_mul_f32 v35, v35, v13
    v_cvt_pk_bf16_f32 v40, v32, v33
    v_mfma_f32_32x32x16_bf16 v[80:95], a[56:59], v[140:143], v[80:95]
    buffer_load_dwordx4 v[208:211], v10, s[4:7], s78 offen offset:2048 sc1
    v_cvt_pk_bf16_f32 v41, v34, v35
    v_mul_f32 v126, v124, v36
    v_mul_f32 v127, v124, v37
    v_mul_f32 v12, v124, v38
    v_mul_f32 v13, v124, v39
    v_exp_f32 v126, v126
    v_mfma_f32_32x32x16_bf16 v[96:111], a[60:63], v[140:143], v[96:111]
    buffer_load_dwordx4 v[212:215], v10, s[4:7], s82 offen offset:2048 sc1
    v_mul_f32 v36, v36, v44
    v_exp_f32 v127, v127
    v_mul_f32 v37, v37, v45
    v_exp_f32 v12, v12
    v_mul_f32 v38, v38, v46
    v_mfma_f32_32x32x16_bf16 v[48:63], a[112:115], v[144:147], v[48:63]
    v_exp_f32 v13, v13
    v_mul_f32 v39, v39, v47
    v_fma_f32 v126, v126, v125, v125
    v_fma_f32 v127, v127, v125, v125
    v_fma_f32 v12, v12, v125, v125
    v_fma_f32 v13, v13, v125, v125
    v_mfma_f32_32x32x16_bf16 v[64:79], a[116:119], v[144:147], v[64:79]
    buffer_load_dwordx4 v[216:219], v10, s[4:7], s78 offen offset:3072 sc1
    v_rcp_f32 v126, v126
    v_rcp_f32 v127, v127
    v_rcp_f32 v12, v12
    v_mfma_f32_32x32x16_bf16 v[80:95], a[112:115], v[148:151], v[80:95]
    buffer_load_dwordx4 v[220:223], v10, s[4:7], s82 offen offset:3072 sc1
    v_rcp_f32 v13, v13
    v_mul_f32 v36, v36, v126
    v_mul_f32 v37, v37, v127
    v_mul_f32 v38, v38, v12
    v_mul_f32 v39, v39, v13
    v_cvt_pk_bf16_f32 v42, v36, v37
    v_mfma_f32_32x32x16_bf16 v[96:111], a[116:119], v[148:151], v[96:111]
    v_cvt_pk_bf16_f32 v43, v38, v39
    buffer_store_dwordx4 v[40:43], v10, s[4:7], s50 offen offset:2048
    s_xor_b32 s46, s3, 1
    s_mul_i32 s46, s46, 12288
    v_add_u32 v13, s46, v1
    s_xor_b32 s46, s3, 2
    s_mul_i32 s46, s46, 12288
    v_mfma_f32_32x32x16_bf16 v[48:63], a[168:171], v[152:155], v[48:63]
    v_add_u32 v14, s46, v1
    s_xor_b32 s46, s3, 3
    s_mul_i32 s46, s46, 12288
    v_add_u32 v15, s46, v1
    s_mul_i32 s46, s3, 12288
    v_add_u32 v12, s46, v1
    v_mfma_f32_32x32x16_bf16 v[64:79], a[172:175], v[152:155], v[64:79]
    v_mfma_f32_32x32x16_bf16 v[80:95], a[168:171], v[156:159], v[80:95]
    v_mfma_f32_32x32x16_bf16 v[96:111], a[172:175], v[156:159], v[96:111]
    s_waitcnt vmcnt(18)
    v_mfma_f32_32x32x16_bf16 v[48:63], a[8:11], v[160:163], v[48:63]
    v_mfma_f32_32x32x16_bf16 v[64:79], a[12:15], v[160:163], v[64:79]
    v_mfma_f32_32x32x16_bf16 v[80:95], a[8:11], v[164:167], v[80:95]
    v_mfma_f32_32x32x16_bf16 v[96:111], a[12:15], v[164:167], v[96:111]
    s_waitcnt vmcnt(16)
    v_mfma_f32_32x32x16_bf16 v[48:63], a[16:19], v[168:171], v[48:63]
    v_mfma_f32_32x32x16_bf16 v[64:79], a[20:23], v[168:171], v[64:79]
    v_mfma_f32_32x32x16_bf16 v[80:95], a[16:19], v[172:175], v[80:95]
    v_mfma_f32_32x32x16_bf16 v[96:111], a[20:23], v[172:175], v[96:111]
    s_waitcnt vmcnt(14)
    v_mfma_f32_32x32x16_bf16 v[48:63], a[64:67], v[176:179], v[48:63]
    s_waitcnt vmcnt(0)
    v_mov_b32 v4, 4
    s_mov_b64 exec, 1
    buffer_store_dword v4, v3, s[4:7], s74 offen
    s_mov_b64 exec, -1
    v_mfma_f32_32x32x16_bf16 v[64:79], a[68:71], v[176:179], v[64:79]
    v_mfma_f32_32x32x16_bf16 v[80:95], a[64:67], v[180:183], v[80:95]
    v_mfma_f32_32x32x16_bf16 v[96:111], a[68:71], v[180:183], v[96:111]
    v_cmp_le_u32 vcc, 3, v5
    s_cmp_eq_u64 vcc, -1
    s_cbranch_scc0 F_e5s2
F_e5b2:
    buffer_load_dwordx4 v[224:227], v1, s[4:7], s76 offen offset:3072 sc1
    v_mfma_f32_32x32x16_bf16 v[48:63], a[72:75], v[184:187], v[48:63]
    buffer_load_dwordx4 v[228:231], v1, s[4:7], s80 offen offset:3072 sc1
    v_mfma_f32_32x32x16_bf16 v[64:79], a[76:79], v[184:187], v[64:79]
    v_mfma_f32_32x32x16_bf16 v[80:95], a[72:75], v[188:191], v[80:95]
    buffer_load_dwordx4 v[232:235], v10, s[4:7], s76 offen offset:0 sc1
    v_mfma_f32_32x32x16_bf16 v[96:111], a[76:79], v[188:191], v[96:111]
    buffer_load_dwordx4 v[236:239], v10, s[4:7], s80 offen offset:0 sc1
    v_mfma_f32_32x32x16_bf16 v[48:63], a[120:123], v[192:195], v[48:63]
    v_mfma_f32_32x32x16_bf16 v[64:79], a[124:127], v[192:195], v[64:79]
    buffer_load_dwordx4 v[240:243], v1, s[4:7], s77 offen offset:2048 sc1
    v_mfma_f32_32x32x16_bf16 v[80:95], a[120:123], v[196:199], v[80:95]
    buffer_load_dword v5, v3, s[4:7], s75 offen sc1
    buffer_load_dwordx4 v[244:247], v1, s[4:7], s81 offen offset:2048 sc1
    v_mfma_f32_32x32x16_bf16 v[96:111], a[124:127], v[196:199], v[96:111]
    v_mfma_f32_32x32x16_bf16 v[48:63], a[128:131], v[200:203], v[48:63]
    buffer_load_dwordx4 v[16:19], v1, s[4:7], s77 offen offset:3072 sc1
    v_mfma_f32_32x32x16_bf16 v[64:79], a[132:135], v[200:203], v[64:79]
    buffer_load_dwordx4 v[20:23], v1, s[4:7], s81 offen offset:3072 sc1
    v_mfma_f32_32x32x16_bf16 v[80:95], a[128:131], v[204:207], v[80:95]
    v_mfma_f32_32x32x16_bf16 v[96:111], a[132:135], v[204:207], v[96:111]
    buffer_load_dwordx4 v[24:27], v1, s[4:7], s78 offen offset:1024 sc1
    s_barrier
    v_mfma_f32_32x32x16_bf16 v[48:63], a[176:179], v[208:211], v[48:63]
    buffer_load_dwordx4 v[28:31], v1, s[4:7], s82 offen offset:1024 sc1
    v_mfma_f32_32x32x16_bf16 v[64:79], a[180:183], v[208:211], v[64:79]
    v_mfma_f32_32x32x16_bf16 v[80:95], a[176:179], v[212:215], v[80:95]
    buffer_load_dwordx4 v[32:35], v1, s[4:7], s78 offen offset:2048 sc1
    v_mfma_f32_32x32x16_bf16 v[96:111], a[180:183], v[212:215], v[96:111]
    buffer_load_dwordx4 v[36:39], v1, s[4:7], s82 offen offset:2048 sc1
    v_mfma_f32_32x32x16_bf16 v[48:63], a[184:187], v[216:219], v[48:63]
    v_mfma_f32_32x32x16_bf16 v[64:79], a[188:191], v[216:219], v[64:79]
    buffer_load_dwordx4 v[40:43], v1, s[4:7], s79 offen offset:0 sc1
    v_mfma_f32_32x32x16_bf16 v[80:95], a[184:187], v[220:223], v[80:95]
    buffer_load_dwordx4 v[44:47], v1, s[4:7], s83 offen offset:0 sc1
    v_mfma_f32_32x32x16_bf16 v[96:111], a[188:191], v[220:223], v[96:111]
    s_waitcnt vmcnt(13)
    v_mfma_f32_32x32x16_bf16 v[48:63], a[24:27], v[224:227], v[48:63]
    buffer_load_dwordx4 v[112:115], v1, s[4:7], s79 offen offset:1024 sc1
    v_mfma_f32_32x32x16_bf16 v[64:79], a[28:31], v[224:227], v[64:79]
    buffer_load_dwordx4 v[116:119], v1, s[4:7], s83 offen offset:1024 sc1
    v_mfma_f32_32x32x16_bf16 v[80:95], a[24:27], v[228:231], v[80:95]
    v_mfma_f32_32x32x16_bf16 v[96:111], a[28:31], v[228:231], v[96:111]
    s_waitcnt vmcnt(13)
    v_mfma_f32_32x32x16_bf16 v[48:63], a[32:35], v[232:235], v[48:63]
    v_mfma_f32_32x32x16_bf16 v[64:79], a[36:39], v[232:235], v[64:79]
    v_mfma_f32_32x32x16_bf16 v[80:95], a[32:35], v[236:239], v[80:95]
    v_mfma_f32_32x32x16_bf16 v[96:111], a[36:39], v[236:239], v[96:111]
    s_waitcnt vmcnt(10)
    v_mfma_f32_32x32x16_bf16 v[48:63], a[80:83], v[240:243], v[48:63]
    v_cmp_le_u32 vcc, 4, v5
    s_cmp_eq_u64 vcc, -1
    s_cbranch_scc0 F_e5s3
F_e5b3:
    buffer_load_dwordx4 v[120:123], v10, s[4:7], s76 offen offset:1024 sc1
    v_mfma_f32_32x32x16_bf16 v[64:79], a[84:87], v[240:243], v[64:79]
    buffer_load_dwordx4 v[124:127], v10, s[4:7], s80 offen offset:1024 sc1
    v_mfma_f32_32x32x16_bf16 v[80:95], a[80:83], v[244:247], v[80:95]
    v_mfma_f32_32x32x16_bf16 v[96:111], a[84:87], v[244:247], v[96:111]
    buffer_load_dwordx4 v[128:131], v10, s[4:7], s76 offen offset:2048 sc1
    s_waitcnt vmcnt(11)
    v_mfma_f32_32x32x16_bf16 v[48:63], a[88:91], v[16:19], v[48:63]
    buffer_load_dwordx4 v[132:135], v10, s[4:7], s80 offen offset:2048 sc1
    v_mfma_f32_32x32x16_bf16 v[64:79], a[92:95], v[16:19], v[64:79]
    v_mfma_f32_32x32x16_bf16 v[80:95], a[88:91], v[20:23], v[80:95]
    buffer_load_dwordx4 v[136:139], v10, s[4:7], s77 offen offset:0 sc1
    v_mfma_f32_32x32x16_bf16 v[96:111], a[92:95], v[20:23], v[96:111]
    buffer_load_dwordx4 v[140:143], v10, s[4:7], s81 offen offset:0 sc1
    s_waitcnt vmcnt(12)
    v_mfma_f32_32x32x16_bf16 v[64:79], a[140:143], v[24:27], v[64:79]
    buffer_load_dwordx4 v[144:147], v10, s[4:7], s77 offen offset:1024 sc1
    v_mfma_f32_32x32x16_bf16 v[80:95], a[136:139], v[28:31], v[80:95]
    buffer_load_dwordx4 v[148:151], v10, s[4:7], s81 offen offset:1024 sc1
    v_mfma_f32_32x32x16_bf16 v[96:111], a[140:143], v[28:31], v[96:111]
    s_waitcnt vmcnt(12)
    buffer_load_dwordx4 v[152:155], v1, s[4:7], s78 offen offset:3072 sc1
    v_mfma_f32_32x32x16_bf16 v[64:79], a[148:151], v[32:35], v[64:79]
    buffer_load_dwordx4 v[156:159], v1, s[4:7], s82 offen offset:3072 sc1
    v_mfma_f32_32x32x16_bf16 v[80:95], a[144:147], v[36:39], v[80:95]
    v_mfma_f32_32x32x16_bf16 v[96:111], a[148:151], v[36:39], v[96:111]
    buffer_load_dwordx4 v[160:163], v10, s[4:7], s78 offen offset:0 sc1
    buffer_load_dwordx4 v[248:251], v1, s[4:7], s42 offen sc1
    buffer_load_dwordx4 v[252:255], v1, s[4:7], s42 offen offset:1024 sc1
    s_waitcnt vmcnt(15)
    buffer_load_dwordx4 v[164:167], v10, s[4:7], s82 offen offset:0 sc1
    v_mfma_f32_32x32x16_bf16 v[64:79], a[196:199], v[40:43], v[64:79]
    v_mfma_f32_32x32x16_bf16 v[80:95], a[192:195], v[44:47], v[80:95]
    buffer_load_dwordx4 v[168:171], v1, s[4:7], s79 offen offset:2048 sc1
    v_mfma_f32_32x32x16_bf16 v[96:111], a[196:199], v[44:47], v[96:111]
    buffer_load_dwordx4 v[172:175], v1, s[4:7], s83 offen offset:2048 sc1
    s_waitcnt vmcnt(16)
    v_mfma_f32_32x32x16_bf16 v[64:79], a[204:207], v[112:115], v[64:79]
    buffer_load_dwordx4 v[176:179], v1, s[4:7], s79 offen offset:3072 sc1
    v_mfma_f32_32x32x16_bf16 v[80:95], a[200:203], v[116:119], v[80:95]
    buffer_load_dwordx4 v[180:183], v1, s[4:7], s83 offen offset:3072 sc1
    v_mfma_f32_32x32x16_bf16 v[96:111], a[204:207], v[116:119], v[96:111]
    s_waitcnt vmcnt(16)
    v_mfma_f32_32x32x16_bf16 v[64:79], a[44:47], v[120:123], v[64:79]
    v_mfma_f32_32x32x16_bf16 v[80:95], a[40:43], v[124:127], v[80:95]
    v_mfma_f32_32x32x16_bf16 v[96:111], a[44:47], v[124:127], v[96:111]
    s_waitcnt vmcnt(14)
    v_mfma_f32_32x32x16_bf16 v[64:79], a[52:55], v[128:131], v[64:79]
    v_mfma_f32_32x32x16_bf16 v[80:95], a[48:51], v[132:135], v[80:95]
    v_mfma_f32_32x32x16_bf16 v[96:111], a[52:55], v[132:135], v[96:111]
    s_waitcnt vmcnt(12)
    v_mfma_f32_32x32x16_bf16 v[64:79], a[100:103], v[136:139], v[64:79]
    v_mfma_f32_32x32x16_bf16 v[80:95], a[96:99], v[140:143], v[80:95]
    v_mfma_f32_32x32x16_bf16 v[96:111], a[100:103], v[140:143], v[96:111]
    s_waitcnt vmcnt(10)
    v_mfma_f32_32x32x16_bf16 v[64:79], a[108:111], v[144:147], v[64:79]
    v_mfma_f32_32x32x16_bf16 v[80:95], a[104:107], v[148:151], v[80:95]
    v_mfma_f32_32x32x16_bf16 v[96:111], a[108:111], v[148:151], v[96:111]
    s_waitcnt vmcnt(8)
    v_mfma_f32_32x32x16_bf16 v[64:79], a[156:159], v[152:155], v[64:79]
    v_mfma_f32_32x32x16_bf16 v[80:95], a[152:155], v[156:159], v[80:95]
    v_mfma_f32_32x32x16_bf16 v[96:111], a[156:159], v[156:159], v[96:111]
    s_waitcnt vmcnt(4)
    v_mfma_f32_32x32x16_bf16 v[64:79], a[164:167], v[160:163], v[64:79]
    v_mfma_f32_32x32x16_bf16 v[80:95], a[160:163], v[164:167], v[80:95]
    v_mfma_f32_32x32x16_bf16 v[96:111], a[164:167], v[164:167], v[96:111]
    s_waitcnt vmcnt(2)
    v_mfma_f32_32x32x16_bf16 v[64:79], a[212:215], v[168:171], v[64:79]
    v_mfma_f32_32x32x16_bf16 v[80:95], a[208:211], v[172:175], v[80:95]
    v_mfma_f32_32x32x16_bf16 v[96:111], a[212:215], v[172:175], v[96:111]
    s_waitcnt vmcnt(0)
    v_mfma_f32_32x32x16_bf16 v[64:79], a[220:223], v[176:179], v[64:79]
    v_mfma_f32_32x32x16_bf16 v[80:95], a[216:219], v[180:183], v[80:95]
    v_mfma_f32_32x32x16_bf16 v[96:111], a[220:223], v[180:183], v[96:111]
    v_mfma_f32_32x32x16_bf16 v[48:63], a[136:139], v[24:27], v[48:63]
    s_nop 8
    ds_write_b128 v13, v[64:67] offset:0
    v_mfma_f32_32x32x16_bf16 v[48:63], a[144:147], v[32:35], v[48:63]
    ds_write_b128 v13, v[68:71] offset:1024
    v_mfma_f32_32x32x16_bf16 v[48:63], a[192:195], v[40:43], v[48:63]
    ds_write_b128 v13, v[72:75] offset:2048
    v_mfma_f32_32x32x16_bf16 v[48:63], a[200:203], v[112:115], v[48:63]
    ds_write_b128 v13, v[76:79] offset:3072
    v_mfma_f32_32x32x16_bf16 v[48:63], a[40:43], v[120:123], v[48:63]
    ds_write_b128 v14, v[80:83] offset:4096
    v_mfma_f32_32x32x16_bf16 v[48:63], a[48:51], v[128:131], v[48:63]
    ds_write_b128 v14, v[84:87] offset:5120
    v_mfma_f32_32x32x16_bf16 v[48:63], a[96:99], v[136:139], v[48:63]
    ds_write_b128 v14, v[88:91] offset:6144
    v_mfma_f32_32x32x16_bf16 v[48:63], a[104:107], v[144:147], v[48:63]
    ds_write_b128 v14, v[92:95] offset:7168
    v_mfma_f32_32x32x16_bf16 v[48:63], a[152:155], v[152:155], v[48:63]
    ds_write_b128 v15, v[96:99] offset:8192
    v_mfma_f32_32x32x16_bf16 v[48:63], a[160:163], v[160:163], v[48:63]
    ds_write_b128 v15, v[100:103] offset:9216
    v_mfma_f32_32x32x16_bf16 v[48:63], a[208:211], v[168:171], v[48:63]
    ds_write_b128 v15, v[104:107] offset:10240
    v_mfma_f32_32x32x16_bf16 v[48:63], a[216:219], v[176:179], v[48:63]
    ds_write_b128 v15, v[108:111] offset:11264
    s_waitcnt lgkmcnt(0)
    s_barrier
    ds_read_b128 v[64:67], v12 offset:0
    ds_read_b128 v[68:71], v12 offset:1024
    ds_read_b128 v[72:75], v12 offset:2048
    ds_read_b128 v[76:79], v12 offset:3072
    ds_read_b128 v[80:83], v12 offset:4096
    ds_read_b128 v[84:87], v12 offset:5120
    ds_read_b128 v[88:91], v12 offset:6144
    ds_read_b128 v[92:95], v12 offset:7168
    ds_read_b128 v[96:99], v12 offset:8192
    ds_read_b128 v[100:103], v12 offset:9216
    ds_read_b128 v[104:107], v12 offset:10240
    ds_read_b128 v[108:111], v12 offset:11264
    v_lshlrev_b32 v16, 16, v248
    v_and_b32 v17, 0xffff0000, v248
    v_lshlrev_b32 v18, 16, v249
    v_and_b32 v19, 0xffff0000, v249
    v_lshlrev_b32 v20, 16, v250
    v_and_b32 v21, 0xffff0000, v250
    v_lshlrev_b32 v22, 16, v251
    v_and_b32 v23, 0xffff0000, v251
    v_lshlrev_b32 v24, 16, v252
    v_and_b32 v25, 0xffff0000, v252
    v_lshlrev_b32 v26, 16, v253
    v_and_b32 v27, 0xffff0000, v253
    v_lshlrev_b32 v28, 16, v254
    v_and_b32 v29, 0xffff0000, v254
    v_lshlrev_b32 v30, 16, v255
    v_and_b32 v31, 0xffff0000, v255
    v_add_f32 v48, v48, v16
    v_add_f32 v49, v49, v17
    v_add_f32 v50, v50, v18
    v_add_f32 v51, v51, v19
    v_add_f32 v52, v52, v20
    v_add_f32 v53, v53, v21
    v_add_f32 v54, v54, v22
    v_add_f32 v55, v55, v23
    v_add_f32 v56, v56, v24
    v_add_f32 v57, v57, v25
    v_add_f32 v58, v58, v26
    v_add_f32 v59, v59, v27
    v_add_f32 v60, v60, v28
    v_add_f32 v61, v61, v29
    v_add_f32 v62, v62, v30
    v_add_f32 v63, v63, v31
    s_waitcnt lgkmcnt(11)
    v_add_f32 v48, v48, v64
    v_add_f32 v49, v49, v65
    v_add_f32 v50, v50, v66
    v_add_f32 v51, v51, v67
    s_waitcnt lgkmcnt(10)
    v_add_f32 v52, v52, v68
    v_add_f32 v53, v53, v69
    v_add_f32 v54, v54, v70
    v_add_f32 v55, v55, v71
    s_waitcnt lgkmcnt(9)
    v_add_f32 v56, v56, v72
    v_add_f32 v57, v57, v73
    v_add_f32 v58, v58, v74
    v_add_f32 v59, v59, v75
    s_waitcnt lgkmcnt(8)
    v_add_f32 v60, v60, v76
    v_add_f32 v61, v61, v77
    v_add_f32 v62, v62, v78
    v_add_f32 v63, v63, v79
    s_waitcnt lgkmcnt(7)
    v_add_f32 v48, v48, v80
    v_add_f32 v49, v49, v81
    v_add_f32 v50, v50, v82
    v_add_f32 v51, v51, v83
    s_waitcnt lgkmcnt(6)
    v_add_f32 v52, v52, v84
    v_add_f32 v53, v53, v85
    v_add_f32 v54, v54, v86
    v_add_f32 v55, v55, v87
    s_waitcnt lgkmcnt(5)
    v_add_f32 v56, v56, v88
    v_add_f32 v57, v57, v89
    v_add_f32 v58, v58, v90
    v_add_f32 v59, v59, v91
    s_waitcnt lgkmcnt(4)
    v_add_f32 v60, v60, v92
    v_add_f32 v61, v61, v93
    v_add_f32 v62, v62, v94
    v_add_f32 v63, v63, v95
    s_waitcnt lgkmcnt(3)
    v_add_f32 v48, v48, v96
    v_add_f32 v49, v49, v97
    v_add_f32 v50, v50, v98
    v_add_f32 v51, v51, v99
    s_waitcnt lgkmcnt(2)
    v_add_f32 v52, v52, v100
    v_add_f32 v53, v53, v101
    v_add_f32 v54, v54, v102
    v_add_f32 v55, v55, v103
    s_waitcnt lgkmcnt(1)
    v_add_f32 v56, v56, v104
    v_add_f32 v57, v57, v105
    v_add_f32 v58, v58, v106
    v_add_f32 v59, v59, v107
    s_waitcnt lgkmcnt(0)
    v_add_f32 v60, v60, v108
    v_add_f32 v61, v61, v109
    v_add_f32 v62, v62, v110
    v_add_f32 v63, v63, v111
    v_cvt_pk_bf16_f32 v64, v48, v49
    v_cvt_pk_bf16_f32 v65, v50, v51
    v_cvt_pk_bf16_f32 v66, v52, v53
    v_cvt_pk_bf16_f32 v67, v54, v55
    v_cvt_pk_bf16_f32 v68, v56, v57
    v_cvt_pk_bf16_f32 v69, v58, v59
    v_cvt_pk_bf16_f32 v70, v60, v61
    v_cvt_pk_bf16_f32 v71, v62, v63
    v_permlane32_swap_b32 v64, v66
    v_permlane32_swap_b32 v65, v67
    v_permlane32_swap_b32 v68, v70
    v_permlane32_swap_b32 v69, v71
    buffer_store_dwordx4 v[64:67], v7, s[12:15], s37 offen
    buffer_store_dwordx4 v[68:71], v7, s[12:15], s37 offen offset:32
F_exit:
    s_endpgm
F_tailG:
    s_waitcnt vmcnt(0)
    s_barrier
    s_cmp_lg_u32 s3, 0
    s_cbranch_scc1 F_f2G
    v_mov_b32 v6, 0
    v_mov_b32 v7, 1
    s_mov_b64 exec, 1
    buffer_store_dword v7, v6, s[4:7], s47 offen sc1
    s_mov_b64 exec, -1
F_f2G:
F_p2G:
    buffer_load_dword v6, v3, s[4:7], s48 offen sc1
    s_waitcnt vmcnt(0)
    v_cmp_ne_u32 vcc, 0, v6
    s_cmp_eq_u64 vcc, -1
    s_cbranch_scc1 F_p2G_ok
    s_cmp_eq_u32 s30, 0
    s_cbranch_scc1 F_p2G_ok
    s_sub_u32 s30, s30, 1
    s_sleep 1
    s_branch F_p2G
F_p2G_ok:
    buffer_load_dwordx4 v[8:11], v1, s[4:7], s49 offen offset:0 sc1
    buffer_load_dwordx4 v[12:15], v1, s[4:7], s50 offen offset:0 sc1
    buffer_load_dwordx4 v[16:19], v1, s[4:7], s49 offen offset:1024 sc1
    buffer_load_dwordx4 v[20:23], v1, s[4:7], s50 offen offset:1024 sc1
    buffer_load_dwordx4 v[24:27], v1, s[4:7], s49 offen offset:2048 sc1
    buffer_load_dwordx4 v[28:31], v1, s[4:7], s50 offen offset:2048 sc1
    buffer_load_dwordx4 v[32:35], v1, s[4:7], s49 offen offset:3072 sc1
    buffer_load_dwordx4 v[36:39], v1, s[4:7], s50 offen offset:3072 sc1
    buffer_load_dwordx4 v[40:43], v224, s[4:7], s49 offen offset:0 sc1
    buffer_load_dwordx4 v[44:47], v224, s[4:7], s50 offen offset:0 sc1
    buffer_load_dwordx4 v[48:51], v224, s[4:7], s49 offen offset:1024 sc1
    buffer_load_dwordx4 v[52:55], v224, s[4:7], s50 offen offset:1024 sc1
    buffer_load_dwordx4 v[56:59], v224, s[4:7], s49 offen offset:2048 sc1
    buffer_load_dwordx4 v[60:63], v224, s[4:7], s50 offen offset:2048 sc1
    buffer_load_dwordx4 v[64:67], v224, s[4:7], s49 offen offset:3072 sc1
    buffer_load_dwordx4 v[68:71], v224, s[4:7], s50 offen offset:3072 sc1
    s_xor_b32 s31, s3, 1
    s_mul_i32 s31, s31, 12288
    s_add_u32 s31, s31, 114688
    v_add_u32 v137, s31, v1
    s_xor_b32 s31, s3, 2
    s_mul_i32 s31, s31, 12288
    s_add_u32 s31, s31, 114688
    v_add_u32 v138, s31, v1
    s_xor_b32 s31, s3, 3
    s_mul_i32 s31, s31, 12288
    s_add_u32 s31, s31, 114688
    v_add_u32 v139, s31, v1
    s_mul_i32 s31, s3, 12288
    s_add_u32 s31, s31, 114688
    v_add_u32 v136, s31, v1
    s_lshl_b32 s42, s40, 5
    s_lshl_b32 s43, s39, 1
    s_add_u32 s42, s42, s43
    s_lshl_b32 s42, s42, 10
    s_add_u32 s42, s42, 8388608
    v_permlane32_swap_b32 v216, v218
    v_permlane32_swap_b32 v217, v219
    v_permlane32_swap_b32 v220, v222
    v_permlane32_swap_b32 v221, v223
    s_waitcnt vmcnt(14)
    v_mfma_f32_32x32x16_bf16 v[72:87], v[152:155], v[8:11], 0
    buffer_load_dwordx4 a[168:171], v228, s[4:7], s34 offen offset:1024 sc1
    v_mfma_f32_32x32x16_bf16 v[88:103], v[156:159], v[8:11], 0
    buffer_load_dwordx4 a[172:175], v228, s[4:7], s35 offen offset:1024 sc1
    v_mfma_f32_32x32x16_bf16 v[104:119], v[152:155], v[12:15], 0
    v_mfma_f32_32x32x16_bf16 v[120:135], v[156:159], v[12:15], 0
    s_waitcnt vmcnt(14)
    v_mfma_f32_32x32x16_bf16 v[72:87], v[160:163], v[16:19], v[72:87]
    v_mfma_f32_32x32x16_bf16 v[88:103], v[164:167], v[16:19], v[88:103]
    v_mfma_f32_32x32x16_bf16 v[104:119], v[160:163], v[20:23], v[104:119]
    v_mfma_f32_32x32x16_bf16 v[120:135], v[164:167], v[20:23], v[120:135]
    s_waitcnt vmcnt(12)
    v_mfma_f32_32x32x16_bf16 v[72:87], v[168:171], v[24:27], v[72:87]
    v_mfma_f32_32x32x16_bf16 v[88:103], v[172:175], v[24:27], v[88:103]
    v_mfma_f32_32x32x16_bf16 v[104:119], v[168:171], v[28:31], v[104:119]
    v_mfma_f32_32x32x16_bf16 v[120:135], v[172:175], v[28:31], v[120:135]
    s_waitcnt vmcnt(10)
    v_mfma_f32_32x32x16_bf16 v[72:87], v[176:179], v[32:35], v[72:87]
    v_mfma_f32_32x32x16_bf16 v[88:103], v[180:183], v[32:35], v[88:103]
    v_mfma_f32_32x32x16_bf16 v[104:119], v[176:179], v[36:39], v[104:119]
    v_mfma_f32_32x32x16_bf16 v[120:135], v[180:183], v[36:39], v[120:135]
    s_waitcnt vmcnt(8)
    v_mfma_f32_32x32x16_bf16 v[72:87], v[184:187], v[40:43], v[72:87]
    v_mfma_f32_32x32x16_bf16 v[88:103], v[188:191], v[40:43], v[88:103]
    v_mfma_f32_32x32x16_bf16 v[104:119], v[184:187], v[44:47], v[104:119]
    v_mfma_f32_32x32x16_bf16 v[120:135], v[188:191], v[44:47], v[120:135]
    s_waitcnt vmcnt(6)
    v_mfma_f32_32x32x16_bf16 v[72:87], v[192:195], v[48:51], v[72:87]
    v_mfma_f32_32x32x16_bf16 v[88:103], v[196:199], v[48:51], v[88:103]
    v_mfma_f32_32x32x16_bf16 v[104:119], v[192:195], v[52:55], v[104:119]
    v_mfma_f32_32x32x16_bf16 v[120:135], v[196:199], v[52:55], v[120:135]
    s_waitcnt vmcnt(4)
    v_mfma_f32_32x32x16_bf16 v[72:87], v[200:203], v[56:59], v[72:87]
    v_mfma_f32_32x32x16_bf16 v[88:103], v[204:207], v[56:59], v[88:103]
    v_mfma_f32_32x32x16_bf16 v[104:119], v[200:203], v[60:63], v[104:119]
    v_mfma_f32_32x32x16_bf16 v[120:135], v[204:207], v[60:63], v[120:135]
    s_waitcnt vmcnt(2)
    v_mfma_f32_32x32x16_bf16 v[88:103], v[212:215], v[64:67], v[88:103]
    v_mfma_f32_32x32x16_bf16 v[104:119], v[208:211], v[68:71], v[104:119]
    v_mfma_f32_32x32x16_bf16 v[120:135], v[212:215], v[68:71], v[120:135]
    v_mfma_f32_32x32x16_bf16 v[72:87], v[208:211], v[64:67], v[72:87]
    s_nop 8
    ds_write_b128 v137, v[88:91] offset:0
    ds_write_b128 v137, v[92:95] offset:1024
    ds_write_b128 v137, v[96:99] offset:2048
    ds_write_b128 v137, v[100:103] offset:3072
    ds_write_b128 v138, v[104:107] offset:4096
    ds_write_b128 v138, v[108:111] offset:5120
    ds_write_b128 v138, v[112:115] offset:6144
    ds_write_b128 v138, v[116:119] offset:7168
    ds_write_b128 v139, v[120:123] offset:8192
    ds_write_b128 v139, v[124:127] offset:9216
    ds_write_b128 v139, v[128:131] offset:10240
    ds_write_b128 v139, v[132:135] offset:11264
    v_lshlrev_b32 v8, 16, v216
    v_and_b32 v9, 0xffff0000, v216
    v_lshlrev_b32 v10, 16, v217
    v_and_b32 v11, 0xffff0000, v217
    v_lshlrev_b32 v12, 16, v218
    v_and_b32 v13, 0xffff0000, v218
    v_lshlrev_b32 v14, 16, v219
    v_and_b32 v15, 0xffff0000, v219
    v_lshlrev_b32 v16, 16, v220
    v_and_b32 v17, 0xffff0000, v220
    v_lshlrev_b32 v18, 16, v221
    v_and_b32 v19, 0xffff0000, v221
    v_lshlrev_b32 v20, 16, v222
    v_and_b32 v21, 0xffff0000, v222
    v_lshlrev_b32 v22, 16, v223
    v_and_b32 v23, 0xffff0000, v223
    v_add_f32 v72, v72, v8
    v_add_f32 v73, v73, v9
    v_add_f32 v74, v74, v10
    v_add_f32 v75, v75, v11
    v_add_f32 v76, v76, v12
    v_add_f32 v77, v77, v13
    v_add_f32 v78, v78, v14
    v_add_f32 v79, v79, v15
    v_add_f32 v80, v80, v16
    v_add_f32 v81, v81, v17
    v_add_f32 v82, v82, v18
    v_add_f32 v83, v83, v19
    v_add_f32 v84, v84, v20
    v_add_f32 v85, v85, v21
    v_add_f32 v86, v86, v22
    v_add_f32 v87, v87, v23
    s_waitcnt lgkmcnt(0)
    s_barrier
    ds_read_b128 v[88:91], v136 offset:0
    ds_read_b128 v[92:95], v136 offset:1024
    ds_read_b128 v[96:99], v136 offset:2048
    ds_read_b128 v[100:103], v136 offset:3072
    ds_read_b128 v[104:107], v136 offset:4096
    ds_read_b128 v[108:111], v136 offset:5120
    ds_read_b128 v[112:115], v136 offset:6144
    ds_read_b128 v[116:119], v136 offset:7168
    ds_read_b128 v[120:123], v136 offset:8192
    ds_read_b128 v[124:127], v136 offset:9216
    ds_read_b128 v[128:131], v136 offset:10240
    ds_read_b128 v[132:135], v136 offset:11264
    s_waitcnt lgkmcnt(11)
    v_add_f32 v72, v72, v88
    v_add_f32 v73, v73, v89
    v_add_f32 v74, v74, v90
    v_add_f32 v75, v75, v91
    s_waitcnt lgkmcnt(10)
    v_add_f32 v76, v76, v92
    v_add_f32 v77, v77, v93
    v_add_f32 v78, v78, v94
    v_add_f32 v79, v79, v95
    s_waitcnt lgkmcnt(9)
    v_add_f32 v80, v80, v96
    v_add_f32 v81, v81, v97
    v_add_f32 v82, v82, v98
    v_add_f32 v83, v83, v99
    s_waitcnt lgkmcnt(8)
    v_add_f32 v84, v84, v100
    v_add_f32 v85, v85, v101
    v_add_f32 v86, v86, v102
    v_add_f32 v87, v87, v103
    s_waitcnt lgkmcnt(7)
    v_add_f32 v72, v72, v104
    v_add_f32 v73, v73, v105
    v_add_f32 v74, v74, v106
    v_add_f32 v75, v75, v107
    s_waitcnt lgkmcnt(6)
    v_add_f32 v76, v76, v108
    v_add_f32 v77, v77, v109
    v_add_f32 v78, v78, v110
    v_add_f32 v79, v79, v111
    s_waitcnt lgkmcnt(5)
    v_add_f32 v80, v80, v112
    v_add_f32 v81, v81, v113
    v_add_f32 v82, v82, v114
    v_add_f32 v83, v83, v115
    s_waitcnt lgkmcnt(4)
    v_add_f32 v84, v84, v116
    v_add_f32 v85, v85, v117
    v_add_f32 v86, v86, v118
    v_add_f32 v87, v87, v119
    s_waitcnt lgkmcnt(3)
    v_add_f32 v72, v72, v120
    v_add_f32 v73, v73, v121
    v_add_f32 v74, v74, v122
    v_add_f32 v75, v75, v123
    s_waitcnt lgkmcnt(2)
    v_add_f32 v76, v76, v124
    v_add_f32 v77, v77, v125
    v_add_f32 v78, v78, v126
    v_add_f32 v79, v79, v127
    s_waitcnt lgkmcnt(1)
    v_add_f32 v80, v80, v128
    v_add_f32 v81, v81, v129
    v_add_f32 v82, v82, v130
    v_add_f32 v83, v83, v131
    s_waitcnt lgkmcnt(0)
    v_add_f32 v84, v84, v132
    v_add_f32 v85, v85, v133
    v_add_f32 v86, v86, v134
    v_add_f32 v87, v87, v135
    v_cvt_pk_bf16_f32 v88, v72, v73
    v_cvt_pk_bf16_f32 v89, v74, v75
    v_cvt_pk_bf16_f32 v90, v76, v77
    v_cvt_pk_bf16_f32 v91, v78, v79
    v_cvt_pk_bf16_f32 v92, v80, v81
    v_cvt_pk_bf16_f32 v93, v82, v83
    v_cvt_pk_bf16_f32 v94, v84, v85
    v_cvt_pk_bf16_f32 v95, v86, v87
    buffer_store_dwordx4 v[88:91], v1, s[4:7], s42 offen sc1
    buffer_store_dwordx4 v[92:95], v1, s[4:7], s42 offen offset:1024 sc1
    v_add_f32 v8, v72, v73
    v_mul_f32 v9, v72, v72
    v_add_f32 v10, v74, v75
    v_mul_f32 v11, v73, v73
    v_fma_f32 v9, v74, v74, v9
    v_fma_f32 v11, v75, v75, v11
    v_fma_f32 v9, v76, v76, v9
    v_add_f32 v8, v8, v76
    v_fma_f32 v11, v77, v77, v11
    v_add_f32 v10, v10, v77
    v_fma_f32 v9, v78, v78, v9
    v_add_f32 v8, v8, v78
    v_fma_f32 v11, v79, v79, v11
    v_add_f32 v10, v10, v79
    v_fma_f32 v9, v80, v80, v9
    v_add_f32 v8, v8, v80
    v_fma_f32 v11, v81, v81, v11
    v_add_f32 v10, v10, v81
    v_fma_f32 v9, v82, v82, v9
    v_add_f32 v8, v8, v82
    v_fma_f32 v11, v83, v83, v11
    v_add_f32 v10, v10, v83
    v_fma_f32 v9, v84, v84, v9
    v_add_f32 v8, v8, v84
    v_fma_f32 v11, v85, v85, v11
    v_add_f32 v10, v10, v85
    v_fma_f32 v9, v86, v86, v9
    v_add_f32 v8, v8, v86
    v_fma_f32 v11, v87, v87, v11
    v_add_f32 v10, v10, v87
    v_add_f32 v8, v8, v10
    v_add_f32 v9, v9, v11
    v_and_b32 v5, 31, v2
    v_lshrrev_b32 v6, 5, v2
    v_lshlrev_b32 v12, 4, v5
    v_lshl_add_u32 v12, v6, 2, v12
    v_permlane32_swap_b32 v8, v9
    s_lshl_b32 s47, s40, 12
    s_and_b32 s48, s3, 1
    s_lshl3_add_u32 s47, s48, s47
    s_and_b32 s48, s61, 3
    s_lshl_b32 s48, s48, 10
    s_add_u32 s47, s47, s48
    s_lshr_b32 s48, s61, 2
    s_lshl_b32 s48, s48, 9
    s_add_u32 s47, s47, s48
    s_add_u32 s47, s47, 25165824
    v_add_f32 v8, v8, v9
    buffer_store_dword v8, v12, s[4:7], s47 offen sc1
    s_lshr_b32 s31, s60, 1
    s_mul_i32 s31, s31, 256
    s_and_b32 s43, s60, 1
    s_lshl_b32 s43, s43, 3
    s_add_u32 s43, s43, s61
    s_lshl_b32 s43, s43, 4
    s_add_u32 s31, s31, s43
    s_add_u32 s31, s31, 25698304
    s_lshl_b32 s47, s62, 2
    s_add_u32 s47, s47, s3
    s_lshl_b32 s48, s47, 15
    s_add_u32 s48, s48, 8388608
    s_lshl_b32 s49, s47, 12
    s_add_u32 s49, s49, 25165824
    s_mul_i32 s50, s47, 114688
    s_mul_i32 s43, s63, 7168
    s_add_u32 s50, s50, s43
    s_add_u32 s50, s50, 10485760
    s_mul_i32 s43, s62, 256
    s_lshr_b32 s51, s3, 1
    s_lshl_b32 s51, s51, 7
    s_add_u32 s43, s43, s51
    s_add_u32 s43, s43, 25698304
    v_add_u32 v10, 4096, v1
    v_add_u32 v11, 65536, v1
    v_add_u32 v14, 131072, v1
    v_mov_b32 v7, v239
    v_mov_b32 v8, v240
    v_mov_b32 v9, v241
    s_add_u32 s51, s45, 114688
    v_add_u32 v15, s51, v1
    s_waitcnt vmcnt(0)
    s_barrier
    s_cmp_lg_u32 s3, 0
    s_cbranch_scc1 F_f3G
    v_mov_b32 v4, 0
    v_mov_b32 v5, 1
    s_mov_b64 exec, 1
    buffer_store_dword v5, v4, s[4:7], s31 offen sc1
    s_mov_b64 exec, -1
F_f3G:
    ds_write_b128 v15, a[176:179] offset:0
    ds_write_b128 v15, a[180:183] offset:1024
    ds_write_b128 v15, a[184:187] offset:2048
    ds_write_b128 v15, a[188:191] offset:3072
    ds_write_b128 v15, a[192:195] offset:16384
    ds_write_b128 v15, a[196:199] offset:17408
    ds_write_b128 v15, a[200:203] offset:18432
    ds_write_b128 v15, a[204:207] offset:19456
    ds_write_b128 v15, a[208:211] offset:32768
    ds_write_b128 v15, a[212:215] offset:33792
    ds_write_b128 v15, a[216:219] offset:34816
    ds_write_b128 v15, a[220:223] offset:35840
F_p3G:
    buffer_load_dword v4, v3, s[4:7], s43 offen sc1
    s_waitcnt vmcnt(0)
    v_cmp_ne_u32 vcc, 0, v4
    s_cmp_eq_u64 vcc, -1
    s_cbranch_scc1 F_p3G_ok
    s_cmp_eq_u32 s30, 0
    s_cbranch_scc1 F_p3G_ok
    s_sub_u32 s30, s30, 1
    s_sleep 1
    s_branch F_p3G
F_p3G_ok:
    buffer_load_dwordx4 v[128:131], v1, s[4:7], s48 offen offset:0 sc1
    buffer_load_dwordx4 v[132:135], v1, s[4:7], s48 offen offset:1024 sc1
    buffer_load_dwordx4 v[136:139], v1, s[4:7], s48 offen offset:2048 sc1
    buffer_load_dwordx4 v[140:143], v1, s[4:7], s48 offen offset:3072 sc1
    buffer_load_dwordx4 v[144:147], v10, s[4:7], s48 offen offset:0 sc1
    s_mul_i32 s31, s62, 256
    s_lshl_b32 s43, s63, 4
    s_add_u32 s31, s31, s43
    s_lshl2_add_u32 s31, s3, s31
    s_add_u32 s74, s31, 25702400
    s_lshr_b32 s43, s60, 1
    s_mul_i32 s43, s43, 256
    s_lshl_b32 s31, s3, 6
    s_add_u32 s43, s43, s31
    s_and_b32 s31, s60, 1
    s_lshl3_add_u32 s43, s31, s43
    s_add_u32 s75, s43, 25702400
    s_mul_i32 s31, s3, 28672
    s_add_u32 s31, s31, 10485760
    s_mul_i32 s76, s40, 114688
    s_add_u32 s76, s76, s31
    s_xor_b32 s43, s40, 1
    s_mul_i32 s80, s43, 114688
    s_add_u32 s80, s80, s31
    v_and_b32 v3, 3, v2
    v_lshlrev_b32 v3, 4, v3
    v_bfe_u32 v4, v2, 2, 1
    v_lshl_add_u32 v3, v4, 2, v3
    v_and_b32 v5, 31, v2
    v_lshlrev_b32 v7, 10, v5
    v_lshl_add_u32 v7, v6, 4, v7
    s_add_u32 s77, s76, 8192
    s_add_u32 s78, s76, 16384
    s_add_u32 s79, s76, 24576
    s_add_u32 s81, s80, 8192
    s_add_u32 s82, s80, 16384
    s_add_u32 s83, s80, 24576
    ds_read_b128 v[96:99], v1 offset:0
    ds_read_b128 v[100:103], v1 offset:1024
    ds_read_b128 v[104:107], v1 offset:2048
    ds_read_b128 v[108:111], v1 offset:3072
    ds_read_b128 v[112:115], v1 offset:4096
    s_waitcnt vmcnt(4)
    s_waitcnt lgkmcnt(3)
    v_mfma_f32_32x32x16_bf16 v[16:31], v[96:99], v[128:131], 0
    ds_read_b128 v[116:119], v1 offset:5120
    buffer_load_dwordx4 v[148:151], v10, s[4:7], s48 offen offset:1024 sc1
    v_mfma_f32_32x32x16_bf16 v[32:47], v[100:103], v[128:131], 0
    ds_read_b128 v[96:99], v1 offset:6144
    s_waitcnt lgkmcnt(3)
    v_mfma_f32_32x32x16_bf16 v[48:63], v[104:107], v[128:131], 0
    ds_read_b128 v[100:103], v1 offset:7168
    v_mfma_f32_32x32x16_bf16 v[64:79], v[108:111], v[128:131], 0
    ds_read_b128 v[104:107], v1 offset:8192
    buffer_load_dwordx4 v[152:155], v10, s[4:7], s48 offen offset:2048 sc1
    s_waitcnt vmcnt(5)
    s_waitcnt lgkmcnt(3)
    v_mfma_f32_32x32x16_bf16 v[16:31], v[112:115], v[132:135], v[16:31]
    ds_read_b128 v[108:111], v1 offset:9216
    v_mfma_f32_32x32x16_bf16 v[32:47], v[116:119], v[132:135], v[32:47]
    ds_read_b128 v[112:115], v1 offset:10240
    s_waitcnt lgkmcnt(3)
    v_mfma_f32_32x32x16_bf16 v[48:63], v[96:99], v[132:135], v[48:63]
    ds_read_b128 v[116:119], v1 offset:11264
    buffer_load_dwordx4 v[156:159], v10, s[4:7], s48 offen offset:3072 sc1
    s_add_u32 s48, s48, 8192
    v_mfma_f32_32x32x16_bf16 v[64:79], v[100:103], v[132:135], v[64:79]
    ds_read_b128 v[96:99], v1 offset:12288
    s_waitcnt vmcnt(5)
    s_waitcnt lgkmcnt(3)
    v_mfma_f32_32x32x16_bf16 v[16:31], v[104:107], v[136:139], v[16:31]
    ds_read_b128 v[100:103], v1 offset:13312
    v_mfma_f32_32x32x16_bf16 v[32:47], v[108:111], v[136:139], v[32:47]
    ds_read_b128 v[104:107], v1 offset:14336
    buffer_load_dwordx4 v[160:163], v1, s[4:7], s48 offen offset:0 sc1
    s_waitcnt lgkmcnt(3)
    v_mfma_f32_32x32x16_bf16 v[48:63], v[112:115], v[136:139], v[48:63]
    ds_read_b128 v[108:111], v1 offset:15360
    v_mfma_f32_32x32x16_bf16 v[64:79], v[116:119], v[136:139], v[64:79]
    ds_read_b128 v[112:115], v1 offset:16384
    s_waitcnt vmcnt(5)
    s_waitcnt lgkmcnt(3)
    v_mfma_f32_32x32x16_bf16 v[16:31], v[96:99], v[140:143], v[16:31]
    ds_read_b128 v[116:119], v1 offset:17408
    buffer_load_dwordx4 v[164:167], v1, s[4:7], s48 offen offset:1024 sc1
    v_mfma_f32_32x32x16_bf16 v[32:47], v[100:103], v[140:143], v[32:47]
    ds_read_b128 v[96:99], v1 offset:18432
    s_waitcnt lgkmcnt(3)
    v_mfma_f32_32x32x16_bf16 v[48:63], v[104:107], v[140:143], v[48:63]
    ds_read_b128 v[100:103], v1 offset:19456
    v_mfma_f32_32x32x16_bf16 v[64:79], v[108:111], v[140:143], v[64:79]
    ds_read_b128 v[104:107], v1 offset:20480
    buffer_load_dwordx4 v[168:171], v1, s[4:7], s48 offen offset:2048 sc1
    s_waitcnt vmcnt(6)
    s_waitcnt lgkmcnt(3)
    v_mfma_f32_32x32x16_bf16 v[16:31], v[112:115], v[144:147], v[16:31]
    ds_read_b128 v[108:111], v1 offset:21504
    v_mfma_f32_32x32x16_bf16 v[32:47], v[116:119], v[144:147], v[32:47]
    ds_read_b128 v[112:115], v1 offset:22528
    s_waitcnt lgkmcnt(3)
    v_mfma_f32_32x32x16_bf16 v[48:63], v[96:99], v[144:147], v[48:63]
    ds_read_b128 v[116:119], v1 offset:23552
    buffer_load_dwordx4 v[172:175], v1, s[4:7], s48 offen offset:3072 sc1
    v_mfma_f32_32x32x16_bf16 v[64:79], v[100:103], v[144:147], v[64:79]
    ds_read_b128 v[96:99], v1 offset:24576
    s_waitcnt vmcnt(6)
    s_waitcnt lgkmcnt(3)
    v_mfma_f32_32x32x16_bf16 v[16:31], v[104:107], v[148:151], v[16:31]
    ds_read_b128 v[100:103], v1 offset:25600
    v_mfma_f32_32x32x16_bf16 v[32:47], v[108:111], v[148:151], v[32:47]
    ds_read_b128 v[104:107], v1 offset:26624
    buffer_load_dwordx4 v[176:179], v10, s[4:7], s48 offen offset:0 sc1
    s_waitcnt lgkmcnt(3)
    v_mfma_f32_32x32x16_bf16 v[48:63], v[112:115], v[148:151], v[48:63]
    ds_read_b128 v[108:111], v1 offset:27648
    v_mfma_f32_32x32x16_bf16 v[64:79], v[116:119], v[148:151], v[64:79]
    ds_read_b128 v[112:115], v1 offset:28672
    s_waitcnt vmcnt(6)
    s_waitcnt lgkmcnt(3)
    v_mfma_f32_32x32x16_bf16 v[16:31], v[96:99], v[152:155], v[16:31]
    ds_read_b128 v[116:119], v1 offset:29696
    buffer_load_dwordx4 v[180:183], v10, s[4:7], s48 offen offset:1024 sc1
    v_mfma_f32_32x32x16_bf16 v[32:47], v[100:103], v[152:155], v[32:47]
    ds_read_b128 v[96:99], v1 offset:30720
    s_waitcnt lgkmcnt(3)
    v_mfma_f32_32x32x16_bf16 v[48:63], v[104:107], v[152:155], v[48:63]
    ds_read_b128 v[100:103], v1 offset:31744
    v_mfma_f32_32x32x16_bf16 v[64:79], v[108:111], v[152:155], v[64:79]
    ds_read_b128 v[104:107], v1 offset:32768
    buffer_load_dwordx4 v[184:187], v10, s[4:7], s48 offen offset:2048 sc1
    s_waitcnt vmcnt(7)
    s_waitcnt lgkmcnt(3)
    v_mfma_f32_32x32x16_bf16 v[16:31], v[112:115], v[156:159], v[16:31]
    ds_read_b128 v[108:111], v1 offset:33792
    v_mfma_f32_32x32x16_bf16 v[32:47], v[116:119], v[156:159], v[32:47]
    ds_read_b128 v[112:115], v1 offset:34816
    s_waitcnt lgkmcnt(3)
    v_mfma_f32_32x32x16_bf16 v[48:63], v[96:99], v[156:159], v[48:63]
    ds_read_b128 v[116:119], v1 offset:35840
    buffer_load_dwordx4 v[188:191], v10, s[4:7], s48 offen offset:3072 sc1
    v_mfma_f32_32x32x16_bf16 v[64:79], v[100:103], v[156:159], v[64:79]
    ds_read_b128 v[96:99], v1 offset:36864
    s_waitcnt vmcnt(7)
    s_waitcnt lgkmcnt(3)
    v_mfma_f32_32x32x16_bf16 v[16:31], v[104:107], v[160:163], v[16:31]
    ds_read_b128 v[100:103], v1 offset:37888
    v_mfma_f32_32x32x16_bf16 v[32:47], v[108:111], v[160:163], v[32:47]
    ds_read_b128 v[104:107], v1 offset:38912
    buffer_load_dwordx4 v[80:83], v1, s[4:7], s49 offen offset:0 sc1
    s_waitcnt lgkmcnt(3)
    v_mfma_f32_32x32x16_bf16 v[48:63], v[112:115], v[160:163], v[48:63]
    ds_read_b128 v[108:111], v1 offset:39936
    v_mfma_f32_32x32x16_bf16 v[64:79], v[116:119], v[160:163], v[64:79]
    ds_read_b128 v[112:115], v1 offset:40960
    s_waitcnt vmcnt(7)
    s_waitcnt lgkmcnt(3)
    v_mfma_f32_32x32x16_bf16 v[16:31], v[96:99], v[164:167], v[16:31]
    ds_read_b128 v[116:119], v1 offset:41984
    buffer_load_dwordx4 v[84:87], v1, s[4:7], s49 offen offset:1024 sc1
    v_mfma_f32_32x32x16_bf16 v[32:47], v[100:103], v[164:167], v[32:47]
    ds_read_b128 v[96:99], v1 offset:43008
    s_waitcnt lgkmcnt(3)
    v_mfma_f32_32x32x16_bf16 v[48:63], v[104:107], v[164:167], v[48:63]
    ds_read_b128 v[100:103], v1 offset:44032
    v_mfma_f32_32x32x16_bf16 v[64:79], v[108:111], v[164:167], v[64:79]
    ds_read_b128 v[104:107], v1 offset:45056
    buffer_load_dwordx4 v[88:91], v1, s[4:7], s49 offen offset:2048 sc1
    s_waitcnt vmcnt(8)
    s_waitcnt lgkmcnt(3)
    v_mfma_f32_32x32x16_bf16 v[16:31], v[112:115], v[168:171], v[16:31]
    ds_read_b128 v[108:111], v1 offset:46080
    v_mfma_f32_32x32x16_bf16 v[32:47], v[116:119], v[168:171], v[32:47]
    ds_read_b128 v[112:115], v1 offset:47104
    s_waitcnt lgkmcnt(3)
    v_mfma_f32_32x32x16_bf16 v[48:63], v[96:99], v[168:171], v[48:63]
    ds_read_b128 v[116:119], v1 offset:48128
    buffer_load_dwordx4 v[92:95], v1, s[4:7], s49 offen offset:3072 sc1
    s_add_u32 s48, s48, 8192
    v_mfma_f32_32x32x16_bf16 v[64:79], v[100:103], v[168:171], v[64:79]
    ds_read_b128 v[96:99], v1 offset:49152
    s_waitcnt vmcnt(8)
    s_waitcnt lgkmcnt(3)
    v_mfma_f32_32x32x16_bf16 v[16:31], v[104:107], v[172:175], v[16:31]
    ds_read_b128 v[100:103], v1 offset:50176
    v_mfma_f32_32x32x16_bf16 v[32:47], v[108:111], v[172:175], v[32:47]
    ds_read_b128 v[104:107], v1 offset:51200
    buffer_load_dwordx4 v[192:195], v1, s[4:7], s48 offen offset:0 sc1
    s_waitcnt lgkmcnt(3)
    v_mfma_f32_32x32x16_bf16 v[48:63], v[112:115], v[172:175], v[48:63]
    ds_read_b128 v[108:111], v1 offset:52224
    v_mfma_f32_32x32x16_bf16 v[64:79], v[116:119], v[172:175], v[64:79]
    ds_read_b128 v[112:115], v1 offset:53248
    s_waitcnt vmcnt(8)
    s_waitcnt lgkmcnt(3)
    v_mfma_f32_32x32x16_bf16 v[16:31], v[96:99], v[176:179], v[16:31]
    ds_read_b128 v[116:119], v1 offset:54272
    buffer_load_dwordx4 v[196:199], v1, s[4:7], s48 offen offset:1024 sc1
    v_mfma_f32_32x32x16_bf16 v[32:47], v[100:103], v[176:179], v[32:47]
    ds_read_b128 v[96:99], v1 offset:55296
    s_waitcnt lgkmcnt(3)
    v_mfma_f32_32x32x16_bf16 v[48:63], v[104:107], v[176:179], v[48:63]
    ds_read_b128 v[100:103], v1 offset:56320
    v_mfma_f32_32x32x16_bf16 v[64:79], v[108:111], v[176:179], v[64:79]
    ds_read_b128 v[104:107], v1 offset:57344
    buffer_load_dwordx4 v[200:203], v1, s[4:7], s48 offen offset:2048 sc1
    s_waitcnt vmcnt(9)
    s_waitcnt lgkmcnt(3)
    v_mfma_f32_32x32x16_bf16 v[16:31], v[112:115], v[180:183], v[16:31]
    ds_read_b128 v[108:111], v1 offset:58368
    v_mfma_f32_32x32x16_bf16 v[32:47], v[116:119], v[180:183], v[32:47]
    ds_read_b128 v[112:115], v1 offset:59392
    s_waitcnt lgkmcnt(3)
    v_mfma_f32_32x32x16_bf16 v[48:63], v[96:99], v[180:183], v[48:63]
    ds_read_b128 v[116:119], v1 offset:60416
    buffer_load_dwordx4 v[204:207], v1, s[4:7], s48 offen offset:3072 sc1
    v_mfma_f32_32x32x16_bf16 v[64:79], v[100:103], v[180:183], v[64:79]
    ds_read_b128 v[96:99], v1 offset:61440
    s_waitcnt vmcnt(9)
    s_waitcnt lgkmcnt(3)
    v_mfma_f32_32x32x16_bf16 v[16:31], v[104:107], v[184:187], v[16:31]
    ds_read_b128 v[100:103], v1 offset:62464
    v_mfma_f32_32x32x16_bf16 v[32:47], v[108:111], v[184:187], v[32:47]
    ds_read_b128 v[104:107], v1 offset:63488
    buffer_load_dwordx4 v[208:211], v10, s[4:7], s48 offen offset:0 sc1
    s_waitcnt lgkmcnt(3)
    v_mfma_f32_32x32x16_bf16 v[48:63], v[112:115], v[184:187], v[48:63]
    ds_read_b128 v[108:111], v1 offset:64512
    v_mfma_f32_32x32x16_bf16 v[64:79], v[116:119], v[184:187], v[64:79]
    ds_read_b128 v[112:115], v11 offset:0
    s_waitcnt vmcnt(9)
    s_waitcnt lgkmcnt(3)
    v_mfma_f32_32x32x16_bf16 v[16:31], v[96:99], v[188:191], v[16:31]
    ds_read_b128 v[116:119], v11 offset:1024
    buffer_load_dwordx4 v[212:215], v10, s[4:7], s48 offen offset:1024 sc1
    v_mfma_f32_32x32x16_bf16 v[32:47], v[100:103], v[188:191], v[32:47]
    ds_read_b128 v[96:99], v11 offset:2048
    s_waitcnt lgkmcnt(3)
    v_mfma_f32_32x32x16_bf16 v[48:63], v[104:107], v[188:191], v[48:63]
    ds_read_b128 v[100:103], v11 offset:4096
    v_mfma_f32_32x32x16_bf16 v[64:79], v[108:111], v[188:191], v[64:79]
    ds_read_b128 v[104:107], v11 offset:5120
    buffer_load_dwordx4 v[216:219], v10, s[4:7], s48 offen offset:2048 sc1
    s_waitcnt vmcnt(6)
    s_waitcnt lgkmcnt(3)
    v_mfma_f32_32x32x16_bf16 v[16:31], v[112:115], v[192:195], v[16:31]
    ds_read_b128 v[108:111], v11 offset:6144
    v_mfma_f32_32x32x16_bf16 v[32:47], v[116:119], v[192:195], v[32:47]
    ds_read_b128 v[112:115], v11 offset:8192
    s_waitcnt lgkmcnt(3)
    v_mfma_f32_32x32x16_bf16 v[48:63], v[96:99], v[192:195], v[48:63]
    ds_read_b128 v[116:119], v11 offset:9216
    buffer_load_dwordx4 v[220:223], v10, s[4:7], s48 offen offset:3072 sc1
    s_add_u32 s48, s48, 8192
    s_waitcnt vmcnt(6)
    v_mfma_f32_32x32x16_bf16 v[16:31], v[100:103], v[196:199], v[16:31]
    ds_read_b128 v[96:99], v11 offset:10240
    s_waitcnt lgkmcnt(3)
    v_mfma_f32_32x32x16_bf16 v[32:47], v[104:107], v[196:199], v[32:47]
    ds_read_b128 v[100:103], v11 offset:12288
    v_mfma_f32_32x32x16_bf16 v[48:63], v[108:111], v[196:199], v[48:63]
    ds_read_b128 v[104:107], v11 offset:13312
    buffer_load_dwordx4 v[224:227], v1, s[4:7], s48 offen offset:0 sc1
    s_waitcnt vmcnt(6)
    s_waitcnt lgkmcnt(3)
    v_mfma_f32_32x32x16_bf16 v[16:31], v[112:115], v[200:203], v[16:31]
    ds_read_b128 v[108:111], v11 offset:14336
    v_mfma_f32_32x32x16_bf16 v[32:47], v[116:119], v[200:203], v[32:47]
    ds_read_b128 v[112:115], v11 offset:16384
    s_waitcnt lgkmcnt(3)
    v_mfma_f32_32x32x16_bf16 v[48:63], v[96:99], v[200:203], v[48:63]
    ds_read_b128 v[116:119], v11 offset:17408
    buffer_load_dwordx4 v[228:231], v1, s[4:7], s48 offen offset:1024 sc1
    v_add_f32 v80, v80, v88
    v_add_f32 v82, v82, v90
    v_add_f32 v84, v84, v92
    v_add_f32 v86, v86, v94
    v_add_f32 v81, v81, v89
    s_waitcnt vmcnt(6)
    v_mfma_f32_32x32x16_bf16 v[16:31], v[100:103], v[204:207], v[16:31]
    ds_read_b128 v[96:99], v11 offset:18432
    v_add_f32 v83, v83, v91
    v_add_f32 v85, v85, v93
    v_add_f32 v87, v87, v95
    v_add_f32 v80, v80, v84
    v_add_f32 v81, v81, v85
    s_waitcnt lgkmcnt(3)
    v_mfma_f32_32x32x16_bf16 v[32:47], v[104:107], v[204:207], v[32:47]
    ds_read_b128 v[100:103], v11 offset:20480
    v_add_f32 v82, v82, v86
    v_add_f32 v83, v83, v87
    v_add_f32 v80, v80, v82
    v_add_f32 v81, v81, v83
    v_mov_b32 v82, v80
    v_mfma_f32_32x32x16_bf16 v[48:63], v[108:111], v[204:207], v[48:63]
    ds_read_b128 v[104:107], v11 offset:21504
    buffer_load_dwordx4 v[232:235], v1, s[4:7], s48 offen offset:2048 sc1
    v_mov_b32 v83, v81
    v_permlane32_swap_b32 v82, v80
    s_nop 0
    v_permlane32_swap_b32 v83, v81
    s_waitcnt vmcnt(6)
    s_waitcnt lgkmcnt(3)
    v_mfma_f32_32x32x16_bf16 v[16:31], v[112:115], v[208:211], v[16:31]
    ds_read_b128 v[108:111], v11 offset:22528
    v_add_f32 v80, v80, v82
    v_add_f32 v81, v81, v83
    v_mul_f32 v80, 0.001953125, v80
    v_mul_f32 v81, 0.001953125, v81
    v_fma_f32 v81, -v80, v80, v81
    v_mfma_f32_32x32x16_bf16 v[32:47], v[116:119], v[208:211], v[32:47]
    ds_read_b128 v[112:115], v11 offset:24576
    v_max_f32 v81, 0, v81
    v_add_f32 v125, 0x3727c5ac, v81
    v_rsq_f32 v124, v125
    v_sub_f32 v80, 0, v80
    s_waitcnt lgkmcnt(3)
    v_mfma_f32_32x32x16_bf16 v[48:63], v[96:99], v[208:211], v[48:63]
    ds_read_b128 v[116:119], v11 offset:25600
    buffer_load_dwordx4 v[236:239], v1, s[4:7], s48 offen offset:3072 sc1
    v_mul_f32 v124, -1.4426950408889634, v124
    v_cvt_pk_bf16_f32 v84, v80, v80
    v_and_b32 v84, 0xffff0000, v84
    v_sub_f32 v85, v80, v84
    v_cvt_pk_bf16_f32 v120, v84, v85
    s_waitcnt vmcnt(6)
    v_mfma_f32_32x32x16_bf16 v[16:31], v[100:103], v[212:215], v[16:31]
    ds_read_b128 v[96:99], v11 offset:26624
    v_mov_b32 v121, v120
    v_mov_b32 v122, v120
    v_mov_b32 v123, v120
    s_waitcnt lgkmcnt(3)
    v_mfma_f32_32x32x16_bf16 v[32:47], v[104:107], v[212:215], v[32:47]
    ds_read_b128 v[100:103], v11 offset:28672
    v_mfma_f32_32x32x16_bf16 v[48:63], v[108:111], v[212:215], v[48:63]
    ds_read_b128 v[104:107], v11 offset:29696
    buffer_load_dwordx4 v[240:243], v10, s[4:7], s48 offen offset:0 sc1
    s_waitcnt vmcnt(6)
    s_waitcnt lgkmcnt(3)
    v_mfma_f32_32x32x16_bf16 v[16:31], v[112:115], v[216:219], v[16:31]
    ds_read_b128 v[108:111], v11 offset:30720
    v_mfma_f32_32x32x16_bf16 v[32:47], v[116:119], v[216:219], v[32:47]
    ds_read_b128 v[112:115], v11 offset:32768
    s_waitcnt lgkmcnt(3)
    v_mfma_f32_32x32x16_bf16 v[48:63], v[96:99], v[216:219], v[48:63]
    ds_read_b128 v[116:119], v11 offset:33792
    buffer_load_dwordx4 v[244:247], v10, s[4:7], s48 offen offset:1024 sc1
    s_waitcnt vmcnt(6)
    v_mfma_f32_32x32x16_bf16 v[16:31], v[100:103], v[220:223], v[16:31]
    ds_read_b128 v[96:99], v11 offset:34816
    s_waitcnt lgkmcnt(3)
    v_mfma_f32_32x32x16_bf16 v[32:47], v[104:107], v[220:223], v[32:47]
    ds_read_b128 v[100:103], v11 offset:36864
    v_mfma_f32_32x32x16_bf16 v[48:63], v[108:111], v[220:223], v[48:63]
    ds_read_b128 v[104:107], v11 offset:37888
    buffer_load_dwordx4 v[248:251], v10, s[4:7], s48 offen offset:2048 sc1
    s_waitcnt vmcnt(6)
    s_waitcnt lgkmcnt(3)
    v_mfma_f32_32x32x16_bf16 v[16:31], v[112:115], v[224:227], v[16:31]
    ds_read_b128 v[108:111], v11 offset:38912
    v_mfma_f32_32x32x16_bf16 v[32:47], v[116:119], v[224:227], v[32:47]
    ds_read_b128 v[112:115], v11 offset:40960
    s_waitcnt lgkmcnt(3)
    v_mfma_f32_32x32x16_bf16 v[48:63], v[96:99], v[224:227], v[48:63]
    ds_read_b128 v[116:119], v11 offset:41984
    buffer_load_dwordx4 v[252:255], v10, s[4:7], s48 offen offset:3072 sc1
    s_waitcnt vmcnt(6)
    v_mfma_f32_32x32x16_bf16 v[16:31], v[100:103], v[228:231], v[16:31]
    ds_read_b128 v[96:99], v11 offset:43008
    s_waitcnt lgkmcnt(3)
    v_mfma_f32_32x32x16_bf16 v[32:47], v[104:107], v[228:231], v[32:47]
    ds_read_b128 v[100:103], v11 offset:45056
    s_barrier
    v_mfma_f32_32x32x16_bf16 v[48:63], v[108:111], v[228:231], v[48:63]
    ds_read_b128 v[104:107], v11 offset:46080
    s_add_u32 m0, s45, 0
    s_add_u32 s51, s46, 163840
    buffer_load_dwordx4 v1, s[4:7], s51 offen offset:0 sc1 lds
    s_waitcnt vmcnt(6)
    s_waitcnt lgkmcnt(3)
    v_mfma_f32_32x32x16_bf16 v[16:31], v[112:115], v[232:235], v[16:31]
    ds_read_b128 v[108:111], v11 offset:47104
    v_mfma_f32_32x32x16_bf16 v[32:47], v[116:119], v[232:235], v[32:47]
    ds_read_b128 v[112:115], v11 offset:49152
    s_waitcnt lgkmcnt(3)
    v_mfma_f32_32x32x16_bf16 v[48:63], v[96:99], v[232:235], v[48:63]
    ds_read_b128 v[116:119], v11 offset:50176
    buffer_load_dwordx4 v1, s[4:7], s51 offen offset:1024 sc1 lds
    s_waitcnt vmcnt(6)
    v_mfma_f32_32x32x16_bf16 v[16:31], v[100:103], v[236:239], v[16:31]
    ds_read_b128 v[96:99], v11 offset:51200
    s_waitcnt lgkmcnt(3)
    v_mfma_f32_32x32x16_bf16 v[32:47], v[104:107], v[236:239], v[32:47]
    ds_read_b128 v[100:103], v11 offset:53248
    v_mfma_f32_32x32x16_bf16 v[48:63], v[108:111], v[236:239], v[48:63]
    ds_read_b128 v[104:107], v11 offset:54272
    buffer_load_dwordx4 v1, s[4:7], s51 offen offset:2048 sc1 lds
    s_waitcnt vmcnt(6)
    s_waitcnt lgkmcnt(3)
    v_mfma_f32_32x32x16_bf16 v[16:31], v[112:115], v[240:243], v[16:31]
    ds_read_b128 v[108:111], v11 offset:55296
    v_mfma_f32_32x32x16_bf16 v[32:47], v[116:119], v[240:243], v[32:47]
    ds_read_b128 v[112:115], v11 offset:57344
    s_waitcnt lgkmcnt(3)
    v_mfma_f32_32x32x16_bf16 v[48:63], v[96:99], v[240:243], v[48:63]
    ds_read_b128 v[116:119], v11 offset:58368
    buffer_load_dwordx4 v1, s[4:7], s51 offen offset:3072 sc1 lds
    s_add_u32 m0, s45, 16384
    s_add_u32 s51, s46, 180224
    s_waitcnt vmcnt(6)
    v_mfma_f32_32x32x16_bf16 v[16:31], v[100:103], v[244:247], v[16:31]
    ds_read_b128 v[96:99], v11 offset:59392
    s_waitcnt lgkmcnt(3)
    v_mfma_f32_32x32x16_bf16 v[32:47], v[104:107], v[244:247], v[32:47]
    ds_read_b128 v[100:103], v11 offset:61440
    v_mfma_f32_32x32x16_bf16 v[48:63], v[108:111], v[244:247], v[48:63]
    ds_read_b128 v[104:107], v11 offset:62464
    buffer_load_dwordx4 v1, s[4:7], s51 offen offset:0 sc1 lds
    s_waitcnt vmcnt(6)
    s_waitcnt lgkmcnt(3)
    v_mfma_f32_32x32x16_bf16 v[16:31], v[112:115], v[248:251], v[16:31]
    ds_read_b128 v[108:111], v11 offset:63488
    v_mfma_f32_32x32x16_bf16 v[32:47], v[116:119], v[248:251], v[32:47]
    ds_read_b128 v[112:115], v11 offset:3072
    s_waitcnt lgkmcnt(3)
    v_mfma_f32_32x32x16_bf16 v[48:63], v[96:99], v[248:251], v[48:63]
    ds_read_b128 v[116:119], v14 offset:0
    buffer_load_dwordx4 v1, s[4:7], s51 offen offset:1024 sc1 lds
    s_waitcnt vmcnt(6)
    v_mfma_f32_32x32x16_bf16 v[16:31], v[100:103], v[252:255], v[16:31]
    ds_read_b128 v[96:99], v11 offset:7168
    s_waitcnt lgkmcnt(3)
    v_mfma_f32_32x32x16_bf16 v[32:47], v[104:107], v[252:255], v[32:47]
    ds_read_b128 v[100:103], v14 offset:1024
    v_mfma_f32_32x32x16_bf16 v[16:31], a[224:227], v[120:123], v[16:31]
    v_mfma_f32_32x32x16_bf16 v[48:63], v[108:111], v[252:255], v[48:63]
    ds_read_b128 v[104:107], v11 offset:11264
    buffer_load_dwordx4 v1, s[4:7], s51 offen offset:2048 sc1 lds
    v_mfma_f32_32x32x16_bf16 v[32:47], a[228:231], v[120:123], v[32:47]
    s_nop 7
    v_mul_f32 v126, v124, v16
    v_mul_f32 v127, v124, v17
    v_mul_f32 v12, v124, v18
    v_mul_f32 v13, v124, v19
    s_waitcnt lgkmcnt(3)
    v_mfma_f32_32x32x16_bf16 v[64:79], v[112:115], v[192:195], v[64:79]
    ds_read_b128 v[108:111], v14 offset:2048
    v_exp_f32 v126, v126
    v_mul_f32 v16, v16, v24
    v_exp_f32 v127, v127
    v_mfma_f32_32x32x16_bf16 v[48:63], a[232:235], v[120:123], v[48:63]
    v_mul_f32 v17, v17, v25
    v_exp_f32 v12, v12
    v_mul_f32 v18, v18, v26
    v_mfma_f32_32x32x16_bf16 v[80:95], v[116:119], v[128:131], 0
    ds_read_b128 v[112:115], v11 offset:15360
    v_exp_f32 v13, v13
    v_mul_f32 v19, v19, v27
    v_fma_f32 v126, v126, v125, v125
    v_fma_f32 v127, v127, v125, v125
    s_waitcnt lgkmcnt(3)
    v_mfma_f32_32x32x16_bf16 v[64:79], v[96:99], v[196:199], v[64:79]
    ds_read_b128 v[116:119], v14 offset:3072
    buffer_load_dwordx4 v1, s[4:7], s51 offen offset:3072 sc1 lds
    s_add_u32 m0, s45, 32768
    s_add_u32 s51, s46, 196608
    v_fma_f32 v12, v12, v125, v125
    v_fma_f32 v13, v13, v125, v125
    v_rcp_f32 v126, v126
    v_mfma_f32_32x32x16_bf16 v[80:95], v[100:103], v[132:135], v[80:95]
    ds_read_b128 v[96:99], v11 offset:19456
    v_rcp_f32 v127, v127
    v_rcp_f32 v12, v12
    s_waitcnt lgkmcnt(3)
    v_mfma_f32_32x32x16_bf16 v[64:79], v[104:107], v[200:203], v[64:79]
    ds_read_b128 v[100:103], v14 offset:4096
    v_rcp_f32 v13, v13
    v_mul_f32 v16, v16, v126
    v_mul_f32 v17, v17, v127
    v_mul_f32 v18, v18, v12
    v_mfma_f32_32x32x16_bf16 v[80:95], v[108:111], v[136:139], v[80:95]
    ds_read_b128 v[104:107], v11 offset:23552
    buffer_load_dwordx4 v1, s[4:7], s51 offen offset:0 sc1 lds
    v_mul_f32 v19, v19, v13
    v_cvt_pk_bf16_f32 v24, v16, v17
    v_cvt_pk_bf16_f32 v25, v18, v19
    v_mul_f32 v126, v124, v20
    v_mul_f32 v127, v124, v21
    s_waitcnt lgkmcnt(3)
    v_mfma_f32_32x32x16_bf16 v[64:79], v[112:115], v[204:207], v[64:79]
    ds_read_b128 v[108:111], v14 offset:5120
    v_mul_f32 v12, v124, v22
    v_mul_f32 v13, v124, v23
    v_exp_f32 v126, v126
    v_mul_f32 v20, v20, v28
    v_mfma_f32_32x32x16_bf16 v[80:95], v[116:119], v[140:143], v[80:95]
    ds_read_b128 v[112:115], v11 offset:27648
    v_exp_f32 v127, v127
    v_mul_f32 v21, v21, v29
    v_exp_f32 v12, v12
    s_waitcnt lgkmcnt(3)
    v_mfma_f32_32x32x16_bf16 v[64:79], v[96:99], v[208:211], v[64:79]
    ds_read_b128 v[116:119], v14 offset:6144
    buffer_load_dwordx4 v1, s[4:7], s51 offen offset:1024 sc1 lds
    v_mul_f32 v22, v22, v30
    v_exp_f32 v13, v13
    v_mul_f32 v23, v23, v31
    v_fma_f32 v126, v126, v125, v125
    v_mfma_f32_32x32x16_bf16 v[80:95], v[100:103], v[144:147], v[80:95]
    ds_read_b128 v[96:99], v11 offset:31744
    v_fma_f32 v127, v127, v125, v125
    v_fma_f32 v12, v12, v125, v125
    v_fma_f32 v13, v13, v125, v125
    v_rcp_f32 v126, v126
    s_waitcnt lgkmcnt(3)
    v_mfma_f32_32x32x16_bf16 v[64:79], v[104:107], v[212:215], v[64:79]
    ds_read_b128 v[100:103], v14 offset:7168
    v_rcp_f32 v127, v127
    v_rcp_f32 v12, v12
    v_mfma_f32_32x32x16_bf16 v[80:95], v[108:111], v[148:151], v[80:95]
    ds_read_b128 v[104:107], v11 offset:35840
    buffer_load_dwordx4 v1, s[4:7], s51 offen offset:2048 sc1 lds
    v_rcp_f32 v13, v13
    v_mul_f32 v20, v20, v126
    v_mul_f32 v21, v21, v127
    v_mul_f32 v22, v22, v12
    s_waitcnt lgkmcnt(3)
    v_mfma_f32_32x32x16_bf16 v[64:79], v[112:115], v[216:219], v[64:79]
    ds_read_b128 v[108:111], v14 offset:8192
    v_mul_f32 v23, v23, v13
    v_cvt_pk_bf16_f32 v26, v20, v21
    v_cvt_pk_bf16_f32 v27, v22, v23
    v_mfma_f32_32x32x16_bf16 v[80:95], v[116:119], v[152:155], v[80:95]
    ds_read_b128 v[112:115], v11 offset:39936
    buffer_store_dwordx4 v[24:27], v1, s[4:7], s50 offen offset:0 sc1
    v_mul_f32 v126, v124, v32
    v_mul_f32 v127, v124, v33
    s_waitcnt lgkmcnt(3)
    v_mfma_f32_32x32x16_bf16 v[64:79], v[96:99], v[220:223], v[64:79]
    ds_read_b128 v[116:119], v14 offset:9216
    buffer_load_dwordx4 v1, s[4:7], s51 offen offset:3072 sc1 lds
    s_add_u32 m0, s45, 49152
    s_add_u32 s51, s46, 212992
    v_mul_f32 v12, v124, v34
    v_mul_f32 v13, v124, v35
    v_exp_f32 v126, v126
    v_mul_f32 v32, v32, v40
    v_mfma_f32_32x32x16_bf16 v[80:95], v[100:103], v[156:159], v[80:95]
    ds_read_b128 v[96:99], v11 offset:44032
    v_exp_f32 v127, v127
    v_mul_f32 v33, v33, v41
    v_exp_f32 v12, v12
    s_waitcnt lgkmcnt(3)
    v_mfma_f32_32x32x16_bf16 v[64:79], v[104:107], v[224:227], v[64:79]
    ds_read_b128 v[100:103], v14 offset:10240
    v_mul_f32 v34, v34, v42
    v_exp_f32 v13, v13
    v_mul_f32 v35, v35, v43
    v_fma_f32 v126, v126, v125, v125
    v_mfma_f32_32x32x16_bf16 v[80:95], v[108:111], v[160:163], v[80:95]
    ds_read_b128 v[104:107], v11 offset:48128
    buffer_load_dwordx4 v1, s[4:7], s51 offen offset:0 sc1 lds
    v_fma_f32 v127, v127, v125, v125
    v_fma_f32 v12, v12, v125, v125
    v_fma_f32 v13, v13, v125, v125
    v_rcp_f32 v126, v126
    s_waitcnt lgkmcnt(3)
    v_mfma_f32_32x32x16_bf16 v[64:79], v[112:115], v[228:231], v[64:79]
    ds_read_b128 v[108:111], v14 offset:11264
    v_rcp_f32 v127, v127
    v_rcp_f32 v12, v12
    v_mfma_f32_32x32x16_bf16 v[80:95], v[116:119], v[164:167], v[80:95]
    ds_read_b128 v[112:115], v11 offset:52224
    v_rcp_f32 v13, v13
    v_mul_f32 v32, v32, v126
    v_mul_f32 v33, v33, v127
    v_mul_f32 v34, v34, v12
    s_waitcnt lgkmcnt(3)
    v_mfma_f32_32x32x16_bf16 v[64:79], v[96:99], v[232:235], v[64:79]
    ds_read_b128 v[116:119], v14 offset:12288
    buffer_load_dwordx4 v1, s[4:7], s51 offen offset:1024 sc1 lds
    v_mul_f32 v35, v35, v13
    v_cvt_pk_bf16_f32 v40, v32, v33
    v_cvt_pk_bf16_f32 v41, v34, v35
    v_mul_f32 v126, v124, v36
    v_mul_f32 v127, v124, v37
    v_mfma_f32_32x32x16_bf16 v[80:95], v[100:103], v[168:171], v[80:95]
    ds_read_b128 v[96:99], v11 offset:56320
    v_mul_f32 v12, v124, v38
    v_mul_f32 v13, v124, v39
    v_exp_f32 v126, v126
    v_mul_f32 v36, v36, v44
    s_waitcnt lgkmcnt(3)
    v_mfma_f32_32x32x16_bf16 v[64:79], v[104:107], v[236:239], v[64:79]
    ds_read_b128 v[100:103], v14 offset:13312
    v_exp_f32 v127, v127
    v_mul_f32 v37, v37, v45
    v_exp_f32 v12, v12
    v_mfma_f32_32x32x16_bf16 v[80:95], v[108:111], v[172:175], v[80:95]
    ds_read_b128 v[104:107], v11 offset:60416
    buffer_load_dwordx4 v1, s[4:7], s51 offen offset:2048 sc1 lds
    v_mul_f32 v38, v38, v46
    v_exp_f32 v13, v13
    v_mul_f32 v39, v39, v47
    v_fma_f32 v126, v126, v125, v125
    s_waitcnt lgkmcnt(3)
    v_mfma_f32_32x32x16_bf16 v[64:79], v[112:115], v[240:243], v[64:79]
    ds_read_b128 v[108:111], v14 offset:14336
    v_fma_f32 v127, v127, v125, v125
    v_fma_f32 v12, v12, v125, v125
    v_fma_f32 v13, v13, v125, v125
    v_rcp_f32 v126, v126
    v_mfma_f32_32x32x16_bf16 v[80:95], v[116:119], v[176:179], v[80:95]
    ds_read_b128 v[112:115], v11 offset:64512
    v_rcp_f32 v127, v127
    v_rcp_f32 v12, v12
    s_waitcnt lgkmcnt(3)
    v_mfma_f32_32x32x16_bf16 v[64:79], v[96:99], v[244:247], v[64:79]
    ds_read_b128 v[116:119], v14 offset:15360
    buffer_load_dwordx4 v1, s[4:7], s51 offen offset:3072 sc1 lds
    s_add_u32 s34, s34, 16384
    v_rcp_f32 v13, v13
    v_mul_f32 v36, v36, v126
    v_mul_f32 v37, v37, v127
    v_mul_f32 v38, v38, v12
    v_mfma_f32_32x32x16_bf16 v[80:95], v[100:103], v[180:183], v[80:95]
    ds_read_b128 v[96:99], v14 offset:16384
    v_mul_f32 v39, v39, v13
    v_cvt_pk_bf16_f32 v42, v36, v37
    v_cvt_pk_bf16_f32 v43, v38, v39
    s_waitcnt vmcnt(13)
    s_barrier
    s_waitcnt lgkmcnt(3)
    v_mfma_f32_32x32x16_bf16 v[64:79], v[104:107], v[248:251], v[64:79]
    ds_read_b128 v[100:103], v1 offset:0
    buffer_store_dwordx4 v[40:43], v1, s[4:7], s50 offen offset:1024 sc1
    v_mul_f32 v126, v124, v48
    v_mul_f32 v127, v124, v49
    v_mfma_f32_32x32x16_bf16 v[80:95], v[108:111], v[184:187], v[80:95]
    ds_read_b128 v[104:107], v14 offset:17408
    buffer_load_dwordx4 a[176:179], v10, s[4:7], s34 offen offset:2048 sc1
    s_add_u32 s35, s35, 16384
    v_mul_f32 v12, v124, v50
    v_mul_f32 v13, v124, v51
    v_exp_f32 v126, v126
    v_mul_f32 v48, v48, v56
    s_waitcnt lgkmcnt(3)
    v_mfma_f32_32x32x16_bf16 v[64:79], v[112:115], v[252:255], v[64:79]
    ds_read_b128 v[108:111], v1 offset:1024
    v_exp_f32 v127, v127
    v_mul_f32 v49, v49, v57
    v_exp_f32 v12, v12
    v_mfma_f32_32x32x16_bf16 v[80:95], v[116:119], v[188:191], v[80:95]
    ds_read_b128 v[112:115], v14 offset:18432
    v_mul_f32 v50, v50, v58
    v_exp_f32 v13, v13
    v_mul_f32 v51, v51, v59
    v_fma_f32 v126, v126, v125, v125
    v_mfma_f32_32x32x16_bf16 v[64:79], a[236:239], v[120:123], v[64:79]
    v_fma_f32 v127, v127, v125, v125
    v_fma_f32 v12, v12, v125, v125
    v_fma_f32 v13, v13, v125, v125
    v_rcp_f32 v126, v126
    s_waitcnt lgkmcnt(3)
    v_mfma_f32_32x32x16_bf16 v[80:95], v[96:99], v[192:195], v[80:95]
    ds_read_b128 v[116:119], v1 offset:2048
    buffer_load_dwordx4 a[180:183], v10, s[4:7], s35 offen offset:2048 sc1
    v_rcp_f32 v127, v127
    v_rcp_f32 v12, v12
    v_mfma_f32_32x32x16_bf16 v[16:31], v[100:103], v[128:131], 0
    ds_read_b128 v[96:99], v14 offset:19456
    v_rcp_f32 v13, v13
    v_mul_f32 v48, v48, v126
    v_mul_f32 v49, v49, v127
    v_mul_f32 v50, v50, v12
    s_waitcnt lgkmcnt(3)
    v_mfma_f32_32x32x16_bf16 v[80:95], v[104:107], v[196:199], v[80:95]
    ds_read_b128 v[100:103], v1 offset:3072
    v_mul_f32 v51, v51, v13
    v_cvt_pk_bf16_f32 v56, v48, v49
    v_cvt_pk_bf16_f32 v57, v50, v51
    v_mul_f32 v126, v124, v52
    v_mul_f32 v127, v124, v53
    v_mfma_f32_32x32x16_bf16 v[16:31], v[108:111], v[132:135], v[16:31]
    ds_read_b128 v[104:107], v14 offset:20480
    buffer_load_dwordx4 a[184:187], v10, s[4:7], s34 offen offset:3072 sc1
    v_mul_f32 v12, v124, v54
    v_mul_f32 v13, v124, v55
    v_exp_f32 v126, v126
    v_mul_f32 v52, v52, v60
    s_waitcnt lgkmcnt(3)
    v_mfma_f32_32x32x16_bf16 v[80:95], v[112:115], v[200:203], v[80:95]
    ds_read_b128 v[108:111], v1 offset:4096
    v_exp_f32 v127, v127
    v_mul_f32 v53, v53, v61
    v_exp_f32 v12, v12
    v_mfma_f32_32x32x16_bf16 v[16:31], v[116:119], v[136:139], v[16:31]
    ds_read_b128 v[112:115], v14 offset:21504
    v_mul_f32 v54, v54, v62
    v_exp_f32 v13, v13
    v_mul_f32 v55, v55, v63
    v_fma_f32 v126, v126, v125, v125
    s_waitcnt lgkmcnt(3)
    v_mfma_f32_32x32x16_bf16 v[80:95], v[96:99], v[204:207], v[80:95]
    ds_read_b128 v[116:119], v1 offset:5120
    buffer_load_dwordx4 a[188:191], v10, s[4:7], s35 offen offset:3072 sc1
    s_add_u32 s34, s34, 8192
    v_fma_f32 v127, v127, v125, v125
    v_fma_f32 v12, v12, v125, v125
    v_fma_f32 v13, v13, v125, v125
    v_rcp_f32 v126, v126
    v_mfma_f32_32x32x16_bf16 v[16:31], v[100:103], v[140:143], v[16:31]
    ds_read_b128 v[96:99], v14 offset:22528
    v_rcp_f32 v127, v127
    v_rcp_f32 v12, v12
    s_waitcnt lgkmcnt(3)
    v_mfma_f32_32x32x16_bf16 v[80:95], v[104:107], v[208:211], v[80:95]
    ds_read_b128 v[100:103], v1 offset:6144
    v_rcp_f32 v13, v13
    v_mul_f32 v52, v52, v126
    v_mul_f32 v53, v53, v127
    v_mul_f32 v54, v54, v12
    v_mfma_f32_32x32x16_bf16 v[16:31], v[108:111], v[144:147], v[16:31]
    ds_read_b128 v[104:107], v14 offset:23552
    buffer_load_dwordx4 a[192:195], v1, s[4:7], s34 offen offset:0 sc1
    s_add_u32 s35, s35, 8192
    s_waitcnt vmcnt(11)
    v_mov_b32 v4, 1
    s_mov_b64 exec, 1
    buffer_store_dword v4, v3, s[4:7], s74 offen sc1
    s_mov_b64 exec, -1
    v_mul_f32 v55, v55, v13
    v_cvt_pk_bf16_f32 v58, v52, v53
    v_cvt_pk_bf16_f32 v59, v54, v55
    s_waitcnt lgkmcnt(3)
    v_mfma_f32_32x32x16_bf16 v[80:95], v[112:115], v[212:215], v[80:95]
    ds_read_b128 v[108:111], v1 offset:7168
    buffer_store_dwordx4 v[56:59], v1, s[4:7], s50 offen offset:2048 sc1
    v_mul_f32 v126, v124, v64
    v_mul_f32 v127, v124, v65
    v_mfma_f32_32x32x16_bf16 v[16:31], v[116:119], v[148:151], v[16:31]
    ds_read_b128 v[112:115], v14 offset:24576
    v_mul_f32 v12, v124, v66
    v_mul_f32 v13, v124, v67
    v_exp_f32 v126, v126
    v_mul_f32 v64, v64, v72
    s_waitcnt lgkmcnt(3)
    v_mfma_f32_32x32x16_bf16 v[80:95], v[96:99], v[216:219], v[80:95]
    ds_read_b128 v[116:119], v1 offset:8192
    buffer_load_dwordx4 a[196:199], v1, s[4:7], s35 offen offset:0 sc1
    v_exp_f32 v127, v127
    v_mul_f32 v65, v65, v73
    v_exp_f32 v12, v12
    v_mfma_f32_32x32x16_bf16 v[16:31], v[100:103], v[152:155], v[16:31]
    ds_read_b128 v[96:99], v14 offset:25600
    v_mul_f32 v66, v66, v74
    v_exp_f32 v13, v13
    v_mul_f32 v67, v67, v75
    v_fma_f32 v126, v126, v125, v125
    s_waitcnt lgkmcnt(3)
    v_mfma_f32_32x32x16_bf16 v[80:95], v[104:107], v[220:223], v[80:95]
    ds_read_b128 v[100:103], v1 offset:9216
    v_fma_f32 v127, v127, v125, v125
    v_fma_f32 v12, v12, v125, v125
    v_fma_f32 v13, v13, v125, v125
    v_rcp_f32 v126, v126
    v_mfma_f32_32x32x16_bf16 v[16:31], v[108:111], v[156:159], v[16:31]
    ds_read_b128 v[104:107], v14 offset:26624
    buffer_load_dwordx4 a[200:203], v1, s[4:7], s34 offen offset:1024 sc1
    v_rcp_f32 v127, v127
    v_rcp_f32 v12, v12
    s_waitcnt lgkmcnt(3)
    v_mfma_f32_32x32x16_bf16 v[80:95], v[112:115], v[224:227], v[80:95]
    ds_read_b128 v[108:111], v1 offset:10240
    v_rcp_f32 v13, v13
    v_mul_f32 v64, v64, v126
    v_mul_f32 v65, v65, v127
    v_mul_f32 v66, v66, v12
    v_mfma_f32_32x32x16_bf16 v[16:31], v[116:119], v[160:163], v[16:31]
    ds_read_b128 v[112:115], v14 offset:27648
    buffer_load_dword v5, v3, s[4:7], s75 offen sc1
    v_mul_f32 v67, v67, v13
    v_cvt_pk_bf16_f32 v72, v64, v65
    v_cvt_pk_bf16_f32 v73, v66, v67
    v_mul_f32 v126, v124, v68
    v_mul_f32 v127, v124, v69
    s_waitcnt lgkmcnt(3)
    v_mfma_f32_32x32x16_bf16 v[80:95], v[96:99], v[228:231], v[80:95]
    ds_read_b128 v[116:119], v1 offset:11264
    buffer_load_dwordx4 a[204:207], v1, s[4:7], s35 offen offset:1024 sc1
    v_mul_f32 v12, v124, v70
    v_mul_f32 v13, v124, v71
    v_exp_f32 v126, v126
    v_mul_f32 v68, v68, v76
    v_mfma_f32_32x32x16_bf16 v[16:31], v[100:103], v[164:167], v[16:31]
    ds_read_b128 v[96:99], v14 offset:28672
    v_exp_f32 v127, v127
    v_mul_f32 v69, v69, v77
    v_exp_f32 v12, v12
    s_waitcnt lgkmcnt(3)
    v_mfma_f32_32x32x16_bf16 v[80:95], v[104:107], v[232:235], v[80:95]
    ds_read_b128 v[100:103], v1 offset:12288
    v_mul_f32 v70, v70, v78
    v_exp_f32 v13, v13
    v_mul_f32 v71, v71, v79
    v_fma_f32 v126, v126, v125, v125
    v_mfma_f32_32x32x16_bf16 v[16:31], v[108:111], v[168:171], v[16:31]
    ds_read_b128 v[104:107], v14 offset:29696
    buffer_load_dwordx4 a[208:211], v1, s[4:7], s34 offen offset:2048 sc1
    v_fma_f32 v127, v127, v125, v125
    v_fma_f32 v12, v12, v125, v125
    v_fma_f32 v13, v13, v125, v125
    v_rcp_f32 v126, v126
    s_waitcnt lgkmcnt(3)
    v_mfma_f32_32x32x16_bf16 v[80:95], v[112:115], v[236:239], v[80:95]
    ds_read_b128 v[108:111], v1 offset:13312
    v_rcp_f32 v127, v127
    v_rcp_f32 v12, v12
    v_mfma_f32_32x32x16_bf16 v[16:31], v[116:119], v[172:175], v[16:31]
    ds_read_b128 v[112:115], v14 offset:30720
    v_rcp_f32 v13, v13
    v_mul_f32 v68, v68, v126
    v_mul_f32 v69, v69, v127
    v_mul_f32 v70, v70, v12
    s_waitcnt lgkmcnt(3)
    v_mfma_f32_32x32x16_bf16 v[80:95], v[96:99], v[240:243], v[80:95]
    ds_read_b128 v[116:119], v1 offset:14336
    buffer_load_dwordx4 a[212:215], v1, s[4:7], s35 offen offset:2048 sc1
    v_mul_f32 v71, v71, v13
    v_cvt_pk_bf16_f32 v74, v68, v69
    v_cvt_pk_bf16_f32 v75, v70, v71
    v_mfma_f32_32x32x16_bf16 v[16:31], v[100:103], v[176:179], v[16:31]
    ds_read_b128 v[96:99], v14 offset:31744
    buffer_store_dwordx4 v[72:75], v1, s[4:7], s50 offen offset:3072 sc1
    s_waitcnt lgkmcnt(3)
    v_mfma_f32_32x32x16_bf16 v[80:95], v[104:107], v[244:247], v[80:95]
    ds_read_b128 v[100:103], v1 offset:15360
    s_waitcnt vmcnt(19)
    s_barrier
    v_mfma_f32_32x32x16_bf16 v[16:31], v[108:111], v[180:183], v[16:31]
    ds_read_b128 v[104:107], v1 offset:16384
    buffer_load_dwordx4 a[216:219], v1, s[4:7], s34 offen offset:3072 sc1
    s_waitcnt lgkmcnt(3)
    v_mfma_f32_32x32x16_bf16 v[80:95], v[112:115], v[248:251], v[80:95]
    ds_read_b128 v[108:111], v1 offset:32768
    v_mfma_f32_32x32x16_bf16 v[16:31], v[116:119], v[184:187], v[16:31]
    ds_read_b128 v[112:115], v1 offset:17408
    s_waitcnt lgkmcnt(3)
    v_mfma_f32_32x32x16_bf16 v[80:95], v[96:99], v[252:255], v[80:95]
    ds_read_b128 v[116:119], v1 offset:33792
    buffer_load_dwordx4 a[220:223], v1, s[4:7], s35 offen offset:3072 sc1
    v_mfma_f32_32x32x16_bf16 v[16:31], v[100:103], v[188:191], v[16:31]
    ds_read_b128 v[96:99], v1 offset:18432
    v_mfma_f32_32x32x16_bf16 v[80:95], a[240:243], v[120:123], v[80:95]
    s_waitcnt lgkmcnt(3)
    v_mfma_f32_32x32x16_bf16 v[16:31], v[104:107], v[192:195], v[16:31]
    ds_read_b128 v[100:103], v1 offset:34816
    s_waitcnt vmcnt(6)
    v_cmp_le_u32 vcc, 1, v5
    s_cmp_eq_u64 vcc, -1
    s_cbranch_scc0 F_e5s0G
F_e5b0G:
    v_mfma_f32_32x32x16_bf16 v[32:47], v[108:111], v[128:131], 0
    ds_read_b128 v[104:107], v1 offset:19456
    buffer_load_dwordx4 v[128:131], v1, s[4:7], s76 offen offset:0 sc1
    s_nop 1
    v_mul_f32 v126, v124, v80
    v_mul_f32 v127, v124, v81
    v_mul_f32 v12, v124, v82
    v_mul_f32 v13, v124, v83
    s_waitcnt lgkmcnt(3)
    v_mfma_f32_32x32x16_bf16 v[16:31], v[112:115], v[196:199], v[16:31]
    ds_read_b128 v[108:111], v1 offset:35840
    v_exp_f32 v126, v126
    v_mul_f32 v80, v80, v88
    v_exp_f32 v127, v127
    v_mfma_f32_32x32x16_bf16 v[32:47], v[116:119], v[132:135], v[32:47]
    ds_read_b128 v[112:115], v1 offset:20480
    buffer_load_dwordx4 v[132:135], v1, s[4:7], s80 offen offset:0 sc1
    v_mul_f32 v81, v81, v89
    v_exp_f32 v12, v12
    v_mul_f32 v82, v82, v90
    s_waitcnt lgkmcnt(3)
    v_mfma_f32_32x32x16_bf16 v[16:31], v[96:99], v[200:203], v[16:31]
    ds_read_b128 v[116:119], v1 offset:36864
    v_exp_f32 v13, v13
    v_mul_f32 v83, v83, v91
    v_fma_f32 v126, v126, v125, v125
    v_fma_f32 v127, v127, v125, v125
    v_mfma_f32_32x32x16_bf16 v[32:47], v[100:103], v[136:139], v[32:47]
    ds_read_b128 v[96:99], v1 offset:21504
    buffer_load_dwordx4 v[136:139], v10, s[4:7], s76 offen offset:3072 sc1
    v_fma_f32 v12, v12, v125, v125
    v_fma_f32 v13, v13, v125, v125
    v_rcp_f32 v126, v126
    s_waitcnt lgkmcnt(3)
    v_mfma_f32_32x32x16_bf16 v[16:31], v[104:107], v[204:207], v[16:31]
    ds_read_b128 v[100:103], v1 offset:37888
    v_mov_b32 v4, 2
    s_mov_b64 exec, 1
    buffer_store_dword v4, v3, s[4:7], s74 offen sc1
    s_mov_b64 exec, -1
    v_rcp_f32 v127, v127
    v_rcp_f32 v12, v12
    v_mfma_f32_32x32x16_bf16 v[32:47], v[108:111], v[140:143], v[32:47]
    ds_read_b128 v[104:107], v1 offset:22528
    buffer_load_dwordx4 v[140:143], v10, s[4:7], s80 offen offset:3072 sc1
    v_rcp_f32 v13, v13
    v_mul_f32 v80, v80, v126
    v_mul_f32 v81, v81, v127
    v_mul_f32 v82, v82, v12
    s_waitcnt lgkmcnt(3)
    v_mfma_f32_32x32x16_bf16 v[16:31], v[112:115], v[208:211], v[16:31]
    ds_read_b128 v[108:111], v1 offset:38912
    v_mul_f32 v83, v83, v13
    v_cvt_pk_bf16_f32 v88, v80, v81
    v_cvt_pk_bf16_f32 v89, v82, v83
    v_mul_f32 v126, v124, v84
    v_mul_f32 v127, v124, v85
    v_mfma_f32_32x32x16_bf16 v[32:47], v[116:119], v[144:147], v[32:47]
    ds_read_b128 v[112:115], v1 offset:23552
    buffer_load_dwordx4 v[144:147], v10, s[4:7], s77 offen offset:2048 sc1
    v_mul_f32 v12, v124, v86
    v_mul_f32 v13, v124, v87
    v_exp_f32 v126, v126
    v_mul_f32 v84, v84, v92
    s_waitcnt lgkmcnt(3)
    v_mfma_f32_32x32x16_bf16 v[16:31], v[96:99], v[212:215], v[16:31]
    ds_read_b128 v[116:119], v1 offset:39936
    v_exp_f32 v127, v127
    v_mul_f32 v85, v85, v93
    v_exp_f32 v12, v12
    v_mfma_f32_32x32x16_bf16 v[32:47], v[100:103], v[148:151], v[32:47]
    ds_read_b128 v[96:99], v1 offset:24576
    buffer_load_dwordx4 v[148:151], v10, s[4:7], s81 offen offset:2048 sc1
    v_mul_f32 v86, v86, v94
    v_exp_f32 v13, v13
    v_mul_f32 v87, v87, v95
    v_fma_f32 v126, v126, v125, v125
    s_waitcnt lgkmcnt(3)
    v_mfma_f32_32x32x16_bf16 v[16:31], v[104:107], v[216:219], v[16:31]
    ds_read_b128 v[100:103], v1 offset:40960
    v_fma_f32 v127, v127, v125, v125
    v_fma_f32 v12, v12, v125, v125
    v_fma_f32 v13, v13, v125, v125
    v_rcp_f32 v126, v126
    v_mfma_f32_32x32x16_bf16 v[32:47], v[108:111], v[152:155], v[32:47]
    ds_read_b128 v[104:107], v1 offset:25600
    buffer_load_dwordx4 v[152:155], v10, s[4:7], s78 offen offset:1024 sc1
    v_rcp_f32 v127, v127
    v_rcp_f32 v12, v12
    s_waitcnt lgkmcnt(3)
    v_mfma_f32_32x32x16_bf16 v[16:31], v[112:115], v[220:223], v[16:31]
    ds_read_b128 v[108:111], v1 offset:41984
    buffer_load_dword v5, v3, s[4:7], s75 offen sc1
    v_rcp_f32 v13, v13
    v_mul_f32 v84, v84, v126
    v_mul_f32 v85, v85, v127
    v_mul_f32 v86, v86, v12
    v_mfma_f32_32x32x16_bf16 v[32:47], v[116:119], v[156:159], v[32:47]
    ds_read_b128 v[112:115], v1 offset:26624
    buffer_load_dwordx4 v[156:159], v10, s[4:7], s82 offen offset:1024 sc1
    v_mul_f32 v87, v87, v13
    v_cvt_pk_bf16_f32 v90, v84, v85
    v_cvt_pk_bf16_f32 v91, v86, v87
    s_waitcnt lgkmcnt(3)
    v_mfma_f32_32x32x16_bf16 v[16:31], v[96:99], v[224:227], v[16:31]
    ds_read_b128 v[116:119], v1 offset:43008
    buffer_store_dwordx4 v[88:91], v10, s[4:7], s50 offen offset:0 sc1
    v_mfma_f32_32x32x16_bf16 v[32:47], v[100:103], v[160:163], v[32:47]
    ds_read_b128 v[96:99], v1 offset:27648
    s_waitcnt lgkmcnt(3)
    v_mfma_f32_32x32x16_bf16 v[16:31], v[104:107], v[228:231], v[16:31]
    ds_read_b128 v[100:103], v1 offset:44032
    v_mfma_f32_32x32x16_bf16 v[32:47], v[108:111], v[164:167], v[32:47]
    ds_read_b128 v[104:107], v1 offset:28672
    s_waitcnt lgkmcnt(3)
    v_mfma_f32_32x32x16_bf16 v[16:31], v[112:115], v[232:235], v[16:31]
    ds_read_b128 v[108:111], v1 offset:45056
    v_mfma_f32_32x32x16_bf16 v[32:47], v[116:119], v[168:171], v[32:47]
    ds_read_b128 v[112:115], v1 offset:29696
    s_waitcnt lgkmcnt(3)
    v_mfma_f32_32x32x16_bf16 v[16:31], v[96:99], v[236:239], v[16:31]
    ds_read_b128 v[116:119], v1 offset:46080
    v_mfma_f32_32x32x16_bf16 v[32:47], v[100:103], v[172:175], v[32:47]
    ds_read_b128 v[96:99], v1 offset:30720
    s_waitcnt lgkmcnt(3)
    v_mfma_f32_32x32x16_bf16 v[16:31], v[104:107], v[240:243], v[16:31]
    ds_read_b128 v[100:103], v1 offset:47104
    v_mfma_f32_32x32x16_bf16 v[32:47], v[108:111], v[176:179], v[32:47]
    ds_read_b128 v[104:107], v1 offset:31744
    s_waitcnt lgkmcnt(3)
    v_mfma_f32_32x32x16_bf16 v[16:31], v[112:115], v[244:247], v[16:31]
    ds_read_b128 v[108:111], v1 offset:48128
    s_barrier
    v_mfma_f32_32x32x16_bf16 v[32:47], v[116:119], v[180:183], v[32:47]
    ds_read_b128 v[112:115], v1 offset:49152
    s_waitcnt lgkmcnt(3)
    v_mfma_f32_32x32x16_bf16 v[16:31], v[96:99], v[248:251], v[16:31]
    ds_read_b128 v[116:119], v1 offset:50176
    v_mfma_f32_32x32x16_bf16 v[32:47], v[100:103], v[184:187], v[32:47]
    ds_read_b128 v[96:99], v1 offset:51200
    s_waitcnt lgkmcnt(3)
    v_mfma_f32_32x32x16_bf16 v[16:31], v[104:107], v[252:255], v[16:31]
    ds_read_b128 v[100:103], v1 offset:52224
    v_mfma_f32_32x32x16_bf16 v[32:47], v[108:111], v[188:191], v[32:47]
    ds_read_b128 v[104:107], v1 offset:53248
    v_mfma_f32_32x32x16_bf16 v[16:31], a[244:247], v[120:123], v[16:31]
    s_waitcnt lgkmcnt(3)
    v_mfma_f32_32x32x16_bf16 v[32:47], v[112:115], v[192:195], v[32:47]
    ds_read_b128 v[108:111], v1 offset:54272
    s_waitcnt vmcnt(2)
    v_cmp_le_u32 vcc, 2, v5
    s_cmp_eq_u64 vcc, -1
    s_cbranch_scc0 F_e5s1G
F_e5b1G:
    buffer_load_dwordx4 v[160:163], v1, s[4:7], s76 offen offset:1024 sc1
    v_mfma_f32_32x32x16_bf16 v[32:47], v[116:119], v[196:199], v[32:47]
    ds_read_b128 v[112:115], v1 offset:55296
    s_nop 1
    v_mul_f32 v126, v124, v16
    v_mul_f32 v127, v124, v17
    v_mul_f32 v12, v124, v18
    v_mul_f32 v13, v124, v19
    s_waitcnt lgkmcnt(3)
    v_mfma_f32_32x32x16_bf16 v[32:47], v[96:99], v[200:203], v[32:47]
    ds_read_b128 v[116:119], v1 offset:56320
    buffer_load_dwordx4 v[164:167], v1, s[4:7], s80 offen offset:1024 sc1
    v_exp_f32 v126, v126
    v_mul_f32 v16, v16, v24
    v_exp_f32 v127, v127
    v_mfma_f32_32x32x16_bf16 v[32:47], v[100:103], v[204:207], v[32:47]
    ds_read_b128 v[96:99], v1 offset:57344
    v_mul_f32 v17, v17, v25
    v_exp_f32 v12, v12
    v_mul_f32 v18, v18, v26
    s_waitcnt lgkmcnt(3)
    v_mfma_f32_32x32x16_bf16 v[32:47], v[104:107], v[208:211], v[32:47]
    ds_read_b128 v[100:103], v1 offset:58368
    buffer_load_dwordx4 v[168:171], v1, s[4:7], s76 offen offset:2048 sc1
    v_exp_f32 v13, v13
    v_mul_f32 v19, v19, v27
    v_fma_f32 v126, v126, v125, v125
    v_fma_f32 v127, v127, v125, v125
    v_mfma_f32_32x32x16_bf16 v[32:47], v[108:111], v[212:215], v[32:47]
    ds_read_b128 v[104:107], v1 offset:59392
    v_fma_f32 v12, v12, v125, v125
    v_fma_f32 v13, v13, v125, v125
    v_rcp_f32 v126, v126
    s_waitcnt lgkmcnt(3)
    v_mfma_f32_32x32x16_bf16 v[32:47], v[112:115], v[216:219], v[32:47]
    ds_read_b128 v[108:111], v1 offset:60416
    buffer_load_dwordx4 v[172:175], v1, s[4:7], s80 offen offset:2048 sc1
    v_rcp_f32 v127, v127
    v_rcp_f32 v12, v12
    v_mfma_f32_32x32x16_bf16 v[32:47], v[116:119], v[220:223], v[32:47]
    ds_read_b128 v[112:115], v1 offset:61440
    v_rcp_f32 v13, v13
    v_mul_f32 v16, v16, v126
    v_mul_f32 v17, v17, v127
    v_mul_f32 v18, v18, v12
    s_waitcnt lgkmcnt(3)
    v_mfma_f32_32x32x16_bf16 v[32:47], v[96:99], v[224:227], v[32:47]
    ds_read_b128 v[116:119], v1 offset:62464
    buffer_load_dwordx4 v[176:179], v1, s[4:7], s77 offen offset:0 sc1
    v_mul_f32 v19, v19, v13
    v_cvt_pk_bf16_f32 v24, v16, v17
    v_cvt_pk_bf16_f32 v25, v18, v19
    v_mul_f32 v126, v124, v20
    v_mul_f32 v127, v124, v21
    v_mfma_f32_32x32x16_bf16 v[32:47], v[100:103], v[228:231], v[32:47]
    ds_read_b128 v[96:99], v1 offset:63488
    v_mul_f32 v12, v124, v22
    v_mul_f32 v13, v124, v23
    v_exp_f32 v126, v126
    v_mul_f32 v20, v20, v28
    s_waitcnt lgkmcnt(3)
    v_mfma_f32_32x32x16_bf16 v[32:47], v[104:107], v[232:235], v[32:47]
    ds_read_b128 v[100:103], v1 offset:64512
    buffer_load_dwordx4 v[180:183], v1, s[4:7], s81 offen offset:0 sc1
    v_exp_f32 v127, v127
    v_mul_f32 v21, v21, v29
    v_exp_f32 v12, v12
    v_mfma_f32_32x32x16_bf16 v[32:47], v[108:111], v[236:239], v[32:47]
    v_mul_f32 v22, v22, v30
    v_exp_f32 v13, v13
    v_mul_f32 v23, v23, v31
    v_fma_f32 v126, v126, v125, v125
    s_waitcnt lgkmcnt(2)
    v_mfma_f32_32x32x16_bf16 v[32:47], v[112:115], v[240:243], v[32:47]
    buffer_load_dwordx4 v[184:187], v1, s[4:7], s77 offen offset:1024 sc1
    v_fma_f32 v127, v127, v125, v125
    v_fma_f32 v12, v12, v125, v125
    v_fma_f32 v13, v13, v125, v125
    v_rcp_f32 v126, v126
    v_mfma_f32_32x32x16_bf16 v[32:47], v[116:119], v[244:247], v[32:47]
    v_rcp_f32 v127, v127
    v_rcp_f32 v12, v12
    s_waitcnt lgkmcnt(0)
    v_mfma_f32_32x32x16_bf16 v[32:47], v[96:99], v[248:251], v[32:47]
    s_waitcnt vmcnt(7)
    v_mov_b32 v4, 3
    s_mov_b64 exec, 1
    buffer_store_dword v4, v3, s[4:7], s74 offen sc1
    s_mov_b64 exec, -1
    buffer_load_dwordx4 v[188:191], v1, s[4:7], s81 offen offset:1024 sc1
    v_rcp_f32 v13, v13
    v_mul_f32 v20, v20, v126
    v_mul_f32 v21, v21, v127
    v_mul_f32 v22, v22, v12
    v_mfma_f32_32x32x16_bf16 v[32:47], v[100:103], v[252:255], v[32:47]
    v_mul_f32 v23, v23, v13
    v_cvt_pk_bf16_f32 v26, v20, v21
    v_cvt_pk_bf16_f32 v27, v22, v23
    v_mfma_f32_32x32x16_bf16 v[32:47], a[248:251], v[120:123], v[32:47]
    buffer_store_dwordx4 v[24:27], v10, s[4:7], s50 offen offset:1024 sc1
    v_mfma_f32_32x32x16_bf16 v[48:63], a[0:3], v[128:131], 0
    buffer_load_dwordx4 v[192:195], v10, s[4:7], s77 offen offset:3072 sc1
    v_mfma_f32_32x32x16_bf16 v[64:79], a[4:7], v[128:131], 0
    buffer_load_dwordx4 v[196:199], v10, s[4:7], s81 offen offset:3072 sc1
    s_nop 6
    v_mul_f32 v126, v124, v32
    v_mul_f32 v127, v124, v33
    v_mul_f32 v12, v124, v34
    v_mul_f32 v13, v124, v35
    v_exp_f32 v126, v126
    v_mul_f32 v32, v32, v40
    v_mfma_f32_32x32x16_bf16 v[80:95], a[0:3], v[132:135], 0
    v_exp_f32 v127, v127
    v_mul_f32 v33, v33, v41
    v_exp_f32 v12, v12
    v_mul_f32 v34, v34, v42
    v_mfma_f32_32x32x16_bf16 v[96:111], a[4:7], v[132:135], 0
    buffer_load_dwordx4 v[200:203], v1, s[4:7], s78 offen offset:0 sc1
    v_exp_f32 v13, v13
    v_mul_f32 v35, v35, v43
    v_fma_f32 v126, v126, v125, v125
    v_fma_f32 v127, v127, v125, v125
    v_fma_f32 v12, v12, v125, v125
    v_fma_f32 v13, v13, v125, v125
    v_mfma_f32_32x32x16_bf16 v[48:63], a[56:59], v[136:139], v[48:63]
    buffer_load_dwordx4 v[204:207], v1, s[4:7], s82 offen offset:0 sc1
    v_rcp_f32 v126, v126
    v_rcp_f32 v127, v127
    v_rcp_f32 v12, v12
    v_mfma_f32_32x32x16_bf16 v[64:79], a[60:63], v[136:139], v[64:79]
    buffer_load_dword v5, v3, s[4:7], s75 offen sc1
    v_rcp_f32 v13, v13
    v_mul_f32 v32, v32, v126
    v_mul_f32 v33, v33, v127
    v_mul_f32 v34, v34, v12
    v_mul_f32 v35, v35, v13
    v_cvt_pk_bf16_f32 v40, v32, v33
    v_mfma_f32_32x32x16_bf16 v[80:95], a[56:59], v[140:143], v[80:95]
    buffer_load_dwordx4 v[208:211], v10, s[4:7], s78 offen offset:2048 sc1
    v_cvt_pk_bf16_f32 v41, v34, v35
    v_mul_f32 v126, v124, v36
    v_mul_f32 v127, v124, v37
    v_mul_f32 v12, v124, v38
    v_mul_f32 v13, v124, v39
    v_exp_f32 v126, v126
    v_mfma_f32_32x32x16_bf16 v[96:111], a[60:63], v[140:143], v[96:111]
    buffer_load_dwordx4 v[212:215], v10, s[4:7], s82 offen offset:2048 sc1
    v_mul_f32 v36, v36, v44
    v_exp_f32 v127, v127
    v_mul_f32 v37, v37, v45
    v_exp_f32 v12, v12
    v_mul_f32 v38, v38, v46
    v_mfma_f32_32x32x16_bf16 v[48:63], a[112:115], v[144:147], v[48:63]
    v_exp_f32 v13, v13
    v_mul_f32 v39, v39, v47
    v_fma_f32 v126, v126, v125, v125
    v_fma_f32 v127, v127, v125, v125
    v_fma_f32 v12, v12, v125, v125
    v_fma_f32 v13, v13, v125, v125
    v_mfma_f32_32x32x16_bf16 v[64:79], a[116:119], v[144:147], v[64:79]
    buffer_load_dwordx4 v[216:219], v10, s[4:7], s78 offen offset:3072 sc1
    v_rcp_f32 v126, v126
    v_rcp_f32 v127, v127
    v_rcp_f32 v12, v12
    v_mfma_f32_32x32x16_bf16 v[80:95], a[112:115], v[148:151], v[80:95]
    buffer_load_dwordx4 v[220:223], v10, s[4:7], s82 offen offset:3072 sc1
    v_rcp_f32 v13, v13
    v_mul_f32 v36, v36, v126
    v_mul_f32 v37, v37, v127
    v_mul_f32 v38, v38, v12
    v_mul_f32 v39, v39, v13
    v_cvt_pk_bf16_f32 v42, v36, v37
    v_mfma_f32_32x32x16_bf16 v[96:111], a[116:119], v[148:151], v[96:111]
    v_cvt_pk_bf16_f32 v43, v38, v39
    buffer_store_dwordx4 v[40:43], v10, s[4:7], s50 offen offset:2048 sc1
    s_xor_b32 s46, s3, 1
    s_mul_i32 s46, s46, 12288
    v_add_u32 v13, s46, v1
    s_xor_b32 s46, s3, 2
    s_mul_i32 s46, s46, 12288
    v_mfma_f32_32x32x16_bf16 v[48:63], a[168:171], v[152:155], v[48:63]
    v_add_u32 v14, s46, v1
    s_xor_b32 s46, s3, 3
    s_mul_i32 s46, s46, 12288
    v_add_u32 v15, s46, v1
    s_mul_i32 s46, s3, 12288
    v_add_u32 v12, s46, v1
    v_mfma_f32_32x32x16_bf16 v[64:79], a[172:175], v[152:155], v[64:79]
    v_mfma_f32_32x32x16_bf16 v[80:95], a[168:171], v[156:159], v[80:95]
    v_mfma_f32_32x32x16_bf16 v[96:111], a[172:175], v[156:159], v[96:111]
    s_waitcnt vmcnt(18)
    v_mfma_f32_32x32x16_bf16 v[48:63], a[8:11], v[160:163], v[48:63]
    v_mfma_f32_32x32x16_bf16 v[64:79], a[12:15], v[160:163], v[64:79]
    v_mfma_f32_32x32x16_bf16 v[80:95], a[8:11], v[164:167], v[80:95]
    v_mfma_f32_32x32x16_bf16 v[96:111], a[12:15], v[164:167], v[96:111]
    s_waitcnt vmcnt(16)
    v_mfma_f32_32x32x16_bf16 v[48:63], a[16:19], v[168:171], v[48:63]
    v_mfma_f32_32x32x16_bf16 v[64:79], a[20:23], v[168:171], v[64:79]
    v_mfma_f32_32x32x16_bf16 v[80:95], a[16:19], v[172:175], v[80:95]
    v_mfma_f32_32x32x16_bf16 v[96:111], a[20:23], v[172:175], v[96:111]
    s_waitcnt vmcnt(14)
    v_mfma_f32_32x32x16_bf16 v[48:63], a[64:67], v[176:179], v[48:63]
    s_waitcnt vmcnt(0)
    v_mov_b32 v4, 4
    s_mov_b64 exec, 1
    buffer_store_dword v4, v3, s[4:7], s74 offen sc1
    s_mov_b64 exec, -1
    v_mfma_f32_32x32x16_bf16 v[64:79], a[68:71], v[176:179], v[64:79]
    v_mfma_f32_32x32x16_bf16 v[80:95], a[64:67], v[180:183], v[80:95]
    v_mfma_f32_32x32x16_bf16 v[96:111], a[68:71], v[180:183], v[96:111]
    v_cmp_le_u32 vcc, 3, v5
    s_cmp_eq_u64 vcc, -1
    s_cbranch_scc0 F_e5s2G
F_e5b2G:
    buffer_load_dwordx4 v[224:227], v1, s[4:7], s76 offen offset:3072 sc1
    v_mfma_f32_32x32x16_bf16 v[48:63], a[72:75], v[184:187], v[48:63]
    buffer_load_dwordx4 v[228:231], v1, s[4:7], s80 offen offset:3072 sc1
    v_mfma_f32_32x32x16_bf16 v[64:79], a[76:79], v[184:187], v[64:79]
    v_mfma_f32_32x32x16_bf16 v[80:95], a[72:75], v[188:191], v[80:95]
    buffer_load_dwordx4 v[232:235], v10, s[4:7], s76 offen offset:0 sc1
    v_mfma_f32_32x32x16_bf16 v[96:111], a[76:79], v[188:191], v[96:111]
    buffer_load_dwordx4 v[236:239], v10, s[4:7], s80 offen offset:0 sc1
    v_mfma_f32_32x32x16_bf16 v[48:63], a[120:123], v[192:195], v[48:63]
    v_mfma_f32_32x32x16_bf16 v[64:79], a[124:127], v[192:195], v[64:79]
    buffer_load_dwordx4 v[240:243], v1, s[4:7], s77 offen offset:2048 sc1
    v_mfma_f32_32x32x16_bf16 v[80:95], a[120:123], v[196:199], v[80:95]
    buffer_load_dword v5, v3, s[4:7], s75 offen sc1
    buffer_load_dwordx4 v[244:247], v1, s[4:7], s81 offen offset:2048 sc1
    v_mfma_f32_32x32x16_bf16 v[96:111], a[124:127], v[196:199], v[96:111]
    v_mfma_f32_32x32x16_bf16 v[48:63], a[128:131], v[200:203], v[48:63]
    buffer_load_dwordx4 v[16:19], v1, s[4:7], s77 offen offset:3072 sc1
    v_mfma_f32_32x32x16_bf16 v[64:79], a[132:135], v[200:203], v[64:79]
    buffer_load_dwordx4 v[20:23], v1, s[4:7], s81 offen offset:3072 sc1
    v_mfma_f32_32x32x16_bf16 v[80:95], a[128:131], v[204:207], v[80:95]
    v_mfma_f32_32x32x16_bf16 v[96:111], a[132:135], v[204:207], v[96:111]
    buffer_load_dwordx4 v[24:27], v1, s[4:7], s78 offen offset:1024 sc1
    s_barrier
    v_mfma_f32_32x32x16_bf16 v[48:63], a[176:179], v[208:211], v[48:63]
    buffer_load_dwordx4 v[28:31], v1, s[4:7], s82 offen offset:1024 sc1
    v_mfma_f32_32x32x16_bf16 v[64:79], a[180:183], v[208:211], v[64:79]
    v_mfma_f32_32x32x16_bf16 v[80:95], a[176:179], v[212:215], v[80:95]
    buffer_load_dwordx4 v[32:35], v1, s[4:7], s78 offen offset:2048 sc1
    v_mfma_f32_32x32x16_bf16 v[96:111], a[180:183], v[212:215], v[96:111]
    buffer_load_dwordx4 v[36:39], v1, s[4:7], s82 offen offset:2048 sc1
    v_mfma_f32_32x32x16_bf16 v[48:63], a[184:187], v[216:219], v[48:63]
    v_mfma_f32_32x32x16_bf16 v[64:79], a[188:191], v[216:219], v[64:79]
    buffer_load_dwordx4 v[40:43], v1, s[4:7], s79 offen offset:0 sc1
    v_mfma_f32_32x32x16_bf16 v[80:95], a[184:187], v[220:223], v[80:95]
    buffer_load_dwordx4 v[44:47], v1, s[4:7], s83 offen offset:0 sc1
    v_mfma_f32_32x32x16_bf16 v[96:111], a[188:191], v[220:223], v[96:111]
    s_waitcnt vmcnt(13)
    v_mfma_f32_32x32x16_bf16 v[48:63], a[24:27], v[224:227], v[48:63]
    buffer_load_dwordx4 v[112:115], v1, s[4:7], s79 offen offset:1024 sc1
    v_mfma_f32_32x32x16_bf16 v[64:79], a[28:31], v[224:227], v[64:79]
    buffer_load_dwordx4 v[116:119], v1, s[4:7], s83 offen offset:1024 sc1
    v_mfma_f32_32x32x16_bf16 v[80:95], a[24:27], v[228:231], v[80:95]
    v_mfma_f32_32x32x16_bf16 v[96:111], a[28:31], v[228:231], v[96:111]
    s_waitcnt vmcnt(13)
    v_mfma_f32_32x32x16_bf16 v[48:63], a[32:35], v[232:235], v[48:63]
    v_mfma_f32_32x32x16_bf16 v[64:79], a[36:39], v[232:235], v[64:79]
    v_mfma_f32_32x32x16_bf16 v[80:95], a[32:35], v[236:239], v[80:95]
    v_mfma_f32_32x32x16_bf16 v[96:111], a[36:39], v[236:239], v[96:111]
    s_waitcnt vmcnt(10)
    v_mfma_f32_32x32x16_bf16 v[48:63], a[80:83], v[240:243], v[48:63]
    v_cmp_le_u32 vcc, 4, v5
    s_cmp_eq_u64 vcc, -1
    s_cbranch_scc0 F_e5s3G
F_e5b3G:
    buffer_load_dwordx4 v[120:123], v10, s[4:7], s76 offen offset:1024 sc1
    v_mfma_f32_32x32x16_bf16 v[64:79], a[84:87], v[240:243], v[64:79]
    buffer_load_dwordx4 v[124:127], v10, s[4:7], s80 offen offset:1024 sc1
    v_mfma_f32_32x32x16_bf16 v[80:95], a[80:83], v[244:247], v[80:95]
    v_mfma_f32_32x32x16_bf16 v[96:111], a[84:87], v[244:247], v[96:111]
    buffer_load_dwordx4 v[128:131], v10, s[4:7], s76 offen offset:2048 sc1
    s_waitcnt vmcnt(11)
    v_mfma_f32_32x32x16_bf16 v[48:63], a[88:91], v[16:19], v[48:63]
    buffer_load_dwordx4 v[132:135], v10, s[4:7], s80 offen offset:2048 sc1
    v_mfma_f32_32x32x16_bf16 v[64:79], a[92:95], v[16:19], v[64:79]
    v_mfma_f32_32x32x16_bf16 v[80:95], a[88:91], v[20:23], v[80:95]
    buffer_load_dwordx4 v[136:139], v10, s[4:7], s77 offen offset:0 sc1
    v_mfma_f32_32x32x16_bf16 v[96:111], a[92:95], v[20:23], v[96:111]
    buffer_load_dwordx4 v[140:143], v10, s[4:7], s81 offen offset:0 sc1
    s_waitcnt vmcnt(12)
    v_mfma_f32_32x32x16_bf16 v[64:79], a[140:143], v[24:27], v[64:79]
    buffer_load_dwordx4 v[144:147], v10, s[4:7], s77 offen offset:1024 sc1
    v_mfma_f32_32x32x16_bf16 v[80:95], a[136:139], v[28:31], v[80:95]
    buffer_load_dwordx4 v[148:151], v10, s[4:7], s81 offen offset:1024 sc1
    v_mfma_f32_32x32x16_bf16 v[96:111], a[140:143], v[28:31], v[96:111]
    s_waitcnt vmcnt(12)
    buffer_load_dwordx4 v[152:155], v1, s[4:7], s78 offen offset:3072 sc1
    v_mfma_f32_32x32x16_bf16 v[64:79], a[148:151], v[32:35], v[64:79]
    buffer_load_dwordx4 v[156:159], v1, s[4:7], s82 offen offset:3072 sc1
    v_mfma_f32_32x32x16_bf16 v[80:95], a[144:147], v[36:39], v[80:95]
    v_mfma_f32_32x32x16_bf16 v[96:111], a[148:151], v[36:39], v[96:111]
    buffer_load_dwordx4 v[160:163], v10, s[4:7], s78 offen offset:0 sc1
    buffer_load_dwordx4 v[248:251], v1, s[4:7], s42 offen sc1
    buffer_load_dwordx4 v[252:255], v1, s[4:7], s42 offen offset:1024 sc1
    s_waitcnt vmcnt(15)
    buffer_load_dwordx4 v[164:167], v10, s[4:7], s82 offen offset:0 sc1
    v_mfma_f32_32x32x16_bf16 v[64:79], a[196:199], v[40:43], v[64:79]
    v_mfma_f32_32x32x16_bf16 v[80:95], a[192:195], v[44:47], v[80:95]
    buffer_load_dwordx4 v[168:171], v1, s[4:7], s79 offen offset:2048 sc1
    v_mfma_f32_32x32x16_bf16 v[96:111], a[196:199], v[44:47], v[96:111]
    buffer_load_dwordx4 v[172:175], v1, s[4:7], s83 offen offset:2048 sc1
    s_waitcnt vmcnt(16)
    v_mfma_f32_32x32x16_bf16 v[64:79], a[204:207], v[112:115], v[64:79]
    buffer_load_dwordx4 v[176:179], v1, s[4:7], s79 offen offset:3072 sc1
    v_mfma_f32_32x32x16_bf16 v[80:95], a[200:203], v[116:119], v[80:95]
    buffer_load_dwordx4 v[180:183], v1, s[4:7], s83 offen offset:3072 sc1
    v_mfma_f32_32x32x16_bf16 v[96:111], a[204:207], v[116:119], v[96:111]
    s_waitcnt vmcnt(16)
    v_mfma_f32_32x32x16_bf16 v[64:79], a[44:47], v[120:123], v[64:79]
    v_mfma_f32_32x32x16_bf16 v[80:95], a[40:43], v[124:127], v[80:95]
    v_mfma_f32_32x32x16_bf16 v[96:111], a[44:47], v[124:127], v[96:111]
    s_waitcnt vmcnt(14)
    v_mfma_f32_32x32x16_bf16 v[64:79], a[52:55], v[128:131], v[64:79]
    v_mfma_f32_32x32x16_bf16 v[80:95], a[48:51], v[132:135], v[80:95]
    v_mfma_f32_32x32x16_bf16 v[96:111], a[52:55], v[132:135], v[96:111]
    s_waitcnt vmcnt(12)
    v_mfma_f32_32x32x16_bf16 v[64:79], a[100:103], v[136:139], v[64:79]
    v_mfma_f32_32x32x16_bf16 v[80:95], a[96:99], v[140:143], v[80:95]
    v_mfma_f32_32x32x16_bf16 v[96:111], a[100:103], v[140:143], v[96:111]
    s_waitcnt vmcnt(10)
    v_mfma_f32_32x32x16_bf16 v[64:79], a[108:111], v[144:147], v[64:79]
    v_mfma_f32_32x32x16_bf16 v[80:95], a[104:107], v[148:151], v[80:95]
    v_mfma_f32_32x32x16_bf16 v[96:111], a[108:111], v[148:151], v[96:111]
    s_waitcnt vmcnt(8)
    v_mfma_f32_32x32x16_bf16 v[64:79], a[156:159], v[152:155], v[64:79]
    v_mfma_f32_32x32x16_bf16 v[80:95], a[152:155], v[156:159], v[80:95]
    v_mfma_f32_32x32x16_bf16 v[96:111], a[156:159], v[156:159], v[96:111]
    s_waitcnt vmcnt(4)
    v_mfma_f32_32x32x16_bf16 v[64:79], a[164:167], v[160:163], v[64:79]
    v_mfma_f32_32x32x16_bf16 v[80:95], a[160:163], v[164:167], v[80:95]
    v_mfma_f32_32x32x16_bf16 v[96:111], a[164:167], v[164:167], v[96:111]
    s_waitcnt vmcnt(2)
    v_mfma_f32_32x32x16_bf16 v[64:79], a[212:215], v[168:171], v[64:79]
    v_mfma_f32_32x32x16_bf16 v[80:95], a[208:211], v[172:175], v[80:95]
    v_mfma_f32_32x32x16_bf16 v[96:111], a[212:215], v[172:175], v[96:111]
    s_waitcnt vmcnt(0)
    v_mfma_f32_32x32x16_bf16 v[64:79], a[220:223], v[176:179], v[64:79]
    v_mfma_f32_32x32x16_bf16 v[80:95], a[216:219], v[180:183], v[80:95]
    v_mfma_f32_32x32x16_bf16 v[96:111], a[220:223], v[180:183], v[96:111]
    v_mfma_f32_32x32x16_bf16 v[48:63], a[136:139], v[24:27], v[48:63]
    s_nop 8
    ds_write_b128 v13, v[64:67] offset:0
    v_mfma_f32_32x32x16_bf16 v[48:63], a[144:147], v[32:35], v[48:63]
    ds_write_b128 v13, v[68:71] offset:1024
    v_mfma_f32_32x32x16_bf16 v[48:63], a[192:195], v[40:43], v[48:63]
    ds_write_b128 v13, v[72:75] offset:2048
    v_mfma_f32_32x32x16_bf16 v[48:63], a[200:203], v[112:115], v[48:63]
    ds_write_b128 v13, v[76:79] offset:3072
    v_mfma_f32_32x32x16_bf16 v[48:63], a[40:43], v[120:123], v[48:63]
    ds_write_b128 v14, v[80:83] offset:4096
    v_mfma_f32_32x32x16_bf16 v[48:63], a[48:51], v[128:131], v[48:63]
    ds_write_b128 v14, v[84:87] offset:5120
    v_mfma_f32_32x32x16_bf16 v[48:63], a[96:99], v[136:139], v[48:63]
    ds_write_b128 v14, v[88:91] offset:6144
    v_mfma_f32_32x32x16_bf16 v[48:63], a[104:107], v[144:147], v[48:63]
    ds_write_b128 v14, v[92:95] offset:7168
    v_mfma_f32_32x32x16_bf16 v[48:63], a[152:155], v[152:155], v[48:63]
    ds_write_b128 v15, v[96:99] offset:8192
    v_mfma_f32_32x32x16_bf16 v[48:63], a[160:163], v[160:163], v[48:63]
    ds_write_b128 v15, v[100:103] offset:9216
    v_mfma_f32_32x32x16_bf16 v[48:63], a[208:211], v[168:171], v[48:63]
    ds_write_b128 v15, v[104:107] offset:10240
    v_mfma_f32_32x32x16_bf16 v[48:63], a[216:219], v[176:179], v[48:63]
    ds_write_b128 v15, v[108:111] offset:11264
    s_waitcnt lgkmcnt(0)
    s_barrier
    ds_read_b128 v[64:67], v12 offset:0
    ds_read_b128 v[68:71], v12 offset:1024
    ds_read_b128 v[72:75], v12 offset:2048
    ds_read_b128 v[76:79], v12 offset:3072
    ds_read_b128 v[80:83], v12 offset:4096
    ds_read_b128 v[84:87], v12 offset:5120
    ds_read_b128 v[88:91], v12 offset:6144
    ds_read_b128 v[92:95], v12 offset:7168
    ds_read_b128 v[96:99], v12 offset:8192
    ds_read_b128 v[100:103], v12 offset:9216
    ds_read_b128 v[104:107], v12 offset:10240
    ds_read_b128 v[108:111], v12 offset:11264
    v_lshlrev_b32 v16, 16, v248
    v_and_b32 v17, 0xffff0000, v248
    v_lshlrev_b32 v18, 16, v249
    v_and_b32 v19, 0xffff0000, v249
    v_lshlrev_b32 v20, 16, v250
    v_and_b32 v21, 0xffff0000, v250
    v_lshlrev_b32 v22, 16, v251
    v_and_b32 v23, 0xffff0000, v251
    v_lshlrev_b32 v24, 16, v252
    v_and_b32 v25, 0xffff0000, v252
    v_lshlrev_b32 v26, 16, v253
    v_and_b32 v27, 0xffff0000, v253
    v_lshlrev_b32 v28, 16, v254
    v_and_b32 v29, 0xffff0000, v254
    v_lshlrev_b32 v30, 16, v255
    v_and_b32 v31, 0xffff0000, v255
    v_add_f32 v48, v48, v16
    v_add_f32 v49, v49, v17
    v_add_f32 v50, v50, v18
    v_add_f32 v51, v51, v19
    v_add_f32 v52, v52, v20
    v_add_f32 v53, v53, v21
    v_add_f32 v54, v54, v22
    v_add_f32 v55, v55, v23
    v_add_f32 v56, v56, v24
    v_add_f32 v57, v57, v25
    v_add_f32 v58, v58, v26
    v_add_f32 v59, v59, v27
    v_add_f32 v60, v60, v28
    v_add_f32 v61, v61, v29
    v_add_f32 v62, v62, v30
    v_add_f32 v63, v63, v31
    s_waitcnt lgkmcnt(11)
    v_add_f32 v48, v48, v64
    v_add_f32 v49, v49, v65
    v_add_f32 v50, v50, v66
    v_add_f32 v51, v51, v67
    s_waitcnt lgkmcnt(10)
    v_add_f32 v52, v52, v68
    v_add_f32 v53, v53, v69
    v_add_f32 v54, v54, v70
    v_add_f32 v55, v55, v71
    s_waitcnt lgkmcnt(9)
    v_add_f32 v56, v56, v72
    v_add_f32 v57, v57, v73
    v_add_f32 v58, v58, v74
    v_add_f32 v59, v59, v75
    s_waitcnt lgkmcnt(8)
    v_add_f32 v60, v60, v76
    v_add_f32 v61, v61, v77
    v_add_f32 v62, v62, v78
    v_add_f32 v63, v63, v79
    s_waitcnt lgkmcnt(7)
    v_add_f32 v48, v48, v80
    v_add_f32 v49, v49, v81
    v_add_f32 v50, v50, v82
    v_add_f32 v51, v51, v83
    s_waitcnt lgkmcnt(6)
    v_add_f32 v52, v52, v84
    v_add_f32 v53, v53, v85
    v_add_f32 v54, v54, v86
    v_add_f32 v55, v55, v87
    s_waitcnt lgkmcnt(5)
    v_add_f32 v56, v56, v88
    v_add_f32 v57, v57, v89
    v_add_f32 v58, v58, v90
    v_add_f32 v59, v59, v91
    s_waitcnt lgkmcnt(4)
    v_add_f32 v60, v60, v92
    v_add_f32 v61, v61, v93
    v_add_f32 v62, v62, v94
    v_add_f32 v63, v63, v95
    s_waitcnt lgkmcnt(3)
    v_add_f32 v48, v48, v96
    v_add_f32 v49, v49, v97
    v_add_f32 v50, v50, v98
    v_add_f32 v51, v51, v99
    s_waitcnt lgkmcnt(2)
    v_add_f32 v52, v52, v100
    v_add_f32 v53, v53, v101
    v_add_f32 v54, v54, v102
    v_add_f32 v55, v55, v103
    s_waitcnt lgkmcnt(1)
    v_add_f32 v56, v56, v104
    v_add_f32 v57, v57, v105
    v_add_f32 v58, v58, v106
    v_add_f32 v59, v59, v107
    s_waitcnt lgkmcnt(0)
    v_add_f32 v60, v60, v108
    v_add_f32 v61, v61, v109
    v_add_f32 v62, v62, v110
    v_add_f32 v63, v63, v111
    v_cvt_pk_bf16_f32 v64, v48, v49
    v_cvt_pk_bf16_f32 v65, v50, v51
    v_cvt_pk_bf16_f32 v66, v52, v53
    v_cvt_pk_bf16_f32 v67, v54, v55
    v_cvt_pk_bf16_f32 v68, v56, v57
    v_cvt_pk_bf16_f32 v69, v58, v59
    v_cvt_pk_bf16_f32 v70, v60, v61
    v_cvt_pk_bf16_f32 v71, v62, v63
    v_permlane32_swap_b32 v64, v66
    v_permlane32_swap_b32 v65, v67
    v_permlane32_swap_b32 v68, v70
    v_permlane32_swap_b32 v69, v71
    buffer_store_dwordx4 v[64:67], v7, s[12:15], s37 offen
    buffer_store_dwordx4 v[68:71], v7, s[12:15], s37 offen offset:32
    s_endpgm
F_f0slowa:
    s_sleep 2
    buffer_load_dword v232, v234, s[4:7], s43 offen sc1
    s_waitcnt vmcnt(0)
    v_cmp_eq_u32 vcc, 1, v232
    s_cmp_eq_u64 vcc, -1
    s_cbranch_scc1 F_f0backa
    s_cmp_eq_u32 s30, 0
    s_cbranch_scc1 F_f0backa
    s_sub_u32 s30, s30, 1
    s_branch F_f0slowa
F_f0slowb:
    s_sleep 2
    buffer_load_dword v232, v233, s[4:7], s42 offen sc1
    s_waitcnt vmcnt(0)
    v_cmp_eq_u32 vcc, 1, v232
    s_cmp_eq_u64 vcc, -1
    s_cbranch_scc1 F_f0backb
    s_cmp_eq_u32 s30, 0
    s_cbranch_scc1 F_f0backb
    s_sub_u32 s30, s30, 1
    s_branch F_f0slowb
F_ls1:
    ds_read_b32 v226, v225 offset:4
    s_waitcnt lgkmcnt(0)
    v_cmp_ne_u32 vcc, s74, v226
    s_cbranch_vccz F_lb1
    s_cmp_eq_u32 s30, 0
    s_cbranch_scc1 F_lb1
    s_sub_u32 s30, s30, 1
    s_branch F_ls1
F_ls2:
    ds_read_b32 v226, v225 offset:8
    s_waitcnt lgkmcnt(0)
    v_cmp_ne_u32 vcc, s74, v226
    s_cbranch_vccz F_lb2
    s_cmp_eq_u32 s30, 0
    s_cbranch_scc1 F_lb2
    s_sub_u32 s30, s30, 1
    s_branch F_ls2
F_ls3:
    ds_read_b32 v226, v225 offset:12
    s_waitcnt lgkmcnt(0)
    v_cmp_ne_u32 vcc, s74, v226
    s_cbranch_vccz F_lb3
    s_cmp_eq_u32 s30, 0
    s_cbranch_scc1 F_lb3
    s_sub_u32 s30, s30, 1
    s_branch F_ls3
F_ls4:
    ds_read_b32 v226, v225 offset:16
    s_waitcnt lgkmcnt(0)
    v_cmp_ne_u32 vcc, s74, v226
    s_cbranch_vccz F_lb4
    s_cmp_eq_u32 s30, 0
    s_cbranch_scc1 F_lb4
    s_sub_u32 s30, s30, 1
    s_branch F_ls4
F_ls5:
    ds_read_b32 v226, v225 offset:20
    s_waitcnt lgkmcnt(0)
    v_cmp_ne_u32 vcc, s74, v226
    s_cbranch_vccz F_lb5
    s_cmp_eq_u32 s30, 0
    s_cbranch_scc1 F_lb5
    s_sub_u32 s30, s30, 1
    s_branch F_ls5
F_ls6:
    ds_read_b32 v226, v225 offset:24
    s_waitcnt lgkmcnt(0)
    v_cmp_ne_u32 vcc, s74, v226
    s_cbranch_vccz F_lb6
    s_cmp_eq_u32 s30, 0
    s_cbranch_scc1 F_lb6
    s_sub_u32 s30, s30, 1
    s_branch F_ls6
F_ls7:
    ds_read_b32 v226, v225 offset:28
    s_waitcnt lgkmcnt(0)
    v_cmp_ne_u32 vcc, s74, v226
    s_cbranch_vccz F_lb7
    s_cmp_eq_u32 s30, 0
    s_cbranch_scc1 F_lb7
    s_sub_u32 s30, s30, 1
    s_branch F_ls7
F_ls8:
    ds_read_b32 v226, v225 offset:32
    s_waitcnt lgkmcnt(0)
    v_cmp_ne_u32 vcc, s74, v226
    s_cbranch_vccz F_lb8
    s_cmp_eq_u32 s30, 0
    s_cbranch_scc1 F_lb8
    s_sub_u32 s30, s30, 1
    s_branch F_ls8
F_qsk:
    buffer_store_dwordx4 v[48:51], v1, s[4:7], s49 offen sc1
    buffer_store_dwordx4 v[52:55], v1, s[4:7], s50 offen sc1
    s_branch F_qbk
F_qsv:
    buffer_store_dwordx4 v[64:67], v31, s[4:7], s49 offen offset:1024 sc1
    buffer_store_dwordx4 v[68:71], v31, s[4:7], s49 offen offset:1040 sc1
    s_branch F_qbv
F_qsq:
    buffer_store_dwordx4 v[32:35], v1, s[4:7], s47 offen sc1
    buffer_store_dwordx4 v[36:39], v1, s[4:7], s48 offen sc1
    s_branch F_qbq
F_f1r:
    v_mov_b32 v28, 1
    v_mov_b32 v29, 1
    v_mov_b32 v30, 1
    v_mov_b32 v31, 1
    s_add_u32 s83, s83, 4096
    s_mov_b64 exec, 1
    buffer_store_dwordx4 v[28:31], v26, s[4:7], s83 offen sc1
    s_mov_b64 exec, -1
    s_branch F_f1
F_p1slow:
    s_mov_b64 exec, 1
    buffer_store_dword v21, v26, s[4:7], s78 offen sc1
    s_mov_b64 exec, -1
    v_lshlrev_b32 v22, 2, v2
    v_and_b32 v23, 60, v2
    v_lshlrev_b32 v23, 2, v23
    s_add_u32 s31, s80, 4096
F_p1s:
    v_mov_b32 v20, 0
    buffer_load_dword v19, v22, s[4:7], s31 offen sc1
    s_cmp_eq_u32 s82, s70
    s_cbranch_scc0 F_p1s2
    buffer_load_dword v20, v23, s[4:7], s80 offen sc1
F_p1s2:
    s_waitcnt vmcnt(0)
    v_or_b32 v20, v19, v20
    v_cmp_ne_u32 vcc, 0, v20
    s_cmp_eq_u64 vcc, -1
    s_cbranch_scc1 F_p1_ok
    s_cmp_eq_u32 s30, 0
    s_cbranch_scc1 F_p1_ok
    s_sub_u32 s30, s30, 1
    s_sleep 2
    s_branch F_p1s
F_tabslow:
    v_min_u32 v196, v192, v193
    v_min3_u32 v196, v196, v194, v195
    v_cmp_ne_u32 vcc, 0, v196
    s_cmp_eq_u64 vcc, -1
    s_cbranch_scc1 F_tabfull
    s_cmp_eq_u32 s30, 0
    s_cbranch_scc1 F_tabfull
    s_sub_u32 s30, s30, 1
    s_sleep 2
    buffer_load_dword v192, v1, s[4:7], s79 offen offset:0 sc1
    buffer_load_dword v193, v1, s[4:7], s79 offen offset:1024 sc1
    buffer_load_dword v194, v1, s[4:7], s79 offen offset:2048 sc1
    buffer_load_dword v195, v1, s[4:7], s79 offen offset:3072 sc1
    s_waitcnt vmcnt(0)
    v_lshl_or_b32 v196, v193, 8, v192
    v_lshl_or_b32 v197, v195, 8, v194
    v_lshl_or_b32 v196, v197, 16, v196
    v_cmp_ne_u32 vcc, v196, v246
    s_cbranch_vccz F_tabback
    s_branch F_tabslow
F_tabfull:
    s_and_b32 s41, s2, 7
    s_add_u32 s42, s41, 1
    s_cmp_eq_u32 s42, s70
    s_cbranch_scc0 F_tabrank
    s_xor_b32 s41, s41, 0
    s_lshr_b32 s42, s2, 3
    s_lshr_b32 s43, s42, 4
    s_lshl3_add_u32 s41, s43, s41
    s_and_b32 s42, s42, 15
    s_lshl_b32 s80, s41, 4
    s_add_u32 s80, s80, s42
    s_lshl_b32 s80, s80, 4
    s_lshl2_add_u32 s80, s3, s80
    s_add_u32 s80, s80, 25718784
    s_lshl2_add_u32 s42, s42, s3
    s_lshl_b32 s41, s41, 7
    s_add_u32 s41, s41, s42
    s_lshl_b32 s39, s41, 10
    s_add_u32 s40, s39, 65536
    s_lshl_b32 s42, s41, 11
    s_add_u32 s42, s42, 2097152
    s_add_u32 s43, s42, 131072
    buffer_load_dwordx4 v[200:203], v1, s[4:7], s39 offen offset:0 sc1
    buffer_load_dwordx4 v[204:207], v1, s[4:7], s40 offen offset:0 sc1
    buffer_load_dwordx4 v[208:211], v1, s[4:7], s42 offen offset:0 sc1
    s_waitcnt vmcnt(0)
    buffer_store_dwordx4 v[200:203], v1, s[4:7], s39 offen offset:0 sc1
    buffer_store_dwordx4 v[204:207], v1, s[4:7], s40 offen offset:0 sc1
    buffer_store_dwordx4 v[208:211], v1, s[4:7], s42 offen offset:0 sc1
    s_waitcnt vmcnt(0)
    buffer_load_dwordx4 v[200:203], v1, s[4:7], s43 offen offset:0 sc1
    buffer_load_dwordx4 v[204:207], v1, s[4:7], s42 offen offset:1024 sc1
    buffer_load_dwordx4 v[208:211], v1, s[4:7], s43 offen offset:1024 sc1
    s_waitcnt vmcnt(0)
    buffer_store_dwordx4 v[200:203], v1, s[4:7], s43 offen offset:0 sc1
    buffer_store_dwordx4 v[204:207], v1, s[4:7], s42 offen offset:1024 sc1
    buffer_store_dwordx4 v[208:211], v1, s[4:7], s43 offen offset:1024 sc1
    s_waitcnt vmcnt(0)
    v_mov_b32 v200, 0
    v_mov_b32 v201, 1
    s_mov_b64 exec, 1
    buffer_store_dword v201, v200, s[4:7], s80 offen sc1
    s_mov_b64 exec, -1
F_tabrank:
    v_lshl_add_u32 v196, v192, 8, v2
    v_lshl_add_u32 v197, v193, 8, v2
    v_lshl_add_u32 v198, v194, 8, v2
    v_lshl_add_u32 v199, v195, 8, v2
    s_sub_u32 s80, s71, 64
    s_sub_u32 s81, s71, 128
    s_sub_u32 s82, s71, 192
    v_cmp_gt_i32 vcc, s71, v196
    s_bcnt1_i32_b64 s41, vcc
    s_mov_b32 s72, s41
    v_cmp_gt_i32 vcc, s80, v197
    s_bcnt1_i32_b64 s41, vcc
    s_add_u32 s72, s72, s41
    v_cmp_gt_i32 vcc, s81, v198
    s_bcnt1_i32_b64 s41, vcc
    s_add_u32 s72, s72, s41
    v_cmp_gt_i32 vcc, s82, v199
    s_bcnt1_i32_b64 s41, vcc
    s_add_u32 s72, s72, s41
    v_cmp_gt_u32 vcc, s70, v192
    s_bcnt1_i32_b64 s41, vcc
    s_mov_b32 s39, s41
    v_cmp_gt_u32 vcc, s70, v193
    s_bcnt1_i32_b64 s41, vcc
    s_add_u32 s39, s39, s41
    v_cmp_gt_u32 vcc, s70, v194
    s_bcnt1_i32_b64 s41, vcc
    s_add_u32 s39, s39, s41
    v_cmp_gt_u32 vcc, s70, v195
    s_bcnt1_i32_b64 s41, vcc
    s_add_u32 s39, s39, s41
    v_cmp_ge_u32 vcc, s70, v192
    s_bcnt1_i32_b64 s41, vcc
    s_mov_b32 s40, s41
    v_cmp_ge_u32 vcc, s70, v193
    s_bcnt1_i32_b64 s41, vcc
    s_add_u32 s40, s40, s41
    v_cmp_ge_u32 vcc, s70, v194
    s_bcnt1_i32_b64 s41, vcc
    s_add_u32 s40, s40, s41
    v_cmp_ge_u32 vcc, s70, v195
    s_bcnt1_i32_b64 s41, vcc
    s_add_u32 s40, s40, s41
    s_and_b32 s72, s72, 255
    s_andn2_b32 s41, s72, 31
    s_add_u32 s42, s41, 32
    s_cmp_le_u32 s39, s41
    s_cselect_b32 s73, 1, 0
    s_cmp_ge_u32 s40, s42
    s_cselect_b32 s73, s73, 0
    s_lshr_b32 s60, s72, 3
    s_and_b32 s61, s72, 7
    s_lshr_b32 s62, s72, 4
    s_and_b32 s63, s72, 15
    s_lshl1_add_u32 s39, s61, s38
    s_lshl1_add_u32 s40, s60, s77
    s_lshl_b32 s41, s61, 16
    s_add_u32 s32, s74, s41
    s_xor_b32 s33, s32, 0x8000
    s_mul_i32 s41, s61, 229376
    s_add_u32 s34, s75, s41
    s_add_u32 s35, s76, s41
    s_mul_i32 s36, s63, 7168
    s_add_u32 s36, s36, 22544384
    s_lshl_b32 s37, s40, 15
    s_lshl_b32 s41, s39, 6
    s_add_u32 s37, s37, s41
    s_mul_i32 s42, s61, 512
    s_add_u32 s42, s42, 25706496
    s_mul_i32 s43, s63, 256
    s_add_u32 s43, s43, 25710592
    s_add_u32 s41, s63, 1
    s_bitcmp1_b32 s41, 1
    s_cselect_b32 s41, 11, 7
    v_min_u32 v234, s41, v2
    v_lshlrev_b32 v234, 4, v234
    s_branch F_tabback
F_e5s0:
    s_cmp_eq_u32 s30, 0
    s_cbranch_scc1 F_e5b0
    s_sub_u32 s30, s30, 1
    buffer_load_dword v5, v3, s[4:7], s75 offen sc1
    s_waitcnt vmcnt(0)
    v_cmp_le_u32 vcc, 1, v5
    s_cmp_eq_u64 vcc, -1
    s_cbranch_scc1 F_e5b0
    s_sleep 1
    s_branch F_e5s0
F_e5s1:
    s_cmp_eq_u32 s30, 0
    s_cbranch_scc1 F_e5b1
    s_sub_u32 s30, s30, 1
    buffer_load_dword v5, v3, s[4:7], s75 offen sc1
    s_waitcnt vmcnt(0)
    v_cmp_le_u32 vcc, 2, v5
    s_cmp_eq_u64 vcc, -1
    s_cbranch_scc1 F_e5b1
    s_sleep 1
    s_branch F_e5s1
F_e5s2:
    s_cmp_eq_u32 s30, 0
    s_cbranch_scc1 F_e5b2
    s_sub_u32 s30, s30, 1
    buffer_load_dword v5, v3, s[4:7], s75 offen sc1
    s_waitcnt vmcnt(0)
    v_cmp_le_u32 vcc, 3, v5
    s_cmp_eq_u64 vcc, -1
    s_cbranch_scc1 F_e5b2
    s_sleep 1
    s_branch F_e5s2
F_e5s3:
    s_cmp_eq_u32 s30, 0
    s_cbranch_scc1 F_e5b3
    s_sub_u32 s30, s30, 1
    buffer_load_dword v5, v3, s[4:7], s75 offen sc1
    s_waitcnt vmcnt(0)
    v_cmp_le_u32 vcc, 4, v5
    s_cmp_eq_u64 vcc, -1
    s_cbranch_scc1 F_e5b3
    s_sleep 1
    s_branch F_e5s3
F_e5s0G:
    s_cmp_eq_u32 s30, 0
    s_cbranch_scc1 F_e5b0G
    s_sub_u32 s30, s30, 1
    buffer_load_dword v5, v3, s[4:7], s75 offen sc1
    s_waitcnt vmcnt(0)
    v_cmp_le_u32 vcc, 1, v5
    s_cmp_eq_u64 vcc, -1
    s_cbranch_scc1 F_e5b0G
    s_sleep 1
    s_branch F_e5s0G
F_e5s1G:
    s_cmp_eq_u32 s30, 0
    s_cbranch_scc1 F_e5b1G
    s_sub_u32 s30, s30, 1
    buffer_load_dword v5, v3, s[4:7], s75 offen sc1
    s_waitcnt vmcnt(0)
    v_cmp_le_u32 vcc, 2, v5
    s_cmp_eq_u64 vcc, -1
    s_cbranch_scc1 F_e5b1G
    s_sleep 1
    s_branch F_e5s1G
F_e5s2G:
    s_cmp_eq_u32 s30, 0
    s_cbranch_scc1 F_e5b2G
    s_sub_u32 s30, s30, 1
    buffer_load_dword v5, v3, s[4:7], s75 offen sc1
    s_waitcnt vmcnt(0)
    v_cmp_le_u32 vcc, 3, v5
    s_cmp_eq_u64 vcc, -1
    s_cbranch_scc1 F_e5b2G
    s_sleep 1
    s_branch F_e5s2G
F_e5s3G:
    s_cmp_eq_u32 s30, 0
    s_cbranch_scc1 F_e5b3G
    s_sub_u32 s30, s30, 1
    buffer_load_dword v5, v3, s[4:7], s75 offen sc1
    s_waitcnt vmcnt(0)
    v_cmp_le_u32 vcc, 4, v5
    s_cmp_eq_u64 vcc, -1
    s_cbranch_scc1 F_e5b3G
    s_sleep 1
    s_branch F_e5s3G
F_fallback:
    s_lshl_b32 s38, s54, 17
    s_add_u32 s38, s38, 2097152
    s_mov_b32 s41, s38
    v_mov_b32 v6, 0xff800000
    v_mov_b32 v7, 0xff800000
    s_mov_b32 s31, 0
F_maxloop:
    buffer_load_dwordx4 v[16:19], v1, s[4:7], s41 offen sc1
    s_add_u32 s41, s41, 2048
    s_waitcnt vmcnt(0)
    v_mfma_f32_32x32x16_bf16 v[72:87], v[16:19], v[8:11], 0
    v_mfma_f32_32x32x16_bf16 v[88:103], v[16:19], v[12:15], 0
    s_nop 10
    v_max3_f32 v6, v6, v72, v73
    v_max3_f32 v6, v6, v74, v75
    v_max3_f32 v6, v6, v76, v77
    v_max3_f32 v6, v6, v78, v79
    v_max3_f32 v6, v6, v80, v81
    v_max3_f32 v6, v6, v82, v83
    v_max3_f32 v6, v6, v84, v85
    v_max3_f32 v6, v6, v86, v87
    v_max3_f32 v7, v7, v88, v89
    v_max3_f32 v7, v7, v90, v91
    v_max3_f32 v7, v7, v92, v93
    v_max3_f32 v7, v7, v94, v95
    v_max3_f32 v7, v7, v96, v97
    v_max3_f32 v7, v7, v98, v99
    v_max3_f32 v7, v7, v100, v101
    v_max3_f32 v7, v7, v102, v103
    s_add_u32 s31, s31, 1
    s_cmp_lt_u32 s31, 64
    s_cbranch_scc1 F_maxloop
    v_mov_b32 v104, v6
    v_mov_b32 v105, v7
    s_nop 0
    v_permlane32_swap_b32 v104, v6
    v_permlane32_swap_b32 v105, v7
    v_max_f32 v6, v6, v104
    v_max_f32 v7, v7, v105
    v_sub_f32 v40, 0, v6
    v_mov_b32 v120, 0
    v_sub_f32 v41, 0, v6
    v_mov_b32 v121, 0
    v_sub_f32 v42, 0, v6
    v_mov_b32 v122, 0
    v_sub_f32 v43, 0, v6
    v_mov_b32 v123, 0
    v_sub_f32 v44, 0, v6
    v_mov_b32 v124, 0
    v_sub_f32 v45, 0, v6
    v_mov_b32 v125, 0
    v_sub_f32 v46, 0, v6
    v_mov_b32 v126, 0
    v_sub_f32 v47, 0, v6
    v_mov_b32 v127, 0
    v_sub_f32 v48, 0, v6
    v_mov_b32 v128, 0
    v_sub_f32 v49, 0, v6
    v_mov_b32 v129, 0
    v_sub_f32 v50, 0, v6
    v_mov_b32 v130, 0
    v_sub_f32 v51, 0, v6
    v_mov_b32 v131, 0
    v_sub_f32 v52, 0, v6
    v_mov_b32 v132, 0
    v_sub_f32 v53, 0, v6
    v_mov_b32 v133, 0
    v_sub_f32 v54, 0, v6
    v_mov_b32 v134, 0
    v_sub_f32 v55, 0, v6
    v_mov_b32 v135, 0
    v_sub_f32 v56, 0, v7
    v_mov_b32 v136, 0
    v_sub_f32 v57, 0, v7
    v_mov_b32 v137, 0
    v_sub_f32 v58, 0, v7
    v_mov_b32 v138, 0
    v_sub_f32 v59, 0, v7
    v_mov_b32 v139, 0
    v_sub_f32 v60, 0, v7
    v_mov_b32 v140, 0
    v_sub_f32 v61, 0, v7
    v_mov_b32 v141, 0
    v_sub_f32 v62, 0, v7
    v_mov_b32 v142, 0
    v_sub_f32 v63, 0, v7
    v_mov_b32 v143, 0
    v_sub_f32 v64, 0, v7
    v_mov_b32 v144, 0
    v_sub_f32 v65, 0, v7
    v_mov_b32 v145, 0
    v_sub_f32 v66, 0, v7
    v_mov_b32 v146, 0
    v_sub_f32 v67, 0, v7
    v_mov_b32 v147, 0
    v_sub_f32 v68, 0, v7
    v_mov_b32 v148, 0
    v_sub_f32 v69, 0, v7
    v_mov_b32 v149, 0
    v_sub_f32 v70, 0, v7
    v_mov_b32 v150, 0
    v_sub_f32 v71, 0, v7
    v_mov_b32 v151, 0
    v_and_b32 v6, 15, v2
    v_lshrrev_b32 v7, 5, v2
    v_lshl_add_u32 v6, v7, 4, v6
    v_lshlrev_b32 v6, 5, v6
    v_and_b32 v7, 16, v2
    v_cmp_eq_u32 s[48:49], 0, v7
    v_mov_b32 v7, 1065369472
    s_mov_b32 s31, 0
F_fbloop:
    buffer_load_dwordx4 v[16:19], v1, s[4:7], s38 offen sc1
    buffer_load_dwordx4 v[24:27], v6, s[4:7], s38 offen offset:1024 sc1
    buffer_load_dwordx4 v[28:31], v6, s[4:7], s38 offen offset:1040 sc1
    s_add_u32 s38, s38, 2048
    s_waitcnt vmcnt(0)
    v_cndmask_b32 v24, v7, v24, s[48:49]
    v_cndmask_b32 v25, v7, v25, s[48:49]
    v_cndmask_b32 v26, v7, v26, s[48:49]
    v_cndmask_b32 v27, v7, v27, s[48:49]
    v_cndmask_b32 v28, v7, v28, s[48:49]
    v_cndmask_b32 v29, v7, v29, s[48:49]
    v_cndmask_b32 v30, v7, v30, s[48:49]
    v_cndmask_b32 v31, v7, v31, s[48:49]
    v_mfma_f32_32x32x16_bf16 v[72:87], v[16:19], v[8:11], v[40:55]
    v_mfma_f32_32x32x16_bf16 v[88:103], v[16:19], v[12:15], v[56:71]
    s_nop 10
    v_exp_f32 v72, v72
    v_exp_f32 v73, v73
    v_exp_f32 v74, v74
    v_exp_f32 v75, v75
    v_exp_f32 v76, v76
    v_exp_f32 v77, v77
    v_exp_f32 v78, v78
    v_exp_f32 v79, v79
    v_exp_f32 v80, v80
    v_exp_f32 v81, v81
    v_exp_f32 v82, v82
    v_exp_f32 v83, v83
    v_exp_f32 v84, v84
    v_exp_f32 v85, v85
    v_exp_f32 v86, v86
    v_exp_f32 v87, v87
    v_cvt_pk_bf16_f32 v104, v72, v73
    v_cvt_pk_bf16_f32 v105, v74, v75
    v_cvt_pk_bf16_f32 v106, v76, v77
    v_cvt_pk_bf16_f32 v107, v78, v79
    v_cvt_pk_bf16_f32 v108, v80, v81
    v_cvt_pk_bf16_f32 v109, v82, v83
    v_cvt_pk_bf16_f32 v110, v84, v85
    v_cvt_pk_bf16_f32 v111, v86, v87
    v_mfma_f32_32x32x16_bf16 v[120:135], v[24:27], v[104:107], v[120:135]
    s_nop 0
    v_mfma_f32_32x32x16_bf16 v[120:135], v[28:31], v[108:111], v[120:135]
    v_exp_f32 v88, v88
    v_exp_f32 v89, v89
    v_exp_f32 v90, v90
    v_exp_f32 v91, v91
    v_exp_f32 v92, v92
    v_exp_f32 v93, v93
    v_exp_f32 v94, v94
    v_exp_f32 v95, v95
    v_exp_f32 v96, v96
    v_exp_f32 v97, v97
    v_exp_f32 v98, v98
    v_exp_f32 v99, v99
    v_exp_f32 v100, v100
    v_exp_f32 v101, v101
    v_exp_f32 v102, v102
    v_exp_f32 v103, v103
    v_cvt_pk_bf16_f32 v112, v88, v89
    v_cvt_pk_bf16_f32 v113, v90, v91
    v_cvt_pk_bf16_f32 v114, v92, v93
    v_cvt_pk_bf16_f32 v115, v94, v95
    v_cvt_pk_bf16_f32 v116, v96, v97
    v_cvt_pk_bf16_f32 v117, v98, v99
    v_cvt_pk_bf16_f32 v118, v100, v101
    v_cvt_pk_bf16_f32 v119, v102, v103
    v_mfma_f32_32x32x16_bf16 v[136:151], v[24:27], v[112:115], v[136:151]
    s_nop 0
    v_mfma_f32_32x32x16_bf16 v[136:151], v[28:31], v[116:119], v[136:151]
    s_add_u32 s31, s31, 1
    s_cmp_lt_u32 s31, 64
    s_nop 7
    s_nop 3
    s_cbranch_scc1 F_fbloop
    s_branch F_attn_done
.section .rodata,"a"
.p2align 6
.amdhsa_kernel sequential_preLN__softmax_full_mha__glu_gated_swiglu__prompt_kernel
  .amdhsa_next_free_vgpr 512
  .amdhsa_next_free_sgpr 102
  .amdhsa_accum_offset 256
  .amdhsa_group_segment_fixed_size 0
  .amdhsa_kernarg_size 80
  .amdhsa_user_sgpr_count 2
  .amdhsa_user_sgpr_kernarg_segment_ptr 1
  .amdhsa_system_sgpr_workgroup_id_x 1
.end_amdhsa_kernel
```
